```python
import torch

def _softmax(x, axis=-1):
    return torch.softmax(x, dim=axis)
def _gelu(x):
    return torch.nn.functional.gelu(x, approximate="tanh")
def _silu(x):
    return torch.nn.functional.silu(x)
def _sigmoid(x):
    return torch.sigmoid(x)
def _layernorm(x, axis=-1, eps=1e-5):
    m = x.mean(dim=axis, keepdim=True)
    v = x.var(dim=axis, keepdim=True, unbiased=False)
    return (x - m) / torch.sqrt(v + eps)
def _scatter_add(tgt, idx, src, axis=0):
    return tgt.clone().index_add_(axis, idx, src)
def _segment_sum(src, seg, n):
    out = torch.zeros((n,) + src.shape[1:], dtype=src.dtype)
    return out.index_add_(0, seg, src)
def _pad(x, pw):
    flat = tuple(v for pair in reversed(pw) for v in pair)
    return torch.nn.functional.pad(x, flat)

kernel_name = 'sequential_preLN__sliding_block__mixer_channel_mlp__prompt'

def setup_inputs():

    _w = (lambda a: (lambda t: t.to(torch.bfloat16) if t.is_floating_point() else t)(torch.as_tensor(a)))
    def _A_setup():
        B, S, D = 1, 2048, 640
        return {
            "x": _w((lambda *s: torch.randn(*s, dtype=torch.bfloat16) * 0.05)(B, S, D)),
            "wqkv": _w((lambda *s: torch.randn(*s, dtype=torch.bfloat16) * 0.05)(D, 3 * D)),
            "wo": _w((lambda *s: torch.randn(*s, dtype=torch.bfloat16) * 0.05)(D, D)),
        }
    _A_in = _A_setup()

    def _B_setup():
        B, S, D, F = 1, 2048, 640, 1536
        return {
            "x": _w((lambda *s: torch.randn(*s, dtype=torch.bfloat16) * 0.05)(B, S, D)),
            "w1": _w((lambda *s: torch.randn(*s, dtype=torch.bfloat16) * 3.2)(D, F) * (D ** -0.5)),
            "b1": _w((lambda *s: torch.randn(*s, dtype=torch.bfloat16) * 1.6)(F)),
            "w2": _w((lambda *s: torch.randn(*s, dtype=torch.bfloat16) * 0.2)(F, D) * (F ** -0.5)),
            "b2": _w((lambda *s: torch.randn(*s, dtype=torch.bfloat16) * 0.4)(D)),
        }
    _B_in = _B_setup()

    return {
        "A_x": _A_in["x"],
        "A_wqkv": _A_in["wqkv"],
        "A_wo": _A_in["wo"],
        "B_x": _B_in["x"],
        "B_w1": _B_in["w1"],
        "B_b1": _B_in["b1"],
        "B_w2": _B_in["w2"],
        "B_b2": _B_in["b2"],
    }

def reference(A_x, A_wqkv, A_wo, B_x, B_w1, B_b1, B_w2, B_b2):
    def _A_ref(x, wqkv, wo):
        B, S, D = x.shape
        H = 32; Dh = D // H; W = 256
        qkv = (lambda x, *d: x.permute(*d))((x @ wqkv).reshape(B, S, 3, H, Dh), 2, 0, 3, 1, 4)
        q, k, v = qkv[0], qkv[1], qkv[2]
        scores = torch.einsum("bhqd,bhkd->bhqk", q, k) * (Dh ** -0.5)
        idx = torch.arange(S)
        mask = (idx[:, None] - idx[None, :] >= 0) & (idx[:, None] - idx[None, :] < W)
        scores = torch.where(mask[None, None], scores, -1e9)
        p = _softmax(scores, axis=-1)
        o = torch.einsum("bhqk,bhkd->bhqd", p, v)
        return (lambda x, *d: x.permute(*d))(o, 0, 2, 1, 3).reshape(B, S, D) @ wo

    def _B_ref(x, w1, b1, w2, b2):
        y = _layernorm(x, axis=-1)
        h = _gelu(torch.einsum("bsd,df->bsf", y, w1) + b1)
        return torch.einsum("bsf,fd->bsd", h, w2) + b2

    x = A_x
    h = x + _A_ref(_layernorm(x, axis=-1), A_wqkv, A_wo)
    h2 = h + _B_ref(_layernorm(h, axis=-1), B_w1, B_b1, B_w2, B_b2)
    return h2
```

```asm
; @launch kernel=k1_qkv_kernel grid=(256,1,1) block=(768,1,1) lds=163840
; @launch kernel=k2_attn_kernel grid=(256,1,1) block=(512,1,1) lds=70336
; @launch kernel=k3_wo_kernel grid=(256,1,1) block=(512,1,1) lds=147456
; @launch kernel=k4_w1_kernel grid=(256,1,1) block=(512,1,1) lds=115712
; @launch kernel=k5_w2_kernel grid=(256,1,1) block=(512,1,1) lds=147456
.amdgcn_target "amdgcn-amd-amdhsa--gfx950"
.text
.globl k1_qkv_kernel
.p2align 8
.type k1_qkv_kernel,@function
k1_qkv_kernel:
    s_cmp_ge_u32 s2, 256
    s_cbranch_scc1 k1_qkv_kernel_end1
    s_load_dwordx16 s[4:19], s[0:1], 0
    s_cmp_ge_u32 s2, 32
    s_cbranch_scc1 k1_qkv_kernel_nocpf2
    v_cmp_gt_u32 vcc, 64, v0
    s_getpc_b64 s[32:33]
k1_qkv_kernel_here3:
    s_add_u32 s28, s32, k1_qkv_kernel-k1_qkv_kernel_here3
    s_addc_u32 s29, s33, -1
    s_and_b32 s29, s29, 0xffff
    s_mov_b32 s30, code_end-k1_qkv_kernel
    s_mov_b32 s31, 0x20000
    s_lshr_b32 s3, s2, 3
    s_mul_i32 s3, s3, 24576
    v_lshlrev_b32 v2, 7, v0
    v_add_u32 v2, s3, v2
    v_mov_b32 v3, 0x7f000000
    v_cndmask_b32 v2, v3, v2, vcc
    v_readfirstlane_b32 s3, v0
    s_cmp_ge_u32 s3, 64
    s_cbranch_scc1 k1_qkv_kernel_nocpf2
    buffer_load_dword v1, v2, s[28:31], 0 offen offset:0
    v_add_u32 v2, 8192, v2
    buffer_load_dword v1, v2, s[28:31], 0 offen
    v_add_u32 v2, 8192, v2
    buffer_load_dword v1, v2, s[28:31], 0 offen
k1_qkv_kernel_nocpf2:
    s_load_dwordx4 s[20:23], s[0:1], 64
    s_load_dwordx2 s[24:25], s[0:1], 80
    v_lshrrev_b32 v5, 6, v0
    v_and_b32 v2, 63, v0
    v_readfirstlane_b32 s26, v5
    v_and_b32 v3, 15, v2
    v_lshrrev_b32 v4, 4, v2
    s_and_b32 s29, s26, 3
    s_and_b32 s27, s2, 7
    s_lshr_b32 s28, s2, 3
    s_and_b32 s30, s27, 3
    s_lshl_b32 s30, s30, 2
    s_and_b32 s3, s28, 3
    s_add_u32 s30, s30, s3
    s_lshr_b32 s31, s27, 2
    s_lshl_b32 s31, s31, 3
    s_lshr_b32 s3, s28, 2
    s_add_u32 s31, s31, s3
    s_lshr_b32 s32, s29, 1
    s_and_b32 s33, s29, 1
    s_cmp_lt_u32 s26, 4
    s_cbranch_scc1 k1_qkv_kernel_cons7
    s_cmp_ge_u32 s26, 8
    s_cbranch_scc1 k1_qkv_kernel_statw9
    s_cmp_eq_u32 s31, 15
    s_cbranch_scc1 k1_qkv_kernel_spare5l
    v_lshrrev_b32 v5, 3, v2
    s_lshl_b32 s3, s30, 7
    s_lshl_b32 s27, s29, 5
    s_add_u32 s3, s3, s27
    v_add_u32 v5, s3, v5
    v_mul_u32_u24 v5, 1280, v5
    v_and_b32 v6, 7, v2
    v_xor_b32 v7, v6, v4
    v_lshl_add_u32 v8, v7, 4, v5
    v_xor_b32 v7, 4, v7
    v_lshl_add_u32 v9, v7, 4, v5
    v_add_u32 v9, 10240, v9
    v_add_u32 v10, 20480, v8
    v_add_u32 v11, 20480, v9
    s_lshl_b32 s3, s29, 4
    v_add_u32 v6, s3, v4
    v_mul_u32_u24 v6, 3840, v6
    s_lshl_b32 s3, s31, 8
    v_add_u32 v6, s3, v6
    v_lshlrev_b32 v5, 1, v4
    v_sub_u32 v5, v3, v5
    v_subrev_u32 v5, 0, v5
    v_and_b32 v5, 15, v5
    v_lshl_add_u32 v12, v5, 4, v6
    v_add_u32 v12, 0, v12
    v_add_u32 v13, 15360, v12
    v_lshlrev_b32 v5, 1, v4
    v_sub_u32 v5, v3, v5
    v_subrev_u32 v5, 8, v5
    v_and_b32 v5, 15, v5
    v_lshl_add_u32 v14, v5, 4, v6
    v_add_u32 v14, 30720, v14
    v_add_u32 v15, 15360, v14
    s_lshl_b32 s50, s29, 12
    s_and_b32 s3, s2, 3
    s_mul_i32 s48, s3, 5
    s_lshr_b32 s48, s48, 1
    s_lshr_b32 s3, s2, 2
    s_and_b32 s3, s3, 1
    s_add_u32 s3, s3, s48
    s_lshl_b32 s48, s3, 7
    s_mul_i32 s49, s3, 245760
    s_waitcnt lgkmcnt(0)
    s_mov_b32 s36, s4
    s_and_b32 s37, s5, 0xffff
    s_mov_b32 s38, 2621440
    s_mov_b32 s39, 0x20000
    s_mov_b32 s40, s6
    s_and_b32 s41, s7, 0xffff
    s_mov_b32 s42, 2457600
    s_mov_b32 s43, 0x20000
    s_add_u32 m0, s50, 0
    s_nop 0
    buffer_load_dwordx4 v8, s[36:39], s48 offen lds
    s_add_u32 m0, s50, 1024
    s_nop 0
    buffer_load_dwordx4 v9, s[36:39], s48 offen lds
    s_add_u32 m0, s50, 2048
    s_nop 0
    buffer_load_dwordx4 v10, s[36:39], s48 offen lds
    s_add_u32 m0, s50, 3072
    s_nop 0
    buffer_load_dwordx4 v11, s[36:39], s48 offen lds
    s_add_u32 m0, s50, 16384
    s_nop 0
    buffer_load_dwordx4 v12, s[40:43], s49 offen lds
    s_add_u32 m0, s50, 17408
    s_nop 0
    buffer_load_dwordx4 v13, s[40:43], s49 offen lds
    s_add_u32 m0, s50, 18432
    s_nop 0
    buffer_load_dwordx4 v14, s[40:43], s49 offen lds
    s_add_u32 m0, s50, 19456
    s_nop 0
    buffer_load_dwordx4 v15, s[40:43], s49 offen lds
    s_add_u32 s48, s48, 128
    s_add_u32 s49, s49, 245760
    s_cmp_ge_u32 s48, 1280
    s_cselect_b32 s48, 0, s48
    s_cselect_b32 s49, 0, s49
    s_add_u32 m0, s50, 32768
    s_nop 0
    buffer_load_dwordx4 v8, s[36:39], s48 offen lds
    s_add_u32 m0, s50, 33792
    s_nop 0
    buffer_load_dwordx4 v9, s[36:39], s48 offen lds
    s_add_u32 m0, s50, 34816
    s_nop 0
    buffer_load_dwordx4 v10, s[36:39], s48 offen lds
    s_add_u32 m0, s50, 35840
    s_nop 0
    buffer_load_dwordx4 v11, s[36:39], s48 offen lds
    s_add_u32 m0, s50, 49152
    s_nop 0
    buffer_load_dwordx4 v12, s[40:43], s49 offen lds
    s_add_u32 m0, s50, 50176
    s_nop 0
    buffer_load_dwordx4 v13, s[40:43], s49 offen lds
    s_add_u32 m0, s50, 51200
    s_nop 0
    buffer_load_dwordx4 v14, s[40:43], s49 offen lds
    s_add_u32 m0, s50, 52224
    s_nop 0
    buffer_load_dwordx4 v15, s[40:43], s49 offen lds
    s_add_u32 s48, s48, 128
    s_add_u32 s49, s49, 245760
    s_cmp_ge_u32 s48, 1280
    s_cselect_b32 s48, 0, s48
    s_cselect_b32 s49, 0, s49
    s_waitcnt vmcnt(8)
    s_barrier
    s_add_u32 m0, s50, 65536
    s_nop 0
    buffer_load_dwordx4 v8, s[36:39], s48 offen lds
    s_add_u32 m0, s50, 66560
    s_nop 0
    buffer_load_dwordx4 v9, s[36:39], s48 offen lds
    s_add_u32 m0, s50, 67584
    s_nop 0
    buffer_load_dwordx4 v10, s[36:39], s48 offen lds
    s_add_u32 m0, s50, 68608
    s_nop 0
    buffer_load_dwordx4 v11, s[36:39], s48 offen lds
    s_add_u32 m0, s50, 81920
    s_nop 0
    buffer_load_dwordx4 v12, s[40:43], s49 offen lds
    s_add_u32 m0, s50, 82944
    s_nop 0
    buffer_load_dwordx4 v13, s[40:43], s49 offen lds
    s_add_u32 m0, s50, 83968
    s_nop 0
    buffer_load_dwordx4 v14, s[40:43], s49 offen lds
    s_add_u32 m0, s50, 84992
    s_nop 0
    buffer_load_dwordx4 v15, s[40:43], s49 offen lds
    s_add_u32 s48, s48, 128
    s_add_u32 s49, s49, 245760
    s_cmp_ge_u32 s48, 1280
    s_cselect_b32 s48, 0, s48
    s_cselect_b32 s49, 0, s49
    s_add_u32 m0, s50, 98304
    s_nop 0
    buffer_load_dwordx4 v8, s[36:39], s48 offen lds
    s_add_u32 m0, s50, 99328
    s_nop 0
    buffer_load_dwordx4 v9, s[36:39], s48 offen lds
    s_add_u32 m0, s50, 100352
    s_nop 0
    buffer_load_dwordx4 v10, s[36:39], s48 offen lds
    s_add_u32 m0, s50, 101376
    s_nop 0
    buffer_load_dwordx4 v11, s[36:39], s48 offen lds
    s_add_u32 m0, s50, 114688
    s_nop 0
    buffer_load_dwordx4 v12, s[40:43], s49 offen lds
    s_add_u32 m0, s50, 115712
    s_nop 0
    buffer_load_dwordx4 v13, s[40:43], s49 offen lds
    s_add_u32 m0, s50, 116736
    s_nop 0
    buffer_load_dwordx4 v14, s[40:43], s49 offen lds
    s_add_u32 m0, s50, 117760
    s_nop 0
    buffer_load_dwordx4 v15, s[40:43], s49 offen lds
    s_add_u32 s48, s48, 128
    s_add_u32 s49, s49, 245760
    s_cmp_ge_u32 s48, 1280
    s_cselect_b32 s48, 0, s48
    s_cselect_b32 s49, 0, s49
    s_lshl_b32 s59, s30, 4
    s_add_u32 s59, s59, s31
    s_lshl_b32 s59, s59, 2
    s_add_u32 s59, s59, s29
    s_lshl_b32 s63, s29, 13
    s_add_u32 s63, s63, 131072
    s_mov_b32 s57, 0
    s_add_u32 s52, s24, 28311552
    s_addc_u32 s53, s25, 0
    s_and_b32 s53, s53, 0xffff
    s_mov_b32 s54, 1966080
    s_mov_b32 s55, 0x20000
    s_mov_b32 s56, 0
    v_mov_b32 v16, 0
    v_mov_b32 v17, 0
    s_cmp_ge_u32 s59, 864
    s_cbranch_scc1 k1_qkv_kernel_tz14
    s_cmp_ge_u32 s59, 544
    s_cbranch_scc1 k1_qkv_kernel_tB11
    s_mov_b32 s57, 1
    s_cmp_ge_u32 s59, 160
    s_cbranch_scc1 k1_qkv_kernel_tw212
    s_and_b32 s60, s59, 7
    s_lshr_b32 s61, s59, 3
    s_mov_b32 s64, s8
    s_and_b32 s65, s9, 0xffff
    s_mov_b32 s66, 819200
    s_mov_b32 s67, 0x20000
    s_add_u32 s52, s24, 25165824
    s_addc_u32 s53, s25, 0
    s_and_b32 s53, s53, 0xffff
    s_mov_b32 s54, 819200
    s_mov_b32 s55, 0x20000
    s_mul_i32 s56, s60, 102400
    s_branch k1_qkv_kernel_tA13
k1_qkv_kernel_tw212:
    s_sub_u32 s59, s59, 160
    s_and_b32 s60, s59, 7
    s_lshr_b32 s61, s59, 3
    s_mov_b32 s64, s16
    s_and_b32 s65, s17, 0xffff
    s_mov_b32 s66, 1966080
    s_mov_b32 s67, 0x20000
    s_mul_i32 s56, s60, 245760
k1_qkv_kernel_tA13:
    s_mul_i32 s3, s61, 5120
    s_add_u32 s56, s56, s3
    s_mul_i32 s62, s61, 40960
    s_mul_i32 s3, s60, 160
    s_add_u32 s62, s62, s3
    v_add_u32 v5, 0, v2
    v_mul_u32_u24 v6, 6554, v5
    v_lshrrev_b32 v6, 16, v6
    v_mul_u32_u24 v7, 10, v6
    v_sub_u32 v5, v5, v7
    v_and_b32 v7, 0x13, v6
    v_and_b32 v164, 4, v6
    v_lshl_or_b32 v7, v164, 1, v7
    v_and_b32 v164, 8, v6
    v_lshrrev_b32 v164, 1, v164
    v_or_b32 v7, v7, v164
    v_mul_u32_u24 v7, 1280, v7
    v_lshl_add_u32 v164, v5, 4, v7
    s_add_u32 m0, s63, 0
    s_nop 0
    buffer_load_dwordx4 v164, s[64:67], s62 offen lds
    v_add_u32 v5, 64, v2
    v_mul_u32_u24 v6, 6554, v5
    v_lshrrev_b32 v6, 16, v6
    v_mul_u32_u24 v7, 10, v6
    v_sub_u32 v5, v5, v7
    v_and_b32 v7, 0x13, v6
    v_and_b32 v164, 4, v6
    v_lshl_or_b32 v7, v164, 1, v7
    v_and_b32 v164, 8, v6
    v_lshrrev_b32 v164, 1, v164
    v_or_b32 v7, v7, v164
    v_mul_u32_u24 v7, 1280, v7
    v_lshl_add_u32 v164, v5, 4, v7
    s_add_u32 m0, s63, 1024
    s_nop 0
    buffer_load_dwordx4 v164, s[64:67], s62 offen lds
    v_add_u32 v5, 128, v2
    v_mul_u32_u24 v6, 6554, v5
    v_lshrrev_b32 v6, 16, v6
    v_mul_u32_u24 v7, 10, v6
    v_sub_u32 v5, v5, v7
    v_and_b32 v7, 0x13, v6
    v_and_b32 v164, 4, v6
    v_lshl_or_b32 v7, v164, 1, v7
    v_and_b32 v164, 8, v6
    v_lshrrev_b32 v164, 1, v164
    v_or_b32 v7, v7, v164
    v_mul_u32_u24 v7, 1280, v7
    v_lshl_add_u32 v164, v5, 4, v7
    s_add_u32 m0, s63, 2048
    s_nop 0
    buffer_load_dwordx4 v164, s[64:67], s62 offen lds
    v_add_u32 v5, 192, v2
    v_mul_u32_u24 v6, 6554, v5
    v_lshrrev_b32 v6, 16, v6
    v_mul_u32_u24 v7, 10, v6
    v_sub_u32 v5, v5, v7
    v_and_b32 v7, 0x13, v6
    v_and_b32 v164, 4, v6
    v_lshl_or_b32 v7, v164, 1, v7
    v_and_b32 v164, 8, v6
    v_lshrrev_b32 v164, 1, v164
    v_or_b32 v7, v7, v164
    v_mul_u32_u24 v7, 1280, v7
    v_lshl_add_u32 v164, v5, 4, v7
    s_add_u32 m0, s63, 3072
    s_nop 0
    buffer_load_dwordx4 v164, s[64:67], s62 offen lds
    v_add_u32 v5, 256, v2
    v_mul_u32_u24 v6, 6554, v5
    v_lshrrev_b32 v6, 16, v6
    v_mul_u32_u24 v7, 10, v6
    v_sub_u32 v5, v5, v7
    v_and_b32 v7, 0x13, v6
    v_and_b32 v164, 4, v6
    v_lshl_or_b32 v7, v164, 1, v7
    v_and_b32 v164, 8, v6
    v_lshrrev_b32 v164, 1, v164
    v_or_b32 v7, v7, v164
    v_mul_u32_u24 v7, 1280, v7
    v_lshl_add_u32 v164, v5, 4, v7
    s_add_u32 m0, s63, 4096
    s_nop 0
    buffer_load_dwordx4 v164, s[64:67], s62 offen lds
    v_lshrrev_b32 v5, 1, v4
    v_lshlrev_b32 v5, 4, v5
    v_and_b32 v6, 1, v4
    v_lshl_add_u32 v5, v6, 2, v5
    v_lshrrev_b32 v6, 2, v3
    v_add_u32 v5, v5, v6
    v_mul_u32_u24 v5, 160, v5
    v_and_b32 v6, 3, v2
    v_lshlrev_b32 v6, 3, v6
    v_add3_u32 v16, v5, v6, s63
    v_mov_b32 v164, 0x7f000000
    buffer_load_dword v1, v164, s[52:55], 0 offen
    buffer_load_dword v1, v164, s[52:55], 0 offen
    buffer_load_dword v1, v164, s[52:55], 0 offen
    s_branch k1_qkv_kernel_tdone10
k1_qkv_kernel_tB11:
    s_mov_b32 s57, 2
    s_sub_u32 s59, s59, 544
    s_and_b32 s60, s59, 15
    s_lshr_b32 s61, s59, 4
    s_mov_b32 s64, s12
    s_and_b32 s65, s13, 0xffff
    s_mov_b32 s66, 1966080
    s_mov_b32 s67, 0x20000
    s_add_u32 s52, s24, 26214400
    s_addc_u32 s53, s25, 0
    s_and_b32 s53, s53, 0xffff
    s_mov_b32 s54, 1966080
    s_mov_b32 s55, 0x20000
    s_mul_i32 s56, s60, 122880
    s_mul_i32 s3, s61, 6144
    s_add_u32 s56, s56, s3
    s_mul_i32 s62, s61, 98304
    s_mul_i32 s3, s60, 192
    s_add_u32 s62, s62, s3
    v_mul_u32_u24 v6, 3072, v4
    v_lshlrev_b32 v5, 1, v4
    v_sub_u32 v5, v3, v5
    v_subrev_u32 v5, 0, v5
    v_and_b32 v5, 15, v5
    v_lshl_add_u32 v164, v5, 4, v6
    v_add_u32 v164, 0, v164
    v_cmp_lt_u32 vcc, 11, v5
    v_mov_b32 v7, 0x7f000000
    s_add_u32 m0, s63, 0
    v_cndmask_b32 v164, v164, v7, vcc
    buffer_load_dwordx4 v164, s[64:67], s62 offen lds
    v_lshlrev_b32 v5, 1, v4
    v_sub_u32 v5, v3, v5
    v_subrev_u32 v5, 0, v5
    v_and_b32 v5, 15, v5
    v_lshl_add_u32 v164, v5, 4, v6
    v_add_u32 v164, 12288, v164
    v_cmp_lt_u32 vcc, 11, v5
    v_mov_b32 v7, 0x7f000000
    s_add_u32 m0, s63, 1024
    v_cndmask_b32 v164, v164, v7, vcc
    buffer_load_dwordx4 v164, s[64:67], s62 offen lds
    v_lshlrev_b32 v5, 1, v4
    v_sub_u32 v5, v3, v5
    v_subrev_u32 v5, 8, v5
    v_and_b32 v5, 15, v5
    v_lshl_add_u32 v164, v5, 4, v6
    v_add_u32 v164, 24576, v164
    v_cmp_lt_u32 vcc, 11, v5
    v_mov_b32 v7, 0x7f000000
    s_add_u32 m0, s63, 2048
    v_cndmask_b32 v164, v164, v7, vcc
    buffer_load_dwordx4 v164, s[64:67], s62 offen lds
    v_lshlrev_b32 v5, 1, v4
    v_sub_u32 v5, v3, v5
    v_subrev_u32 v5, 8, v5
    v_and_b32 v5, 15, v5
    v_lshl_add_u32 v164, v5, 4, v6
    v_add_u32 v164, 36864, v164
    v_cmp_lt_u32 vcc, 11, v5
    v_mov_b32 v7, 0x7f000000
    s_add_u32 m0, s63, 3072
    v_cndmask_b32 v164, v164, v7, vcc
    buffer_load_dwordx4 v164, s[64:67], s62 offen lds
    v_lshlrev_b32 v5, 1, v4
    v_sub_u32 v5, v3, v5
    v_subrev_u32 v5, 0, v5
    v_and_b32 v5, 15, v5
    v_lshl_add_u32 v164, v5, 4, v6
    v_add_u32 v164, 49152, v164
    v_cmp_lt_u32 vcc, 11, v5
    v_mov_b32 v7, 0x7f000000
    s_add_u32 m0, s63, 4096
    v_cndmask_b32 v164, v164, v7, vcc
    buffer_load_dwordx4 v164, s[64:67], s62 offen lds
    v_lshlrev_b32 v5, 1, v4
    v_sub_u32 v5, v3, v5
    v_subrev_u32 v5, 0, v5
    v_and_b32 v5, 15, v5
    v_lshl_add_u32 v164, v5, 4, v6
    v_add_u32 v164, 61440, v164
    v_cmp_lt_u32 vcc, 11, v5
    v_mov_b32 v7, 0x7f000000
    s_add_u32 m0, s63, 5120
    v_cndmask_b32 v164, v164, v7, vcc
    buffer_load_dwordx4 v164, s[64:67], s62 offen lds
    v_lshlrev_b32 v5, 1, v4
    v_sub_u32 v5, v3, v5
    v_subrev_u32 v5, 8, v5
    v_and_b32 v5, 15, v5
    v_lshl_add_u32 v164, v5, 4, v6
    v_add_u32 v164, 73728, v164
    v_cmp_lt_u32 vcc, 11, v5
    v_mov_b32 v7, 0x7f000000
    s_add_u32 m0, s63, 6144
    v_cndmask_b32 v164, v164, v7, vcc
    buffer_load_dwordx4 v164, s[64:67], s62 offen lds
    v_lshlrev_b32 v5, 1, v4
    v_sub_u32 v5, v3, v5
    v_subrev_u32 v5, 8, v5
    v_and_b32 v5, 15, v5
    v_lshl_add_u32 v164, v5, 4, v6
    v_add_u32 v164, 86016, v164
    v_cmp_lt_u32 vcc, 11, v5
    v_mov_b32 v7, 0x7f000000
    s_add_u32 m0, s63, 7168
    v_cndmask_b32 v164, v164, v7, vcc
    buffer_load_dwordx4 v164, s[64:67], s62 offen lds
    v_lshrrev_b32 v7, 2, v3
    v_and_b32 v5, 1, v4
    v_lshl_add_u32 v5, v5, 2, v7
    v_lshlrev_b32 v5, 1, v5
    v_lshl_add_u32 v6, v4, 3, v7
    v_lshlrev_b32 v6, 8, v6
    v_and_b32 v7, 3, v2
    v_lshrrev_b32 v164, 1, v7
    v_add_u32 v16, v5, v164
    v_and_b32 v7, 1, v7
    v_lshl_add_u32 v6, v7, 3, v6
    v_add_u32 v17, s63, v6
    s_branch k1_qkv_kernel_tdone10
k1_qkv_kernel_tz14:
    v_mov_b32 v164, 0x7f000000
    buffer_load_dword v1, v164, s[52:55], 0 offen
    buffer_load_dword v1, v164, s[52:55], 0 offen
    buffer_load_dword v1, v164, s[52:55], 0 offen
    buffer_load_dword v1, v164, s[52:55], 0 offen
    buffer_load_dword v1, v164, s[52:55], 0 offen
    buffer_load_dword v1, v164, s[52:55], 0 offen
    buffer_load_dword v1, v164, s[52:55], 0 offen
    buffer_load_dword v1, v164, s[52:55], 0 offen
k1_qkv_kernel_tdone10:
    s_waitcnt vmcnt(24)
    s_barrier
    s_add_u32 m0, s50, 0
    s_nop 0
    buffer_load_dwordx4 v8, s[36:39], s48 offen lds
    s_add_u32 m0, s50, 1024
    s_nop 0
    buffer_load_dwordx4 v9, s[36:39], s48 offen lds
    s_add_u32 m0, s50, 2048
    s_nop 0
    buffer_load_dwordx4 v10, s[36:39], s48 offen lds
    s_add_u32 m0, s50, 3072
    s_nop 0
    buffer_load_dwordx4 v11, s[36:39], s48 offen lds
    s_add_u32 m0, s50, 16384
    s_nop 0
    buffer_load_dwordx4 v12, s[40:43], s49 offen lds
    s_add_u32 m0, s50, 17408
    s_nop 0
    buffer_load_dwordx4 v13, s[40:43], s49 offen lds
    s_add_u32 m0, s50, 18432
    s_nop 0
    buffer_load_dwordx4 v14, s[40:43], s49 offen lds
    s_add_u32 m0, s50, 19456
    s_nop 0
    buffer_load_dwordx4 v15, s[40:43], s49 offen lds
    s_add_u32 s48, s48, 128
    s_add_u32 s49, s49, 245760
    s_cmp_ge_u32 s48, 1280
    s_cselect_b32 s48, 0, s48
    s_cselect_b32 s49, 0, s49
    s_waitcnt vmcnt(24)
    s_barrier
    s_add_u32 m0, s50, 32768
    s_nop 0
    buffer_load_dwordx4 v8, s[36:39], s48 offen lds
    s_add_u32 m0, s50, 33792
    s_nop 0
    buffer_load_dwordx4 v9, s[36:39], s48 offen lds
    s_add_u32 m0, s50, 34816
    s_nop 0
    buffer_load_dwordx4 v10, s[36:39], s48 offen lds
    s_add_u32 m0, s50, 35840
    s_nop 0
    buffer_load_dwordx4 v11, s[36:39], s48 offen lds
    s_add_u32 m0, s50, 49152
    s_nop 0
    buffer_load_dwordx4 v12, s[40:43], s49 offen lds
    s_add_u32 m0, s50, 50176
    s_nop 0
    buffer_load_dwordx4 v13, s[40:43], s49 offen lds
    s_add_u32 m0, s50, 51200
    s_nop 0
    buffer_load_dwordx4 v14, s[40:43], s49 offen lds
    s_add_u32 m0, s50, 52224
    s_nop 0
    buffer_load_dwordx4 v15, s[40:43], s49 offen lds
    s_add_u32 s48, s48, 128
    s_add_u32 s49, s49, 245760
    s_cmp_ge_u32 s48, 1280
    s_cselect_b32 s48, 0, s48
    s_cselect_b32 s49, 0, s49
    s_waitcnt vmcnt(24)
    s_barrier
    s_add_u32 m0, s50, 65536
    s_nop 0
    buffer_load_dwordx4 v8, s[36:39], s48 offen lds
    s_add_u32 m0, s50, 66560
    s_nop 0
    buffer_load_dwordx4 v9, s[36:39], s48 offen lds
    s_add_u32 m0, s50, 67584
    s_nop 0
    buffer_load_dwordx4 v10, s[36:39], s48 offen lds
    s_add_u32 m0, s50, 68608
    s_nop 0
    buffer_load_dwordx4 v11, s[36:39], s48 offen lds
    s_add_u32 m0, s50, 81920
    s_nop 0
    buffer_load_dwordx4 v12, s[40:43], s49 offen lds
    s_add_u32 m0, s50, 82944
    s_nop 0
    buffer_load_dwordx4 v13, s[40:43], s49 offen lds
    s_add_u32 m0, s50, 83968
    s_nop 0
    buffer_load_dwordx4 v14, s[40:43], s49 offen lds
    s_add_u32 m0, s50, 84992
    s_nop 0
    buffer_load_dwordx4 v15, s[40:43], s49 offen lds
    s_add_u32 s48, s48, 128
    s_add_u32 s49, s49, 245760
    s_cmp_ge_u32 s48, 1280
    s_cselect_b32 s48, 0, s48
    s_cselect_b32 s49, 0, s49
    s_waitcnt vmcnt(16)
    s_barrier
    s_add_u32 m0, s50, 98304
    s_nop 0
    buffer_load_dwordx4 v8, s[36:39], s48 offen lds
    s_add_u32 m0, s50, 99328
    s_nop 0
    buffer_load_dwordx4 v9, s[36:39], s48 offen lds
    s_add_u32 m0, s50, 100352
    s_nop 0
    buffer_load_dwordx4 v10, s[36:39], s48 offen lds
    s_add_u32 m0, s50, 101376
    s_nop 0
    buffer_load_dwordx4 v11, s[36:39], s48 offen lds
    s_add_u32 m0, s50, 114688
    s_nop 0
    buffer_load_dwordx4 v12, s[40:43], s49 offen lds
    s_add_u32 m0, s50, 115712
    s_nop 0
    buffer_load_dwordx4 v13, s[40:43], s49 offen lds
    s_add_u32 m0, s50, 116736
    s_nop 0
    buffer_load_dwordx4 v14, s[40:43], s49 offen lds
    s_add_u32 m0, s50, 117760
    s_nop 0
    buffer_load_dwordx4 v15, s[40:43], s49 offen lds
    s_add_u32 s48, s48, 128
    s_add_u32 s49, s49, 245760
    s_cmp_ge_u32 s48, 1280
    s_cselect_b32 s48, 0, s48
    s_cselect_b32 s49, 0, s49
    s_waitcnt vmcnt(16)
    s_barrier
    s_add_u32 m0, s50, 0
    s_nop 0
    buffer_load_dwordx4 v8, s[36:39], s48 offen lds
    s_add_u32 m0, s50, 1024
    s_nop 0
    buffer_load_dwordx4 v9, s[36:39], s48 offen lds
    s_add_u32 m0, s50, 2048
    s_nop 0
    buffer_load_dwordx4 v10, s[36:39], s48 offen lds
    s_add_u32 m0, s50, 3072
    s_nop 0
    buffer_load_dwordx4 v11, s[36:39], s48 offen lds
    s_add_u32 m0, s50, 16384
    s_nop 0
    buffer_load_dwordx4 v12, s[40:43], s49 offen lds
    s_add_u32 m0, s50, 17408
    s_nop 0
    buffer_load_dwordx4 v13, s[40:43], s49 offen lds
    s_add_u32 m0, s50, 18432
    s_nop 0
    buffer_load_dwordx4 v14, s[40:43], s49 offen lds
    s_add_u32 m0, s50, 19456
    s_nop 0
    buffer_load_dwordx4 v15, s[40:43], s49 offen lds
    s_add_u32 s48, s48, 128
    s_add_u32 s49, s49, 245760
    s_cmp_ge_u32 s48, 1280
    s_cselect_b32 s48, 0, s48
    s_cselect_b32 s49, 0, s49
    s_waitcnt vmcnt(16)
    s_barrier
    s_add_u32 m0, s50, 32768
    s_nop 0
    buffer_load_dwordx4 v8, s[36:39], s48 offen lds
    s_add_u32 m0, s50, 33792
    s_nop 0
    buffer_load_dwordx4 v9, s[36:39], s48 offen lds
    s_add_u32 m0, s50, 34816
    s_nop 0
    buffer_load_dwordx4 v10, s[36:39], s48 offen lds
    s_add_u32 m0, s50, 35840
    s_nop 0
    buffer_load_dwordx4 v11, s[36:39], s48 offen lds
    s_add_u32 m0, s50, 49152
    s_nop 0
    buffer_load_dwordx4 v12, s[40:43], s49 offen lds
    s_add_u32 m0, s50, 50176
    s_nop 0
    buffer_load_dwordx4 v13, s[40:43], s49 offen lds
    s_add_u32 m0, s50, 51200
    s_nop 0
    buffer_load_dwordx4 v14, s[40:43], s49 offen lds
    s_add_u32 m0, s50, 52224
    s_nop 0
    buffer_load_dwordx4 v15, s[40:43], s49 offen lds
    s_add_u32 s48, s48, 128
    s_add_u32 s49, s49, 245760
    s_cmp_ge_u32 s48, 1280
    s_cselect_b32 s48, 0, s48
    s_cselect_b32 s49, 0, s49
    s_waitcnt vmcnt(16)
    s_barrier
    s_waitcnt vmcnt(48)
    s_cmp_eq_u32 s57, 0
    s_cbranch_scc1 k1_qkv_kernel_tfz17
    v_lshlrev_b32 v5, 4, v2
    s_cmp_eq_u32 s57, 2
    s_cbranch_scc1 k1_qkv_kernel_tfB16
    ds_read_b64_tr_b16 v[20:21], v16 offset:0
    ds_read_b64_tr_b16 v[22:23], v16 offset:1280
    ds_read_b64_tr_b16 v[24:25], v16 offset:32
    ds_read_b64_tr_b16 v[26:27], v16 offset:1312
    ds_read_b64_tr_b16 v[28:29], v16 offset:64
    ds_read_b64_tr_b16 v[30:31], v16 offset:1344
    ds_read_b64_tr_b16 v[32:33], v16 offset:96
    ds_read_b64_tr_b16 v[34:35], v16 offset:1376
    ds_read_b64_tr_b16 v[36:37], v16 offset:128
    ds_read_b64_tr_b16 v[38:39], v16 offset:1408
    s_waitcnt lgkmcnt(0)
    buffer_store_dwordx4 v[20:23], v5, s[52:55], s56 offen offset:0 sc1
    buffer_store_dwordx4 v[24:27], v5, s[52:55], s56 offen offset:1024 sc1
    buffer_store_dwordx4 v[28:31], v5, s[52:55], s56 offen offset:2048 sc1
    buffer_store_dwordx4 v[32:35], v5, s[52:55], s56 offen offset:3072 sc1
    s_add_u32 s3, s56, 4096
    buffer_store_dwordx4 v[36:39], v5, s[52:55], s3 offen sc1
    v_mov_b32 v7, 0x7f000000
    buffer_store_dword v7, v7, s[52:55], 0 offen
    s_branch k1_qkv_kernel_tfd15
k1_qkv_kernel_tfB16:
    v_add_u32 v7, 0, v16
    v_and_b32 v7, 15, v7
    v_lshl_add_u32 v7, v7, 4, v17
    ds_read_b64_tr_b16 v[20:21], v7 offset:0
    ds_read_b64_tr_b16 v[22:23], v7 offset:1024
    v_add_u32 v7, 2, v16
    v_and_b32 v7, 15, v7
    v_lshl_add_u32 v7, v7, 4, v17
    ds_read_b64_tr_b16 v[24:25], v7 offset:0
    ds_read_b64_tr_b16 v[26:27], v7 offset:1024
    v_add_u32 v7, 4, v16
    v_and_b32 v7, 15, v7
    v_lshl_add_u32 v7, v7, 4, v17
    ds_read_b64_tr_b16 v[28:29], v7 offset:0
    ds_read_b64_tr_b16 v[30:31], v7 offset:1024
    v_add_u32 v7, 6, v16
    v_and_b32 v7, 15, v7
    v_lshl_add_u32 v7, v7, 4, v17
    ds_read_b64_tr_b16 v[32:33], v7 offset:0
    ds_read_b64_tr_b16 v[34:35], v7 offset:1024
    v_add_u32 v7, 8, v16
    v_and_b32 v7, 15, v7
    v_lshl_add_u32 v7, v7, 4, v17
    ds_read_b64_tr_b16 v[36:37], v7 offset:0
    ds_read_b64_tr_b16 v[38:39], v7 offset:1024
    v_add_u32 v7, 10, v16
    v_and_b32 v7, 15, v7
    v_lshl_add_u32 v7, v7, 4, v17
    ds_read_b64_tr_b16 v[40:41], v7 offset:0
    ds_read_b64_tr_b16 v[42:43], v7 offset:1024
    s_waitcnt lgkmcnt(0)
    buffer_store_dwordx4 v[20:23], v5, s[52:55], s56 offen offset:0 sc1
    buffer_store_dwordx4 v[24:27], v5, s[52:55], s56 offen offset:1024 sc1
    buffer_store_dwordx4 v[28:31], v5, s[52:55], s56 offen offset:2048 sc1
    buffer_store_dwordx4 v[32:35], v5, s[52:55], s56 offen offset:3072 sc1
    s_add_u32 s3, s56, 4096
    buffer_store_dwordx4 v[36:39], v5, s[52:55], s3 offen offset:0 sc1
    buffer_store_dwordx4 v[40:43], v5, s[52:55], s3 offen offset:1024 sc1
    s_branch k1_qkv_kernel_tfd15
k1_qkv_kernel_tfz17:
    v_mov_b32 v7, 0x7f000000
    buffer_store_dword v7, v7, s[52:55], 0 offen
    buffer_store_dword v7, v7, s[52:55], 0 offen
    buffer_store_dword v7, v7, s[52:55], 0 offen
    buffer_store_dword v7, v7, s[52:55], 0 offen
    buffer_store_dword v7, v7, s[52:55], 0 offen
    buffer_store_dword v7, v7, s[52:55], 0 offen
k1_qkv_kernel_tfd15:
    s_waitcnt vmcnt(14)
    s_barrier
    s_waitcnt vmcnt(6)
    s_barrier
    s_barrier
    s_branch k1_qkv_kernel_p1end6
k1_qkv_kernel_spare5l:
    s_waitcnt lgkmcnt(0)
    s_lshl_b32 s59, s30, 4
    s_add_u32 s59, s59, s31
    s_lshl_b32 s59, s59, 2
    s_add_u32 s59, s59, s29
    s_lshl_b32 s63, s29, 13
    s_add_u32 s63, s63, 131072
    s_mov_b32 s57, 0
    s_add_u32 s52, s24, 28311552
    s_addc_u32 s53, s25, 0
    s_and_b32 s53, s53, 0xffff
    s_mov_b32 s54, 1966080
    s_mov_b32 s55, 0x20000
    s_mov_b32 s56, 0
    v_mov_b32 v16, 0
    v_mov_b32 v17, 0
    s_cmp_ge_u32 s59, 864
    s_cbranch_scc1 k1_qkv_kernel_tdone18
    s_cmp_ge_u32 s59, 544
    s_cbranch_scc1 k1_qkv_kernel_tB19
    s_mov_b32 s57, 1
    s_cmp_ge_u32 s59, 160
    s_cbranch_scc1 k1_qkv_kernel_tw220
    s_and_b32 s60, s59, 7
    s_lshr_b32 s61, s59, 3
    s_mov_b32 s64, s8
    s_and_b32 s65, s9, 0xffff
    s_mov_b32 s66, 819200
    s_mov_b32 s67, 0x20000
    s_add_u32 s52, s24, 25165824
    s_addc_u32 s53, s25, 0
    s_and_b32 s53, s53, 0xffff
    s_mov_b32 s54, 819200
    s_mov_b32 s55, 0x20000
    s_mul_i32 s56, s60, 102400
    s_branch k1_qkv_kernel_tA21
k1_qkv_kernel_tw220:
    s_sub_u32 s59, s59, 160
    s_and_b32 s60, s59, 7
    s_lshr_b32 s61, s59, 3
    s_mov_b32 s64, s16
    s_and_b32 s65, s17, 0xffff
    s_mov_b32 s66, 1966080
    s_mov_b32 s67, 0x20000
    s_mul_i32 s56, s60, 245760
k1_qkv_kernel_tA21:
    s_mul_i32 s3, s61, 5120
    s_add_u32 s56, s56, s3
    s_mul_i32 s62, s61, 40960
    s_mul_i32 s3, s60, 160
    s_add_u32 s62, s62, s3
    v_add_u32 v5, 0, v2
    v_mul_u32_u24 v6, 6554, v5
    v_lshrrev_b32 v6, 16, v6
    v_mul_u32_u24 v7, 10, v6
    v_sub_u32 v5, v5, v7
    v_and_b32 v7, 0x13, v6
    v_and_b32 v164, 4, v6
    v_lshl_or_b32 v7, v164, 1, v7
    v_and_b32 v164, 8, v6
    v_lshrrev_b32 v164, 1, v164
    v_or_b32 v7, v7, v164
    v_mul_u32_u24 v7, 1280, v7
    v_lshl_add_u32 v164, v5, 4, v7
    s_add_u32 m0, s63, 0
    s_nop 0
    buffer_load_dwordx4 v164, s[64:67], s62 offen lds
    v_add_u32 v5, 64, v2
    v_mul_u32_u24 v6, 6554, v5
    v_lshrrev_b32 v6, 16, v6
    v_mul_u32_u24 v7, 10, v6
    v_sub_u32 v5, v5, v7
    v_and_b32 v7, 0x13, v6
    v_and_b32 v164, 4, v6
    v_lshl_or_b32 v7, v164, 1, v7
    v_and_b32 v164, 8, v6
    v_lshrrev_b32 v164, 1, v164
    v_or_b32 v7, v7, v164
    v_mul_u32_u24 v7, 1280, v7
    v_lshl_add_u32 v164, v5, 4, v7
    s_add_u32 m0, s63, 1024
    s_nop 0
    buffer_load_dwordx4 v164, s[64:67], s62 offen lds
    v_add_u32 v5, 128, v2
    v_mul_u32_u24 v6, 6554, v5
    v_lshrrev_b32 v6, 16, v6
    v_mul_u32_u24 v7, 10, v6
    v_sub_u32 v5, v5, v7
    v_and_b32 v7, 0x13, v6
    v_and_b32 v164, 4, v6
    v_lshl_or_b32 v7, v164, 1, v7
    v_and_b32 v164, 8, v6
    v_lshrrev_b32 v164, 1, v164
    v_or_b32 v7, v7, v164
    v_mul_u32_u24 v7, 1280, v7
    v_lshl_add_u32 v164, v5, 4, v7
    s_add_u32 m0, s63, 2048
    s_nop 0
    buffer_load_dwordx4 v164, s[64:67], s62 offen lds
    v_add_u32 v5, 192, v2
    v_mul_u32_u24 v6, 6554, v5
    v_lshrrev_b32 v6, 16, v6
    v_mul_u32_u24 v7, 10, v6
    v_sub_u32 v5, v5, v7
    v_and_b32 v7, 0x13, v6
    v_and_b32 v164, 4, v6
    v_lshl_or_b32 v7, v164, 1, v7
    v_and_b32 v164, 8, v6
    v_lshrrev_b32 v164, 1, v164
    v_or_b32 v7, v7, v164
    v_mul_u32_u24 v7, 1280, v7
    v_lshl_add_u32 v164, v5, 4, v7
    s_add_u32 m0, s63, 3072
    s_nop 0
    buffer_load_dwordx4 v164, s[64:67], s62 offen lds
    v_add_u32 v5, 256, v2
    v_mul_u32_u24 v6, 6554, v5
    v_lshrrev_b32 v6, 16, v6
    v_mul_u32_u24 v7, 10, v6
    v_sub_u32 v5, v5, v7
    v_and_b32 v7, 0x13, v6
    v_and_b32 v164, 4, v6
    v_lshl_or_b32 v7, v164, 1, v7
    v_and_b32 v164, 8, v6
    v_lshrrev_b32 v164, 1, v164
    v_or_b32 v7, v7, v164
    v_mul_u32_u24 v7, 1280, v7
    v_lshl_add_u32 v164, v5, 4, v7
    s_add_u32 m0, s63, 4096
    s_nop 0
    buffer_load_dwordx4 v164, s[64:67], s62 offen lds
    v_lshrrev_b32 v5, 1, v4
    v_lshlrev_b32 v5, 4, v5
    v_and_b32 v6, 1, v4
    v_lshl_add_u32 v5, v6, 2, v5
    v_lshrrev_b32 v6, 2, v3
    v_add_u32 v5, v5, v6
    v_mul_u32_u24 v5, 160, v5
    v_and_b32 v6, 3, v2
    v_lshlrev_b32 v6, 3, v6
    v_add3_u32 v16, v5, v6, s63
    s_branch k1_qkv_kernel_tdone18
k1_qkv_kernel_tB19:
    s_mov_b32 s57, 2
    s_sub_u32 s59, s59, 544
    s_and_b32 s60, s59, 15
    s_lshr_b32 s61, s59, 4
    s_mov_b32 s64, s12
    s_and_b32 s65, s13, 0xffff
    s_mov_b32 s66, 1966080
    s_mov_b32 s67, 0x20000
    s_add_u32 s52, s24, 26214400
    s_addc_u32 s53, s25, 0
    s_and_b32 s53, s53, 0xffff
    s_mov_b32 s54, 1966080
    s_mov_b32 s55, 0x20000
    s_mul_i32 s56, s60, 122880
    s_mul_i32 s3, s61, 6144
    s_add_u32 s56, s56, s3
    s_mul_i32 s62, s61, 98304
    s_mul_i32 s3, s60, 192
    s_add_u32 s62, s62, s3
    v_mul_u32_u24 v6, 3072, v4
    v_lshlrev_b32 v5, 1, v4
    v_sub_u32 v5, v3, v5
    v_subrev_u32 v5, 0, v5
    v_and_b32 v5, 15, v5
    v_lshl_add_u32 v164, v5, 4, v6
    v_add_u32 v164, 0, v164
    v_cmp_lt_u32 vcc, 11, v5
    v_mov_b32 v7, 0x7f000000
    s_add_u32 m0, s63, 0
    v_cndmask_b32 v164, v164, v7, vcc
    buffer_load_dwordx4 v164, s[64:67], s62 offen lds
    v_lshlrev_b32 v5, 1, v4
    v_sub_u32 v5, v3, v5
    v_subrev_u32 v5, 0, v5
    v_and_b32 v5, 15, v5
    v_lshl_add_u32 v164, v5, 4, v6
    v_add_u32 v164, 12288, v164
    v_cmp_lt_u32 vcc, 11, v5
    v_mov_b32 v7, 0x7f000000
    s_add_u32 m0, s63, 1024
    v_cndmask_b32 v164, v164, v7, vcc
    buffer_load_dwordx4 v164, s[64:67], s62 offen lds
    v_lshlrev_b32 v5, 1, v4
    v_sub_u32 v5, v3, v5
    v_subrev_u32 v5, 8, v5
    v_and_b32 v5, 15, v5
    v_lshl_add_u32 v164, v5, 4, v6
    v_add_u32 v164, 24576, v164
    v_cmp_lt_u32 vcc, 11, v5
    v_mov_b32 v7, 0x7f000000
    s_add_u32 m0, s63, 2048
    v_cndmask_b32 v164, v164, v7, vcc
    buffer_load_dwordx4 v164, s[64:67], s62 offen lds
    v_lshlrev_b32 v5, 1, v4
    v_sub_u32 v5, v3, v5
    v_subrev_u32 v5, 8, v5
    v_and_b32 v5, 15, v5
    v_lshl_add_u32 v164, v5, 4, v6
    v_add_u32 v164, 36864, v164
    v_cmp_lt_u32 vcc, 11, v5
    v_mov_b32 v7, 0x7f000000
    s_add_u32 m0, s63, 3072
    v_cndmask_b32 v164, v164, v7, vcc
    buffer_load_dwordx4 v164, s[64:67], s62 offen lds
    v_lshlrev_b32 v5, 1, v4
    v_sub_u32 v5, v3, v5
    v_subrev_u32 v5, 0, v5
    v_and_b32 v5, 15, v5
    v_lshl_add_u32 v164, v5, 4, v6
    v_add_u32 v164, 49152, v164
    v_cmp_lt_u32 vcc, 11, v5
    v_mov_b32 v7, 0x7f000000
    s_add_u32 m0, s63, 4096
    v_cndmask_b32 v164, v164, v7, vcc
    buffer_load_dwordx4 v164, s[64:67], s62 offen lds
    v_lshlrev_b32 v5, 1, v4
    v_sub_u32 v5, v3, v5
    v_subrev_u32 v5, 0, v5
    v_and_b32 v5, 15, v5
    v_lshl_add_u32 v164, v5, 4, v6
    v_add_u32 v164, 61440, v164
    v_cmp_lt_u32 vcc, 11, v5
    v_mov_b32 v7, 0x7f000000
    s_add_u32 m0, s63, 5120
    v_cndmask_b32 v164, v164, v7, vcc
    buffer_load_dwordx4 v164, s[64:67], s62 offen lds
    v_lshlrev_b32 v5, 1, v4
    v_sub_u32 v5, v3, v5
    v_subrev_u32 v5, 8, v5
    v_and_b32 v5, 15, v5
    v_lshl_add_u32 v164, v5, 4, v6
    v_add_u32 v164, 73728, v164
    v_cmp_lt_u32 vcc, 11, v5
    v_mov_b32 v7, 0x7f000000
    s_add_u32 m0, s63, 6144
    v_cndmask_b32 v164, v164, v7, vcc
    buffer_load_dwordx4 v164, s[64:67], s62 offen lds
    v_lshlrev_b32 v5, 1, v4
    v_sub_u32 v5, v3, v5
    v_subrev_u32 v5, 8, v5
    v_and_b32 v5, 15, v5
    v_lshl_add_u32 v164, v5, 4, v6
    v_add_u32 v164, 86016, v164
    v_cmp_lt_u32 vcc, 11, v5
    v_mov_b32 v7, 0x7f000000
    s_add_u32 m0, s63, 7168
    v_cndmask_b32 v164, v164, v7, vcc
    buffer_load_dwordx4 v164, s[64:67], s62 offen lds
    v_lshrrev_b32 v7, 2, v3
    v_and_b32 v5, 1, v4
    v_lshl_add_u32 v5, v5, 2, v7
    v_lshlrev_b32 v5, 1, v5
    v_lshl_add_u32 v6, v4, 3, v7
    v_lshlrev_b32 v6, 8, v6
    v_and_b32 v7, 3, v2
    v_lshrrev_b32 v164, 1, v7
    v_add_u32 v16, v5, v164
    v_and_b32 v7, 1, v7
    v_lshl_add_u32 v6, v7, 3, v6
    v_add_u32 v17, s63, v6
k1_qkv_kernel_tdone18:
    s_waitcnt vmcnt(0)
    s_cmp_eq_u32 s57, 0
    s_cbranch_scc1 k1_qkv_kernel_tfd23
    v_lshlrev_b32 v5, 4, v2
    s_cmp_eq_u32 s57, 2
    s_cbranch_scc1 k1_qkv_kernel_tfB24
    ds_read_b64_tr_b16 v[20:21], v16 offset:0
    ds_read_b64_tr_b16 v[22:23], v16 offset:1280
    ds_read_b64_tr_b16 v[24:25], v16 offset:32
    ds_read_b64_tr_b16 v[26:27], v16 offset:1312
    ds_read_b64_tr_b16 v[28:29], v16 offset:64
    ds_read_b64_tr_b16 v[30:31], v16 offset:1344
    ds_read_b64_tr_b16 v[32:33], v16 offset:96
    ds_read_b64_tr_b16 v[34:35], v16 offset:1376
    ds_read_b64_tr_b16 v[36:37], v16 offset:128
    ds_read_b64_tr_b16 v[38:39], v16 offset:1408
    s_waitcnt lgkmcnt(0)
    buffer_store_dwordx4 v[20:23], v5, s[52:55], s56 offen offset:0 sc1
    buffer_store_dwordx4 v[24:27], v5, s[52:55], s56 offen offset:1024 sc1
    buffer_store_dwordx4 v[28:31], v5, s[52:55], s56 offen offset:2048 sc1
    buffer_store_dwordx4 v[32:35], v5, s[52:55], s56 offen offset:3072 sc1
    s_add_u32 s3, s56, 4096
    buffer_store_dwordx4 v[36:39], v5, s[52:55], s3 offen sc1
    s_branch k1_qkv_kernel_tfd23
k1_qkv_kernel_tfB24:
    v_add_u32 v7, 0, v16
    v_and_b32 v7, 15, v7
    v_lshl_add_u32 v7, v7, 4, v17
    ds_read_b64_tr_b16 v[20:21], v7 offset:0
    ds_read_b64_tr_b16 v[22:23], v7 offset:1024
    v_add_u32 v7, 2, v16
    v_and_b32 v7, 15, v7
    v_lshl_add_u32 v7, v7, 4, v17
    ds_read_b64_tr_b16 v[24:25], v7 offset:0
    ds_read_b64_tr_b16 v[26:27], v7 offset:1024
    v_add_u32 v7, 4, v16
    v_and_b32 v7, 15, v7
    v_lshl_add_u32 v7, v7, 4, v17
    ds_read_b64_tr_b16 v[28:29], v7 offset:0
    ds_read_b64_tr_b16 v[30:31], v7 offset:1024
    v_add_u32 v7, 6, v16
    v_and_b32 v7, 15, v7
    v_lshl_add_u32 v7, v7, 4, v17
    ds_read_b64_tr_b16 v[32:33], v7 offset:0
    ds_read_b64_tr_b16 v[34:35], v7 offset:1024
    v_add_u32 v7, 8, v16
    v_and_b32 v7, 15, v7
    v_lshl_add_u32 v7, v7, 4, v17
    ds_read_b64_tr_b16 v[36:37], v7 offset:0
    ds_read_b64_tr_b16 v[38:39], v7 offset:1024
    v_add_u32 v7, 10, v16
    v_and_b32 v7, 15, v7
    v_lshl_add_u32 v7, v7, 4, v17
    ds_read_b64_tr_b16 v[40:41], v7 offset:0
    ds_read_b64_tr_b16 v[42:43], v7 offset:1024
    s_waitcnt lgkmcnt(0)
    buffer_store_dwordx4 v[20:23], v5, s[52:55], s56 offen offset:0 sc1
    buffer_store_dwordx4 v[24:27], v5, s[52:55], s56 offen offset:1024 sc1
    buffer_store_dwordx4 v[28:31], v5, s[52:55], s56 offen offset:2048 sc1
    buffer_store_dwordx4 v[32:35], v5, s[52:55], s56 offen offset:3072 sc1
    s_add_u32 s3, s56, 4096
    buffer_store_dwordx4 v[36:39], v5, s[52:55], s3 offen offset:0 sc1
    buffer_store_dwordx4 v[40:43], v5, s[52:55], s3 offen offset:1024 sc1
k1_qkv_kernel_tfd23:
    s_branch k1_qkv_kernel_p1end6
k1_qkv_kernel_statw9:
    s_cmp_eq_u32 s31, 15
    s_cbranch_scc1 k1_qkv_kernel_p1end6
    v_lshrrev_b32 v5, 1, v2
    v_and_b32 v6, 1, v2
    v_lshlrev_b32 v46, 7, v5
    v_lshl_add_u32 v46, v6, 6, v46
    s_lshl_b32 s3, s29, 12
    v_add_u32 v46, s3, v46
    v_and_b32 v47, 3, v5
    v_mov_b32 v44, 0
    v_mov_b32 v45, 0
    s_barrier
    v_add_u32 v64, 0, v47
    v_and_b32 v64, 3, v64
    v_lshl_add_u32 v64, v64, 4, v46
    ds_read_b128 v[48:51], v64 offset:0
    v_add_u32 v64, 1, v47
    v_and_b32 v64, 3, v64
    v_lshl_add_u32 v64, v64, 4, v46
    ds_read_b128 v[52:55], v64 offset:0
    v_add_u32 v64, 2, v47
    v_and_b32 v64, 3, v64
    v_lshl_add_u32 v64, v64, 4, v46
    ds_read_b128 v[56:59], v64 offset:0
    v_add_u32 v64, 3, v47
    v_and_b32 v64, 3, v64
    v_lshl_add_u32 v64, v64, 4, v46
    ds_read_b128 v[60:63], v64 offset:0
    s_waitcnt lgkmcnt(0)
    v_lshlrev_b32 v64, 16, v48
    v_and_b32 v65, 0xffff0000, v48
    v_add_f32 v44, v44, v64
    v_fmac_f32 v45, v64, v64
    v_add_f32 v44, v44, v65
    v_fmac_f32 v45, v65, v65
    v_lshlrev_b32 v64, 16, v49
    v_and_b32 v65, 0xffff0000, v49
    v_add_f32 v44, v44, v64
    v_fmac_f32 v45, v64, v64
    v_add_f32 v44, v44, v65
    v_fmac_f32 v45, v65, v65
    v_lshlrev_b32 v64, 16, v50
    v_and_b32 v65, 0xffff0000, v50
    v_add_f32 v44, v44, v64
    v_fmac_f32 v45, v64, v64
    v_add_f32 v44, v44, v65
    v_fmac_f32 v45, v65, v65
    v_lshlrev_b32 v64, 16, v51
    v_and_b32 v65, 0xffff0000, v51
    v_add_f32 v44, v44, v64
    v_fmac_f32 v45, v64, v64
    v_add_f32 v44, v44, v65
    v_fmac_f32 v45, v65, v65
    v_lshlrev_b32 v64, 16, v52
    v_and_b32 v65, 0xffff0000, v52
    v_add_f32 v44, v44, v64
    v_fmac_f32 v45, v64, v64
    v_add_f32 v44, v44, v65
    v_fmac_f32 v45, v65, v65
    v_lshlrev_b32 v64, 16, v53
    v_and_b32 v65, 0xffff0000, v53
    v_add_f32 v44, v44, v64
    v_fmac_f32 v45, v64, v64
    v_add_f32 v44, v44, v65
    v_fmac_f32 v45, v65, v65
    v_lshlrev_b32 v64, 16, v54
    v_and_b32 v65, 0xffff0000, v54
    v_add_f32 v44, v44, v64
    v_fmac_f32 v45, v64, v64
    v_add_f32 v44, v44, v65
    v_fmac_f32 v45, v65, v65
    v_lshlrev_b32 v64, 16, v55
    v_and_b32 v65, 0xffff0000, v55
    v_add_f32 v44, v44, v64
    v_fmac_f32 v45, v64, v64
    v_add_f32 v44, v44, v65
    v_fmac_f32 v45, v65, v65
    v_lshlrev_b32 v64, 16, v56
    v_and_b32 v65, 0xffff0000, v56
    v_add_f32 v44, v44, v64
    v_fmac_f32 v45, v64, v64
    v_add_f32 v44, v44, v65
    v_fmac_f32 v45, v65, v65
    v_lshlrev_b32 v64, 16, v57
    v_and_b32 v65, 0xffff0000, v57
    v_add_f32 v44, v44, v64
    v_fmac_f32 v45, v64, v64
    v_add_f32 v44, v44, v65
    v_fmac_f32 v45, v65, v65
    v_lshlrev_b32 v64, 16, v58
    v_and_b32 v65, 0xffff0000, v58
    v_add_f32 v44, v44, v64
    v_fmac_f32 v45, v64, v64
    v_add_f32 v44, v44, v65
    v_fmac_f32 v45, v65, v65
    v_lshlrev_b32 v64, 16, v59
    v_and_b32 v65, 0xffff0000, v59
    v_add_f32 v44, v44, v64
    v_fmac_f32 v45, v64, v64
    v_add_f32 v44, v44, v65
    v_fmac_f32 v45, v65, v65
    v_lshlrev_b32 v64, 16, v60
    v_and_b32 v65, 0xffff0000, v60
    v_add_f32 v44, v44, v64
    v_fmac_f32 v45, v64, v64
    v_add_f32 v44, v44, v65
    v_fmac_f32 v45, v65, v65
    v_lshlrev_b32 v64, 16, v61
    v_and_b32 v65, 0xffff0000, v61
    v_add_f32 v44, v44, v64
    v_fmac_f32 v45, v64, v64
    v_add_f32 v44, v44, v65
    v_fmac_f32 v45, v65, v65
    v_lshlrev_b32 v64, 16, v62
    v_and_b32 v65, 0xffff0000, v62
    v_add_f32 v44, v44, v64
    v_fmac_f32 v45, v64, v64
    v_add_f32 v44, v44, v65
    v_fmac_f32 v45, v65, v65
    v_lshlrev_b32 v64, 16, v63
    v_and_b32 v65, 0xffff0000, v63
    v_add_f32 v44, v44, v64
    v_fmac_f32 v45, v64, v64
    v_add_f32 v44, v44, v65
    v_fmac_f32 v45, v65, v65
    s_barrier
    v_add_u32 v64, 0, v47
    v_and_b32 v64, 3, v64
    v_lshl_add_u32 v64, v64, 4, v46
    ds_read_b128 v[48:51], v64 offset:32768
    v_add_u32 v64, 1, v47
    v_and_b32 v64, 3, v64
    v_lshl_add_u32 v64, v64, 4, v46
    ds_read_b128 v[52:55], v64 offset:32768
    v_add_u32 v64, 2, v47
    v_and_b32 v64, 3, v64
    v_lshl_add_u32 v64, v64, 4, v46
    ds_read_b128 v[56:59], v64 offset:32768
    v_add_u32 v64, 3, v47
    v_and_b32 v64, 3, v64
    v_lshl_add_u32 v64, v64, 4, v46
    ds_read_b128 v[60:63], v64 offset:32768
    s_waitcnt lgkmcnt(0)
    v_lshlrev_b32 v64, 16, v48
    v_and_b32 v65, 0xffff0000, v48
    v_add_f32 v44, v44, v64
    v_fmac_f32 v45, v64, v64
    v_add_f32 v44, v44, v65
    v_fmac_f32 v45, v65, v65
    v_lshlrev_b32 v64, 16, v49
    v_and_b32 v65, 0xffff0000, v49
    v_add_f32 v44, v44, v64
    v_fmac_f32 v45, v64, v64
    v_add_f32 v44, v44, v65
    v_fmac_f32 v45, v65, v65
    v_lshlrev_b32 v64, 16, v50
    v_and_b32 v65, 0xffff0000, v50
    v_add_f32 v44, v44, v64
    v_fmac_f32 v45, v64, v64
    v_add_f32 v44, v44, v65
    v_fmac_f32 v45, v65, v65
    v_lshlrev_b32 v64, 16, v51
    v_and_b32 v65, 0xffff0000, v51
    v_add_f32 v44, v44, v64
    v_fmac_f32 v45, v64, v64
    v_add_f32 v44, v44, v65
    v_fmac_f32 v45, v65, v65
    v_lshlrev_b32 v64, 16, v52
    v_and_b32 v65, 0xffff0000, v52
    v_add_f32 v44, v44, v64
    v_fmac_f32 v45, v64, v64
    v_add_f32 v44, v44, v65
    v_fmac_f32 v45, v65, v65
    v_lshlrev_b32 v64, 16, v53
    v_and_b32 v65, 0xffff0000, v53
    v_add_f32 v44, v44, v64
    v_fmac_f32 v45, v64, v64
    v_add_f32 v44, v44, v65
    v_fmac_f32 v45, v65, v65
    v_lshlrev_b32 v64, 16, v54
    v_and_b32 v65, 0xffff0000, v54
    v_add_f32 v44, v44, v64
    v_fmac_f32 v45, v64, v64
    v_add_f32 v44, v44, v65
    v_fmac_f32 v45, v65, v65
    v_lshlrev_b32 v64, 16, v55
    v_and_b32 v65, 0xffff0000, v55
    v_add_f32 v44, v44, v64
    v_fmac_f32 v45, v64, v64
    v_add_f32 v44, v44, v65
    v_fmac_f32 v45, v65, v65
    v_lshlrev_b32 v64, 16, v56
    v_and_b32 v65, 0xffff0000, v56
    v_add_f32 v44, v44, v64
    v_fmac_f32 v45, v64, v64
    v_add_f32 v44, v44, v65
    v_fmac_f32 v45, v65, v65
    v_lshlrev_b32 v64, 16, v57
    v_and_b32 v65, 0xffff0000, v57
    v_add_f32 v44, v44, v64
    v_fmac_f32 v45, v64, v64
    v_add_f32 v44, v44, v65
    v_fmac_f32 v45, v65, v65
    v_lshlrev_b32 v64, 16, v58
    v_and_b32 v65, 0xffff0000, v58
    v_add_f32 v44, v44, v64
    v_fmac_f32 v45, v64, v64
    v_add_f32 v44, v44, v65
    v_fmac_f32 v45, v65, v65
    v_lshlrev_b32 v64, 16, v59
    v_and_b32 v65, 0xffff0000, v59
    v_add_f32 v44, v44, v64
    v_fmac_f32 v45, v64, v64
    v_add_f32 v44, v44, v65
    v_fmac_f32 v45, v65, v65
    v_lshlrev_b32 v64, 16, v60
    v_and_b32 v65, 0xffff0000, v60
    v_add_f32 v44, v44, v64
    v_fmac_f32 v45, v64, v64
    v_add_f32 v44, v44, v65
    v_fmac_f32 v45, v65, v65
    v_lshlrev_b32 v64, 16, v61
    v_and_b32 v65, 0xffff0000, v61
    v_add_f32 v44, v44, v64
    v_fmac_f32 v45, v64, v64
    v_add_f32 v44, v44, v65
    v_fmac_f32 v45, v65, v65
    v_lshlrev_b32 v64, 16, v62
    v_and_b32 v65, 0xffff0000, v62
    v_add_f32 v44, v44, v64
    v_fmac_f32 v45, v64, v64
    v_add_f32 v44, v44, v65
    v_fmac_f32 v45, v65, v65
    v_lshlrev_b32 v64, 16, v63
    v_and_b32 v65, 0xffff0000, v63
    v_add_f32 v44, v44, v64
    v_fmac_f32 v45, v64, v64
    v_add_f32 v44, v44, v65
    v_fmac_f32 v45, v65, v65
    s_barrier
    v_add_u32 v64, 0, v47
    v_and_b32 v64, 3, v64
    v_lshl_add_u32 v64, v64, 4, v46
    v_add_u32 v64, 65536, v64
    ds_read_b128 v[48:51], v64
    v_add_u32 v64, 1, v47
    v_and_b32 v64, 3, v64
    v_lshl_add_u32 v64, v64, 4, v46
    v_add_u32 v64, 65536, v64
    ds_read_b128 v[52:55], v64
    v_add_u32 v64, 2, v47
    v_and_b32 v64, 3, v64
    v_lshl_add_u32 v64, v64, 4, v46
    v_add_u32 v64, 65536, v64
    ds_read_b128 v[56:59], v64
    v_add_u32 v64, 3, v47
    v_and_b32 v64, 3, v64
    v_lshl_add_u32 v64, v64, 4, v46
    v_add_u32 v64, 65536, v64
    ds_read_b128 v[60:63], v64
    s_waitcnt lgkmcnt(0)
    v_lshlrev_b32 v64, 16, v48
    v_and_b32 v65, 0xffff0000, v48
    v_add_f32 v44, v44, v64
    v_fmac_f32 v45, v64, v64
    v_add_f32 v44, v44, v65
    v_fmac_f32 v45, v65, v65
    v_lshlrev_b32 v64, 16, v49
    v_and_b32 v65, 0xffff0000, v49
    v_add_f32 v44, v44, v64
    v_fmac_f32 v45, v64, v64
    v_add_f32 v44, v44, v65
    v_fmac_f32 v45, v65, v65
    v_lshlrev_b32 v64, 16, v50
    v_and_b32 v65, 0xffff0000, v50
    v_add_f32 v44, v44, v64
    v_fmac_f32 v45, v64, v64
    v_add_f32 v44, v44, v65
    v_fmac_f32 v45, v65, v65
    v_lshlrev_b32 v64, 16, v51
    v_and_b32 v65, 0xffff0000, v51
    v_add_f32 v44, v44, v64
    v_fmac_f32 v45, v64, v64
    v_add_f32 v44, v44, v65
    v_fmac_f32 v45, v65, v65
    v_lshlrev_b32 v64, 16, v52
    v_and_b32 v65, 0xffff0000, v52
    v_add_f32 v44, v44, v64
    v_fmac_f32 v45, v64, v64
    v_add_f32 v44, v44, v65
    v_fmac_f32 v45, v65, v65
    v_lshlrev_b32 v64, 16, v53
    v_and_b32 v65, 0xffff0000, v53
    v_add_f32 v44, v44, v64
    v_fmac_f32 v45, v64, v64
    v_add_f32 v44, v44, v65
    v_fmac_f32 v45, v65, v65
    v_lshlrev_b32 v64, 16, v54
    v_and_b32 v65, 0xffff0000, v54
    v_add_f32 v44, v44, v64
    v_fmac_f32 v45, v64, v64
    v_add_f32 v44, v44, v65
    v_fmac_f32 v45, v65, v65
    v_lshlrev_b32 v64, 16, v55
    v_and_b32 v65, 0xffff0000, v55
    v_add_f32 v44, v44, v64
    v_fmac_f32 v45, v64, v64
    v_add_f32 v44, v44, v65
    v_fmac_f32 v45, v65, v65
    v_lshlrev_b32 v64, 16, v56
    v_and_b32 v65, 0xffff0000, v56
    v_add_f32 v44, v44, v64
    v_fmac_f32 v45, v64, v64
    v_add_f32 v44, v44, v65
    v_fmac_f32 v45, v65, v65
    v_lshlrev_b32 v64, 16, v57
    v_and_b32 v65, 0xffff0000, v57
    v_add_f32 v44, v44, v64
    v_fmac_f32 v45, v64, v64
    v_add_f32 v44, v44, v65
    v_fmac_f32 v45, v65, v65
    v_lshlrev_b32 v64, 16, v58
    v_and_b32 v65, 0xffff0000, v58
    v_add_f32 v44, v44, v64
    v_fmac_f32 v45, v64, v64
    v_add_f32 v44, v44, v65
    v_fmac_f32 v45, v65, v65
    v_lshlrev_b32 v64, 16, v59
    v_and_b32 v65, 0xffff0000, v59
    v_add_f32 v44, v44, v64
    v_fmac_f32 v45, v64, v64
    v_add_f32 v44, v44, v65
    v_fmac_f32 v45, v65, v65
    v_lshlrev_b32 v64, 16, v60
    v_and_b32 v65, 0xffff0000, v60
    v_add_f32 v44, v44, v64
    v_fmac_f32 v45, v64, v64
    v_add_f32 v44, v44, v65
    v_fmac_f32 v45, v65, v65
    v_lshlrev_b32 v64, 16, v61
    v_and_b32 v65, 0xffff0000, v61
    v_add_f32 v44, v44, v64
    v_fmac_f32 v45, v64, v64
    v_add_f32 v44, v44, v65
    v_fmac_f32 v45, v65, v65
    v_lshlrev_b32 v64, 16, v62
    v_and_b32 v65, 0xffff0000, v62
    v_add_f32 v44, v44, v64
    v_fmac_f32 v45, v64, v64
    v_add_f32 v44, v44, v65
    v_fmac_f32 v45, v65, v65
    v_lshlrev_b32 v64, 16, v63
    v_and_b32 v65, 0xffff0000, v63
    v_add_f32 v44, v44, v64
    v_fmac_f32 v45, v64, v64
    v_add_f32 v44, v44, v65
    v_fmac_f32 v45, v65, v65
    s_barrier
    v_add_u32 v64, 0, v47
    v_and_b32 v64, 3, v64
    v_lshl_add_u32 v64, v64, 4, v46
    v_add_u32 v64, 98304, v64
    ds_read_b128 v[48:51], v64
    v_add_u32 v64, 1, v47
    v_and_b32 v64, 3, v64
    v_lshl_add_u32 v64, v64, 4, v46
    v_add_u32 v64, 98304, v64
    ds_read_b128 v[52:55], v64
    v_add_u32 v64, 2, v47
    v_and_b32 v64, 3, v64
    v_lshl_add_u32 v64, v64, 4, v46
    v_add_u32 v64, 98304, v64
    ds_read_b128 v[56:59], v64
    v_add_u32 v64, 3, v47
    v_and_b32 v64, 3, v64
    v_lshl_add_u32 v64, v64, 4, v46
    v_add_u32 v64, 98304, v64
    ds_read_b128 v[60:63], v64
    s_waitcnt lgkmcnt(0)
    v_lshlrev_b32 v64, 16, v48
    v_and_b32 v65, 0xffff0000, v48
    v_add_f32 v44, v44, v64
    v_fmac_f32 v45, v64, v64
    v_add_f32 v44, v44, v65
    v_fmac_f32 v45, v65, v65
    v_lshlrev_b32 v64, 16, v49
    v_and_b32 v65, 0xffff0000, v49
    v_add_f32 v44, v44, v64
    v_fmac_f32 v45, v64, v64
    v_add_f32 v44, v44, v65
    v_fmac_f32 v45, v65, v65
    v_lshlrev_b32 v64, 16, v50
    v_and_b32 v65, 0xffff0000, v50
    v_add_f32 v44, v44, v64
    v_fmac_f32 v45, v64, v64
    v_add_f32 v44, v44, v65
    v_fmac_f32 v45, v65, v65
    v_lshlrev_b32 v64, 16, v51
    v_and_b32 v65, 0xffff0000, v51
    v_add_f32 v44, v44, v64
    v_fmac_f32 v45, v64, v64
    v_add_f32 v44, v44, v65
    v_fmac_f32 v45, v65, v65
    v_lshlrev_b32 v64, 16, v52
    v_and_b32 v65, 0xffff0000, v52
    v_add_f32 v44, v44, v64
    v_fmac_f32 v45, v64, v64
    v_add_f32 v44, v44, v65
    v_fmac_f32 v45, v65, v65
    v_lshlrev_b32 v64, 16, v53
    v_and_b32 v65, 0xffff0000, v53
    v_add_f32 v44, v44, v64
    v_fmac_f32 v45, v64, v64
    v_add_f32 v44, v44, v65
    v_fmac_f32 v45, v65, v65
    v_lshlrev_b32 v64, 16, v54
    v_and_b32 v65, 0xffff0000, v54
    v_add_f32 v44, v44, v64
    v_fmac_f32 v45, v64, v64
    v_add_f32 v44, v44, v65
    v_fmac_f32 v45, v65, v65
    v_lshlrev_b32 v64, 16, v55
    v_and_b32 v65, 0xffff0000, v55
    v_add_f32 v44, v44, v64
    v_fmac_f32 v45, v64, v64
    v_add_f32 v44, v44, v65
    v_fmac_f32 v45, v65, v65
    v_lshlrev_b32 v64, 16, v56
    v_and_b32 v65, 0xffff0000, v56
    v_add_f32 v44, v44, v64
    v_fmac_f32 v45, v64, v64
    v_add_f32 v44, v44, v65
    v_fmac_f32 v45, v65, v65
    v_lshlrev_b32 v64, 16, v57
    v_and_b32 v65, 0xffff0000, v57
    v_add_f32 v44, v44, v64
    v_fmac_f32 v45, v64, v64
    v_add_f32 v44, v44, v65
    v_fmac_f32 v45, v65, v65
    v_lshlrev_b32 v64, 16, v58
    v_and_b32 v65, 0xffff0000, v58
    v_add_f32 v44, v44, v64
    v_fmac_f32 v45, v64, v64
    v_add_f32 v44, v44, v65
    v_fmac_f32 v45, v65, v65
    v_lshlrev_b32 v64, 16, v59
    v_and_b32 v65, 0xffff0000, v59
    v_add_f32 v44, v44, v64
    v_fmac_f32 v45, v64, v64
    v_add_f32 v44, v44, v65
    v_fmac_f32 v45, v65, v65
    v_lshlrev_b32 v64, 16, v60
    v_and_b32 v65, 0xffff0000, v60
    v_add_f32 v44, v44, v64
    v_fmac_f32 v45, v64, v64
    v_add_f32 v44, v44, v65
    v_fmac_f32 v45, v65, v65
    v_lshlrev_b32 v64, 16, v61
    v_and_b32 v65, 0xffff0000, v61
    v_add_f32 v44, v44, v64
    v_fmac_f32 v45, v64, v64
    v_add_f32 v44, v44, v65
    v_fmac_f32 v45, v65, v65
    v_lshlrev_b32 v64, 16, v62
    v_and_b32 v65, 0xffff0000, v62
    v_add_f32 v44, v44, v64
    v_fmac_f32 v45, v64, v64
    v_add_f32 v44, v44, v65
    v_fmac_f32 v45, v65, v65
    v_lshlrev_b32 v64, 16, v63
    v_and_b32 v65, 0xffff0000, v63
    v_add_f32 v44, v44, v64
    v_fmac_f32 v45, v64, v64
    v_add_f32 v44, v44, v65
    v_fmac_f32 v45, v65, v65
    s_barrier
    v_add_u32 v64, 0, v47
    v_and_b32 v64, 3, v64
    v_lshl_add_u32 v64, v64, 4, v46
    ds_read_b128 v[48:51], v64 offset:0
    v_add_u32 v64, 1, v47
    v_and_b32 v64, 3, v64
    v_lshl_add_u32 v64, v64, 4, v46
    ds_read_b128 v[52:55], v64 offset:0
    v_add_u32 v64, 2, v47
    v_and_b32 v64, 3, v64
    v_lshl_add_u32 v64, v64, 4, v46
    ds_read_b128 v[56:59], v64 offset:0
    v_add_u32 v64, 3, v47
    v_and_b32 v64, 3, v64
    v_lshl_add_u32 v64, v64, 4, v46
    ds_read_b128 v[60:63], v64 offset:0
    s_waitcnt lgkmcnt(0)
    v_lshlrev_b32 v64, 16, v48
    v_and_b32 v65, 0xffff0000, v48
    v_add_f32 v44, v44, v64
    v_fmac_f32 v45, v64, v64
    v_add_f32 v44, v44, v65
    v_fmac_f32 v45, v65, v65
    v_lshlrev_b32 v64, 16, v49
    v_and_b32 v65, 0xffff0000, v49
    v_add_f32 v44, v44, v64
    v_fmac_f32 v45, v64, v64
    v_add_f32 v44, v44, v65
    v_fmac_f32 v45, v65, v65
    v_lshlrev_b32 v64, 16, v50
    v_and_b32 v65, 0xffff0000, v50
    v_add_f32 v44, v44, v64
    v_fmac_f32 v45, v64, v64
    v_add_f32 v44, v44, v65
    v_fmac_f32 v45, v65, v65
    v_lshlrev_b32 v64, 16, v51
    v_and_b32 v65, 0xffff0000, v51
    v_add_f32 v44, v44, v64
    v_fmac_f32 v45, v64, v64
    v_add_f32 v44, v44, v65
    v_fmac_f32 v45, v65, v65
    v_lshlrev_b32 v64, 16, v52
    v_and_b32 v65, 0xffff0000, v52
    v_add_f32 v44, v44, v64
    v_fmac_f32 v45, v64, v64
    v_add_f32 v44, v44, v65
    v_fmac_f32 v45, v65, v65
    v_lshlrev_b32 v64, 16, v53
    v_and_b32 v65, 0xffff0000, v53
    v_add_f32 v44, v44, v64
    v_fmac_f32 v45, v64, v64
    v_add_f32 v44, v44, v65
    v_fmac_f32 v45, v65, v65
    v_lshlrev_b32 v64, 16, v54
    v_and_b32 v65, 0xffff0000, v54
    v_add_f32 v44, v44, v64
    v_fmac_f32 v45, v64, v64
    v_add_f32 v44, v44, v65
    v_fmac_f32 v45, v65, v65
    v_lshlrev_b32 v64, 16, v55
    v_and_b32 v65, 0xffff0000, v55
    v_add_f32 v44, v44, v64
    v_fmac_f32 v45, v64, v64
    v_add_f32 v44, v44, v65
    v_fmac_f32 v45, v65, v65
    v_lshlrev_b32 v64, 16, v56
    v_and_b32 v65, 0xffff0000, v56
    v_add_f32 v44, v44, v64
    v_fmac_f32 v45, v64, v64
    v_add_f32 v44, v44, v65
    v_fmac_f32 v45, v65, v65
    v_lshlrev_b32 v64, 16, v57
    v_and_b32 v65, 0xffff0000, v57
    v_add_f32 v44, v44, v64
    v_fmac_f32 v45, v64, v64
    v_add_f32 v44, v44, v65
    v_fmac_f32 v45, v65, v65
    v_lshlrev_b32 v64, 16, v58
    v_and_b32 v65, 0xffff0000, v58
    v_add_f32 v44, v44, v64
    v_fmac_f32 v45, v64, v64
    v_add_f32 v44, v44, v65
    v_fmac_f32 v45, v65, v65
    v_lshlrev_b32 v64, 16, v59
    v_and_b32 v65, 0xffff0000, v59
    v_add_f32 v44, v44, v64
    v_fmac_f32 v45, v64, v64
    v_add_f32 v44, v44, v65
    v_fmac_f32 v45, v65, v65
    v_lshlrev_b32 v64, 16, v60
    v_and_b32 v65, 0xffff0000, v60
    v_add_f32 v44, v44, v64
    v_fmac_f32 v45, v64, v64
    v_add_f32 v44, v44, v65
    v_fmac_f32 v45, v65, v65
    v_lshlrev_b32 v64, 16, v61
    v_and_b32 v65, 0xffff0000, v61
    v_add_f32 v44, v44, v64
    v_fmac_f32 v45, v64, v64
    v_add_f32 v44, v44, v65
    v_fmac_f32 v45, v65, v65
    v_lshlrev_b32 v64, 16, v62
    v_and_b32 v65, 0xffff0000, v62
    v_add_f32 v44, v44, v64
    v_fmac_f32 v45, v64, v64
    v_add_f32 v44, v44, v65
    v_fmac_f32 v45, v65, v65
    v_lshlrev_b32 v64, 16, v63
    v_and_b32 v65, 0xffff0000, v63
    v_add_f32 v44, v44, v64
    v_fmac_f32 v45, v64, v64
    v_add_f32 v44, v44, v65
    v_fmac_f32 v45, v65, v65
    s_barrier
    v_add_u32 v64, 0, v47
    v_and_b32 v64, 3, v64
    v_lshl_add_u32 v64, v64, 4, v46
    ds_read_b128 v[48:51], v64 offset:32768
    v_add_u32 v64, 1, v47
    v_and_b32 v64, 3, v64
    v_lshl_add_u32 v64, v64, 4, v46
    ds_read_b128 v[52:55], v64 offset:32768
    v_add_u32 v64, 2, v47
    v_and_b32 v64, 3, v64
    v_lshl_add_u32 v64, v64, 4, v46
    ds_read_b128 v[56:59], v64 offset:32768
    v_add_u32 v64, 3, v47
    v_and_b32 v64, 3, v64
    v_lshl_add_u32 v64, v64, 4, v46
    ds_read_b128 v[60:63], v64 offset:32768
    s_waitcnt lgkmcnt(0)
    v_lshlrev_b32 v64, 16, v48
    v_and_b32 v65, 0xffff0000, v48
    v_add_f32 v44, v44, v64
    v_fmac_f32 v45, v64, v64
    v_add_f32 v44, v44, v65
    v_fmac_f32 v45, v65, v65
    v_lshlrev_b32 v64, 16, v49
    v_and_b32 v65, 0xffff0000, v49
    v_add_f32 v44, v44, v64
    v_fmac_f32 v45, v64, v64
    v_add_f32 v44, v44, v65
    v_fmac_f32 v45, v65, v65
    v_lshlrev_b32 v64, 16, v50
    v_and_b32 v65, 0xffff0000, v50
    v_add_f32 v44, v44, v64
    v_fmac_f32 v45, v64, v64
    v_add_f32 v44, v44, v65
    v_fmac_f32 v45, v65, v65
    v_lshlrev_b32 v64, 16, v51
    v_and_b32 v65, 0xffff0000, v51
    v_add_f32 v44, v44, v64
    v_fmac_f32 v45, v64, v64
    v_add_f32 v44, v44, v65
    v_fmac_f32 v45, v65, v65
    v_lshlrev_b32 v64, 16, v52
    v_and_b32 v65, 0xffff0000, v52
    v_add_f32 v44, v44, v64
    v_fmac_f32 v45, v64, v64
    v_add_f32 v44, v44, v65
    v_fmac_f32 v45, v65, v65
    v_lshlrev_b32 v64, 16, v53
    v_and_b32 v65, 0xffff0000, v53
    v_add_f32 v44, v44, v64
    v_fmac_f32 v45, v64, v64
    v_add_f32 v44, v44, v65
    v_fmac_f32 v45, v65, v65
    v_lshlrev_b32 v64, 16, v54
    v_and_b32 v65, 0xffff0000, v54
    v_add_f32 v44, v44, v64
    v_fmac_f32 v45, v64, v64
    v_add_f32 v44, v44, v65
    v_fmac_f32 v45, v65, v65
    v_lshlrev_b32 v64, 16, v55
    v_and_b32 v65, 0xffff0000, v55
    v_add_f32 v44, v44, v64
    v_fmac_f32 v45, v64, v64
    v_add_f32 v44, v44, v65
    v_fmac_f32 v45, v65, v65
    v_lshlrev_b32 v64, 16, v56
    v_and_b32 v65, 0xffff0000, v56
    v_add_f32 v44, v44, v64
    v_fmac_f32 v45, v64, v64
    v_add_f32 v44, v44, v65
    v_fmac_f32 v45, v65, v65
    v_lshlrev_b32 v64, 16, v57
    v_and_b32 v65, 0xffff0000, v57
    v_add_f32 v44, v44, v64
    v_fmac_f32 v45, v64, v64
    v_add_f32 v44, v44, v65
    v_fmac_f32 v45, v65, v65
    v_lshlrev_b32 v64, 16, v58
    v_and_b32 v65, 0xffff0000, v58
    v_add_f32 v44, v44, v64
    v_fmac_f32 v45, v64, v64
    v_add_f32 v44, v44, v65
    v_fmac_f32 v45, v65, v65
    v_lshlrev_b32 v64, 16, v59
    v_and_b32 v65, 0xffff0000, v59
    v_add_f32 v44, v44, v64
    v_fmac_f32 v45, v64, v64
    v_add_f32 v44, v44, v65
    v_fmac_f32 v45, v65, v65
    v_lshlrev_b32 v64, 16, v60
    v_and_b32 v65, 0xffff0000, v60
    v_add_f32 v44, v44, v64
    v_fmac_f32 v45, v64, v64
    v_add_f32 v44, v44, v65
    v_fmac_f32 v45, v65, v65
    v_lshlrev_b32 v64, 16, v61
    v_and_b32 v65, 0xffff0000, v61
    v_add_f32 v44, v44, v64
    v_fmac_f32 v45, v64, v64
    v_add_f32 v44, v44, v65
    v_fmac_f32 v45, v65, v65
    v_lshlrev_b32 v64, 16, v62
    v_and_b32 v65, 0xffff0000, v62
    v_add_f32 v44, v44, v64
    v_fmac_f32 v45, v64, v64
    v_add_f32 v44, v44, v65
    v_fmac_f32 v45, v65, v65
    v_lshlrev_b32 v64, 16, v63
    v_and_b32 v65, 0xffff0000, v63
    v_add_f32 v44, v44, v64
    v_fmac_f32 v45, v64, v64
    v_add_f32 v44, v44, v65
    v_fmac_f32 v45, v65, v65
    s_barrier
    v_add_u32 v64, 0, v47
    v_and_b32 v64, 3, v64
    v_lshl_add_u32 v64, v64, 4, v46
    v_add_u32 v64, 65536, v64
    ds_read_b128 v[48:51], v64
    v_add_u32 v64, 1, v47
    v_and_b32 v64, 3, v64
    v_lshl_add_u32 v64, v64, 4, v46
    v_add_u32 v64, 65536, v64
    ds_read_b128 v[52:55], v64
    v_add_u32 v64, 2, v47
    v_and_b32 v64, 3, v64
    v_lshl_add_u32 v64, v64, 4, v46
    v_add_u32 v64, 65536, v64
    ds_read_b128 v[56:59], v64
    v_add_u32 v64, 3, v47
    v_and_b32 v64, 3, v64
    v_lshl_add_u32 v64, v64, 4, v46
    v_add_u32 v64, 65536, v64
    ds_read_b128 v[60:63], v64
    s_waitcnt lgkmcnt(0)
    v_lshlrev_b32 v64, 16, v48
    v_and_b32 v65, 0xffff0000, v48
    v_add_f32 v44, v44, v64
    v_fmac_f32 v45, v64, v64
    v_add_f32 v44, v44, v65
    v_fmac_f32 v45, v65, v65
    v_lshlrev_b32 v64, 16, v49
    v_and_b32 v65, 0xffff0000, v49
    v_add_f32 v44, v44, v64
    v_fmac_f32 v45, v64, v64
    v_add_f32 v44, v44, v65
    v_fmac_f32 v45, v65, v65
    v_lshlrev_b32 v64, 16, v50
    v_and_b32 v65, 0xffff0000, v50
    v_add_f32 v44, v44, v64
    v_fmac_f32 v45, v64, v64
    v_add_f32 v44, v44, v65
    v_fmac_f32 v45, v65, v65
    v_lshlrev_b32 v64, 16, v51
    v_and_b32 v65, 0xffff0000, v51
    v_add_f32 v44, v44, v64
    v_fmac_f32 v45, v64, v64
    v_add_f32 v44, v44, v65
    v_fmac_f32 v45, v65, v65
    v_lshlrev_b32 v64, 16, v52
    v_and_b32 v65, 0xffff0000, v52
    v_add_f32 v44, v44, v64
    v_fmac_f32 v45, v64, v64
    v_add_f32 v44, v44, v65
    v_fmac_f32 v45, v65, v65
    v_lshlrev_b32 v64, 16, v53
    v_and_b32 v65, 0xffff0000, v53
    v_add_f32 v44, v44, v64
    v_fmac_f32 v45, v64, v64
    v_add_f32 v44, v44, v65
    v_fmac_f32 v45, v65, v65
    v_lshlrev_b32 v64, 16, v54
    v_and_b32 v65, 0xffff0000, v54
    v_add_f32 v44, v44, v64
    v_fmac_f32 v45, v64, v64
    v_add_f32 v44, v44, v65
    v_fmac_f32 v45, v65, v65
    v_lshlrev_b32 v64, 16, v55
    v_and_b32 v65, 0xffff0000, v55
    v_add_f32 v44, v44, v64
    v_fmac_f32 v45, v64, v64
    v_add_f32 v44, v44, v65
    v_fmac_f32 v45, v65, v65
    v_lshlrev_b32 v64, 16, v56
    v_and_b32 v65, 0xffff0000, v56
    v_add_f32 v44, v44, v64
    v_fmac_f32 v45, v64, v64
    v_add_f32 v44, v44, v65
    v_fmac_f32 v45, v65, v65
    v_lshlrev_b32 v64, 16, v57
    v_and_b32 v65, 0xffff0000, v57
    v_add_f32 v44, v44, v64
    v_fmac_f32 v45, v64, v64
    v_add_f32 v44, v44, v65
    v_fmac_f32 v45, v65, v65
    v_lshlrev_b32 v64, 16, v58
    v_and_b32 v65, 0xffff0000, v58
    v_add_f32 v44, v44, v64
    v_fmac_f32 v45, v64, v64
    v_add_f32 v44, v44, v65
    v_fmac_f32 v45, v65, v65
    v_lshlrev_b32 v64, 16, v59
    v_and_b32 v65, 0xffff0000, v59
    v_add_f32 v44, v44, v64
    v_fmac_f32 v45, v64, v64
    v_add_f32 v44, v44, v65
    v_fmac_f32 v45, v65, v65
    v_lshlrev_b32 v64, 16, v60
    v_and_b32 v65, 0xffff0000, v60
    v_add_f32 v44, v44, v64
    v_fmac_f32 v45, v64, v64
    v_add_f32 v44, v44, v65
    v_fmac_f32 v45, v65, v65
    v_lshlrev_b32 v64, 16, v61
    v_and_b32 v65, 0xffff0000, v61
    v_add_f32 v44, v44, v64
    v_fmac_f32 v45, v64, v64
    v_add_f32 v44, v44, v65
    v_fmac_f32 v45, v65, v65
    v_lshlrev_b32 v64, 16, v62
    v_and_b32 v65, 0xffff0000, v62
    v_add_f32 v44, v44, v64
    v_fmac_f32 v45, v64, v64
    v_add_f32 v44, v44, v65
    v_fmac_f32 v45, v65, v65
    v_lshlrev_b32 v64, 16, v63
    v_and_b32 v65, 0xffff0000, v63
    v_add_f32 v44, v44, v64
    v_fmac_f32 v45, v64, v64
    v_add_f32 v44, v44, v65
    v_fmac_f32 v45, v65, v65
    s_barrier
    v_add_u32 v64, 0, v47
    v_and_b32 v64, 3, v64
    v_lshl_add_u32 v64, v64, 4, v46
    v_add_u32 v64, 98304, v64
    ds_read_b128 v[48:51], v64
    v_add_u32 v64, 1, v47
    v_and_b32 v64, 3, v64
    v_lshl_add_u32 v64, v64, 4, v46
    v_add_u32 v64, 98304, v64
    ds_read_b128 v[52:55], v64
    v_add_u32 v64, 2, v47
    v_and_b32 v64, 3, v64
    v_lshl_add_u32 v64, v64, 4, v46
    v_add_u32 v64, 98304, v64
    ds_read_b128 v[56:59], v64
    v_add_u32 v64, 3, v47
    v_and_b32 v64, 3, v64
    v_lshl_add_u32 v64, v64, 4, v46
    v_add_u32 v64, 98304, v64
    ds_read_b128 v[60:63], v64
    s_waitcnt lgkmcnt(0)
    v_lshlrev_b32 v64, 16, v48
    v_and_b32 v65, 0xffff0000, v48
    v_add_f32 v44, v44, v64
    v_fmac_f32 v45, v64, v64
    v_add_f32 v44, v44, v65
    v_fmac_f32 v45, v65, v65
    v_lshlrev_b32 v64, 16, v49
    v_and_b32 v65, 0xffff0000, v49
    v_add_f32 v44, v44, v64
    v_fmac_f32 v45, v64, v64
    v_add_f32 v44, v44, v65
    v_fmac_f32 v45, v65, v65
    v_lshlrev_b32 v64, 16, v50
    v_and_b32 v65, 0xffff0000, v50
    v_add_f32 v44, v44, v64
    v_fmac_f32 v45, v64, v64
    v_add_f32 v44, v44, v65
    v_fmac_f32 v45, v65, v65
    v_lshlrev_b32 v64, 16, v51
    v_and_b32 v65, 0xffff0000, v51
    v_add_f32 v44, v44, v64
    v_fmac_f32 v45, v64, v64
    v_add_f32 v44, v44, v65
    v_fmac_f32 v45, v65, v65
    v_lshlrev_b32 v64, 16, v52
    v_and_b32 v65, 0xffff0000, v52
    v_add_f32 v44, v44, v64
    v_fmac_f32 v45, v64, v64
    v_add_f32 v44, v44, v65
    v_fmac_f32 v45, v65, v65
    v_lshlrev_b32 v64, 16, v53
    v_and_b32 v65, 0xffff0000, v53
    v_add_f32 v44, v44, v64
    v_fmac_f32 v45, v64, v64
    v_add_f32 v44, v44, v65
    v_fmac_f32 v45, v65, v65
    v_lshlrev_b32 v64, 16, v54
    v_and_b32 v65, 0xffff0000, v54
    v_add_f32 v44, v44, v64
    v_fmac_f32 v45, v64, v64
    v_add_f32 v44, v44, v65
    v_fmac_f32 v45, v65, v65
    v_lshlrev_b32 v64, 16, v55
    v_and_b32 v65, 0xffff0000, v55
    v_add_f32 v44, v44, v64
    v_fmac_f32 v45, v64, v64
    v_add_f32 v44, v44, v65
    v_fmac_f32 v45, v65, v65
    v_lshlrev_b32 v64, 16, v56
    v_and_b32 v65, 0xffff0000, v56
    v_add_f32 v44, v44, v64
    v_fmac_f32 v45, v64, v64
    v_add_f32 v44, v44, v65
    v_fmac_f32 v45, v65, v65
    v_lshlrev_b32 v64, 16, v57
    v_and_b32 v65, 0xffff0000, v57
    v_add_f32 v44, v44, v64
    v_fmac_f32 v45, v64, v64
    v_add_f32 v44, v44, v65
    v_fmac_f32 v45, v65, v65
    v_lshlrev_b32 v64, 16, v58
    v_and_b32 v65, 0xffff0000, v58
    v_add_f32 v44, v44, v64
    v_fmac_f32 v45, v64, v64
    v_add_f32 v44, v44, v65
    v_fmac_f32 v45, v65, v65
    v_lshlrev_b32 v64, 16, v59
    v_and_b32 v65, 0xffff0000, v59
    v_add_f32 v44, v44, v64
    v_fmac_f32 v45, v64, v64
    v_add_f32 v44, v44, v65
    v_fmac_f32 v45, v65, v65
    v_lshlrev_b32 v64, 16, v60
    v_and_b32 v65, 0xffff0000, v60
    v_add_f32 v44, v44, v64
    v_fmac_f32 v45, v64, v64
    v_add_f32 v44, v44, v65
    v_fmac_f32 v45, v65, v65
    v_lshlrev_b32 v64, 16, v61
    v_and_b32 v65, 0xffff0000, v61
    v_add_f32 v44, v44, v64
    v_fmac_f32 v45, v64, v64
    v_add_f32 v44, v44, v65
    v_fmac_f32 v45, v65, v65
    v_lshlrev_b32 v64, 16, v62
    v_and_b32 v65, 0xffff0000, v62
    v_add_f32 v44, v44, v64
    v_fmac_f32 v45, v64, v64
    v_add_f32 v44, v44, v65
    v_fmac_f32 v45, v65, v65
    v_lshlrev_b32 v64, 16, v63
    v_and_b32 v65, 0xffff0000, v63
    v_add_f32 v44, v44, v64
    v_fmac_f32 v45, v64, v64
    v_add_f32 v44, v44, v65
    v_fmac_f32 v45, v65, v65
    s_barrier
    v_add_u32 v64, 0, v47
    v_and_b32 v64, 3, v64
    v_lshl_add_u32 v64, v64, 4, v46
    ds_read_b128 v[48:51], v64 offset:0
    v_add_u32 v64, 1, v47
    v_and_b32 v64, 3, v64
    v_lshl_add_u32 v64, v64, 4, v46
    ds_read_b128 v[52:55], v64 offset:0
    v_add_u32 v64, 2, v47
    v_and_b32 v64, 3, v64
    v_lshl_add_u32 v64, v64, 4, v46
    ds_read_b128 v[56:59], v64 offset:0
    v_add_u32 v64, 3, v47
    v_and_b32 v64, 3, v64
    v_lshl_add_u32 v64, v64, 4, v46
    ds_read_b128 v[60:63], v64 offset:0
    s_waitcnt lgkmcnt(0)
    v_lshlrev_b32 v64, 16, v48
    v_and_b32 v65, 0xffff0000, v48
    v_add_f32 v44, v44, v64
    v_fmac_f32 v45, v64, v64
    v_add_f32 v44, v44, v65
    v_fmac_f32 v45, v65, v65
    v_lshlrev_b32 v64, 16, v49
    v_and_b32 v65, 0xffff0000, v49
    v_add_f32 v44, v44, v64
    v_fmac_f32 v45, v64, v64
    v_add_f32 v44, v44, v65
    v_fmac_f32 v45, v65, v65
    v_lshlrev_b32 v64, 16, v50
    v_and_b32 v65, 0xffff0000, v50
    v_add_f32 v44, v44, v64
    v_fmac_f32 v45, v64, v64
    v_add_f32 v44, v44, v65
    v_fmac_f32 v45, v65, v65
    v_lshlrev_b32 v64, 16, v51
    v_and_b32 v65, 0xffff0000, v51
    v_add_f32 v44, v44, v64
    v_fmac_f32 v45, v64, v64
    v_add_f32 v44, v44, v65
    v_fmac_f32 v45, v65, v65
    v_lshlrev_b32 v64, 16, v52
    v_and_b32 v65, 0xffff0000, v52
    v_add_f32 v44, v44, v64
    v_fmac_f32 v45, v64, v64
    v_add_f32 v44, v44, v65
    v_fmac_f32 v45, v65, v65
    v_lshlrev_b32 v64, 16, v53
    v_and_b32 v65, 0xffff0000, v53
    v_add_f32 v44, v44, v64
    v_fmac_f32 v45, v64, v64
    v_add_f32 v44, v44, v65
    v_fmac_f32 v45, v65, v65
    v_lshlrev_b32 v64, 16, v54
    v_and_b32 v65, 0xffff0000, v54
    v_add_f32 v44, v44, v64
    v_fmac_f32 v45, v64, v64
    v_add_f32 v44, v44, v65
    v_fmac_f32 v45, v65, v65
    v_lshlrev_b32 v64, 16, v55
    v_and_b32 v65, 0xffff0000, v55
    v_add_f32 v44, v44, v64
    v_fmac_f32 v45, v64, v64
    v_add_f32 v44, v44, v65
    v_fmac_f32 v45, v65, v65
    v_lshlrev_b32 v64, 16, v56
    v_and_b32 v65, 0xffff0000, v56
    v_add_f32 v44, v44, v64
    v_fmac_f32 v45, v64, v64
    v_add_f32 v44, v44, v65
    v_fmac_f32 v45, v65, v65
    v_lshlrev_b32 v64, 16, v57
    v_and_b32 v65, 0xffff0000, v57
    v_add_f32 v44, v44, v64
    v_fmac_f32 v45, v64, v64
    v_add_f32 v44, v44, v65
    v_fmac_f32 v45, v65, v65
    v_lshlrev_b32 v64, 16, v58
    v_and_b32 v65, 0xffff0000, v58
    v_add_f32 v44, v44, v64
    v_fmac_f32 v45, v64, v64
    v_add_f32 v44, v44, v65
    v_fmac_f32 v45, v65, v65
    v_lshlrev_b32 v64, 16, v59
    v_and_b32 v65, 0xffff0000, v59
    v_add_f32 v44, v44, v64
    v_fmac_f32 v45, v64, v64
    v_add_f32 v44, v44, v65
    v_fmac_f32 v45, v65, v65
    v_lshlrev_b32 v64, 16, v60
    v_and_b32 v65, 0xffff0000, v60
    v_add_f32 v44, v44, v64
    v_fmac_f32 v45, v64, v64
    v_add_f32 v44, v44, v65
    v_fmac_f32 v45, v65, v65
    v_lshlrev_b32 v64, 16, v61
    v_and_b32 v65, 0xffff0000, v61
    v_add_f32 v44, v44, v64
    v_fmac_f32 v45, v64, v64
    v_add_f32 v44, v44, v65
    v_fmac_f32 v45, v65, v65
    v_lshlrev_b32 v64, 16, v62
    v_and_b32 v65, 0xffff0000, v62
    v_add_f32 v44, v44, v64
    v_fmac_f32 v45, v64, v64
    v_add_f32 v44, v44, v65
    v_fmac_f32 v45, v65, v65
    v_lshlrev_b32 v64, 16, v63
    v_and_b32 v65, 0xffff0000, v63
    v_add_f32 v44, v44, v64
    v_fmac_f32 v45, v64, v64
    v_add_f32 v44, v44, v65
    v_fmac_f32 v45, v65, v65
    s_barrier
    v_add_u32 v64, 0, v47
    v_and_b32 v64, 3, v64
    v_lshl_add_u32 v64, v64, 4, v46
    ds_read_b128 v[48:51], v64 offset:32768
    v_add_u32 v64, 1, v47
    v_and_b32 v64, 3, v64
    v_lshl_add_u32 v64, v64, 4, v46
    ds_read_b128 v[52:55], v64 offset:32768
    v_add_u32 v64, 2, v47
    v_and_b32 v64, 3, v64
    v_lshl_add_u32 v64, v64, 4, v46
    ds_read_b128 v[56:59], v64 offset:32768
    v_add_u32 v64, 3, v47
    v_and_b32 v64, 3, v64
    v_lshl_add_u32 v64, v64, 4, v46
    ds_read_b128 v[60:63], v64 offset:32768
    s_waitcnt lgkmcnt(0)
    v_lshlrev_b32 v64, 16, v48
    v_and_b32 v65, 0xffff0000, v48
    v_add_f32 v44, v44, v64
    v_fmac_f32 v45, v64, v64
    v_add_f32 v44, v44, v65
    v_fmac_f32 v45, v65, v65
    v_lshlrev_b32 v64, 16, v49
    v_and_b32 v65, 0xffff0000, v49
    v_add_f32 v44, v44, v64
    v_fmac_f32 v45, v64, v64
    v_add_f32 v44, v44, v65
    v_fmac_f32 v45, v65, v65
    v_lshlrev_b32 v64, 16, v50
    v_and_b32 v65, 0xffff0000, v50
    v_add_f32 v44, v44, v64
    v_fmac_f32 v45, v64, v64
    v_add_f32 v44, v44, v65
    v_fmac_f32 v45, v65, v65
    v_lshlrev_b32 v64, 16, v51
    v_and_b32 v65, 0xffff0000, v51
    v_add_f32 v44, v44, v64
    v_fmac_f32 v45, v64, v64
    v_add_f32 v44, v44, v65
    v_fmac_f32 v45, v65, v65
    v_lshlrev_b32 v64, 16, v52
    v_and_b32 v65, 0xffff0000, v52
    v_add_f32 v44, v44, v64
    v_fmac_f32 v45, v64, v64
    v_add_f32 v44, v44, v65
    v_fmac_f32 v45, v65, v65
    v_lshlrev_b32 v64, 16, v53
    v_and_b32 v65, 0xffff0000, v53
    v_add_f32 v44, v44, v64
    v_fmac_f32 v45, v64, v64
    v_add_f32 v44, v44, v65
    v_fmac_f32 v45, v65, v65
    v_lshlrev_b32 v64, 16, v54
    v_and_b32 v65, 0xffff0000, v54
    v_add_f32 v44, v44, v64
    v_fmac_f32 v45, v64, v64
    v_add_f32 v44, v44, v65
    v_fmac_f32 v45, v65, v65
    v_lshlrev_b32 v64, 16, v55
    v_and_b32 v65, 0xffff0000, v55
    v_add_f32 v44, v44, v64
    v_fmac_f32 v45, v64, v64
    v_add_f32 v44, v44, v65
    v_fmac_f32 v45, v65, v65
    v_lshlrev_b32 v64, 16, v56
    v_and_b32 v65, 0xffff0000, v56
    v_add_f32 v44, v44, v64
    v_fmac_f32 v45, v64, v64
    v_add_f32 v44, v44, v65
    v_fmac_f32 v45, v65, v65
    v_lshlrev_b32 v64, 16, v57
    v_and_b32 v65, 0xffff0000, v57
    v_add_f32 v44, v44, v64
    v_fmac_f32 v45, v64, v64
    v_add_f32 v44, v44, v65
    v_fmac_f32 v45, v65, v65
    v_lshlrev_b32 v64, 16, v58
    v_and_b32 v65, 0xffff0000, v58
    v_add_f32 v44, v44, v64
    v_fmac_f32 v45, v64, v64
    v_add_f32 v44, v44, v65
    v_fmac_f32 v45, v65, v65
    v_lshlrev_b32 v64, 16, v59
    v_and_b32 v65, 0xffff0000, v59
    v_add_f32 v44, v44, v64
    v_fmac_f32 v45, v64, v64
    v_add_f32 v44, v44, v65
    v_fmac_f32 v45, v65, v65
    v_lshlrev_b32 v64, 16, v60
    v_and_b32 v65, 0xffff0000, v60
    v_add_f32 v44, v44, v64
    v_fmac_f32 v45, v64, v64
    v_add_f32 v44, v44, v65
    v_fmac_f32 v45, v65, v65
    v_lshlrev_b32 v64, 16, v61
    v_and_b32 v65, 0xffff0000, v61
    v_add_f32 v44, v44, v64
    v_fmac_f32 v45, v64, v64
    v_add_f32 v44, v44, v65
    v_fmac_f32 v45, v65, v65
    v_lshlrev_b32 v64, 16, v62
    v_and_b32 v65, 0xffff0000, v62
    v_add_f32 v44, v44, v64
    v_fmac_f32 v45, v64, v64
    v_add_f32 v44, v44, v65
    v_fmac_f32 v45, v65, v65
    v_lshlrev_b32 v64, 16, v63
    v_and_b32 v65, 0xffff0000, v63
    v_add_f32 v44, v44, v64
    v_fmac_f32 v45, v64, v64
    v_add_f32 v44, v44, v65
    v_fmac_f32 v45, v65, v65
    s_nop 1
    v_add_f32_dpp v44, v44, v44 quad_perm:[1,0,3,2] row_mask:0xf bank_mask:0xf
    v_add_f32_dpp v45, v45, v45 quad_perm:[1,0,3,2] row_mask:0xf bank_mask:0xf
    v_lshrrev_b32 v5, 1, v2
    s_lshl_b32 s3, s29, 8
    s_add_u32 s3, s3, 1024
    v_lshlrev_b32 v5, 3, v5
    v_add_u32 v5, s3, v5
    ds_write_b64 v5, v[44:45]
    s_waitcnt lgkmcnt(0)
    s_barrier
    s_branch k1_qkv_kernel_p1end6
k1_qkv_kernel_cons7:
    s_cmp_eq_u32 s31, 15
    s_cbranch_scc1 k1_qkv_kernel_p1end6
    v_mov_b32 v156, 0x3f803f80
    v_mov_b32 v157, 0x3f803f80
    v_mov_b32 v158, 0x3f803f80
    v_mov_b32 v159, 0x3f803f80
    v_lshrrev_b32 v7, 1, v3
    v_xor_b32 v7, v7, v4
    v_lshlrev_b32 v7, 4, v7
    v_lshl_add_u32 v7, v3, 7, v7
    s_lshl_b32 s3, s33, 1
    s_add_u32 s3, s3, 0
    s_and_b32 s3, s3, 3
    s_lshl_b32 s27, s32, 2
    s_add_u32 s55, s3, s27
    s_lshl_b32 s3, s55, 11
    v_add_u32 v8, s3, v7
    v_xor_b32 v9, 64, v8
    s_lshl_b32 s3, s33, 1
    s_add_u32 s3, s3, 1
    s_and_b32 s3, s3, 3
    s_lshl_b32 s27, s32, 2
    s_add_u32 s56, s3, s27
    s_lshl_b32 s3, s56, 11
    v_add_u32 v10, s3, v7
    v_xor_b32 v11, 64, v10
    s_lshl_b32 s3, s33, 1
    s_add_u32 s3, s3, 2
    s_and_b32 s3, s3, 3
    s_lshl_b32 s27, s32, 2
    s_add_u32 s57, s3, s27
    s_lshl_b32 s3, s57, 11
    v_add_u32 v12, s3, v7
    v_xor_b32 v13, 64, v12
    s_lshl_b32 s3, s33, 1
    s_add_u32 s3, s3, 3
    s_and_b32 s3, s3, 3
    s_lshl_b32 s27, s32, 2
    s_add_u32 s58, s3, s27
    s_lshl_b32 s3, s58, 11
    v_add_u32 v14, s3, v7
    v_xor_b32 v15, 64, v14
    v_lshrrev_b32 v7, 2, v3
    v_and_b32 v162, 1, v4
    v_lshl_add_u32 v162, v162, 2, v7
    v_lshlrev_b32 v162, 1, v162
    v_lshl_add_u32 v6, v4, 3, v7
    v_lshlrev_b32 v6, 8, v6
    v_and_b32 v7, 3, v2
    v_lshrrev_b32 v163, 1, v7
    v_add_u32 v162, v162, v163
    v_and_b32 v7, 1, v7
    v_lshl_add_u32 v6, v7, 3, v6
    s_lshl_b32 s3, s32, 1
    s_add_u32 s3, s3, 0
    s_and_b32 s3, s3, 3
    s_lshl_b32 s27, s33, 2
    s_add_u32 s51, s3, s27
    s_lshl_b32 s3, s51, 1
    v_add_u32 v7, s3, v162
    v_and_b32 v7, 15, v7
    v_lshl_add_u32 v16, v7, 4, v6
    s_lshl_b32 s3, s32, 1
    s_add_u32 s3, s3, 1
    s_and_b32 s3, s3, 3
    s_lshl_b32 s27, s33, 2
    s_add_u32 s52, s3, s27
    s_lshl_b32 s3, s52, 1
    v_add_u32 v7, s3, v162
    v_and_b32 v7, 15, v7
    v_lshl_add_u32 v17, v7, 4, v6
    s_lshl_b32 s3, s32, 1
    s_add_u32 s3, s3, 2
    s_and_b32 s3, s3, 3
    s_lshl_b32 s27, s33, 2
    s_add_u32 s53, s3, s27
    s_lshl_b32 s3, s53, 1
    v_add_u32 v7, s3, v162
    v_and_b32 v7, 15, v7
    v_lshl_add_u32 v18, v7, 4, v6
    s_lshl_b32 s3, s32, 1
    s_add_u32 s3, s3, 3
    s_and_b32 s3, s3, 3
    s_lshl_b32 s27, s33, 2
    s_add_u32 s54, s3, s27
    s_lshl_b32 s3, s54, 1
    v_add_u32 v7, s3, v162
    v_and_b32 v7, 15, v7
    v_lshl_add_u32 v19, v7, 4, v6
    v_mov_b32 v84, 0
    v_mov_b32 v85, 0
    v_mov_b32 v86, 0
    v_mov_b32 v87, 0
    v_mov_b32 v88, 0
    v_mov_b32 v89, 0
    v_mov_b32 v90, 0
    v_mov_b32 v91, 0
    v_mov_b32 v92, 0
    v_mov_b32 v93, 0
    v_mov_b32 v94, 0
    v_mov_b32 v95, 0
    v_mov_b32 v96, 0
    v_mov_b32 v97, 0
    v_mov_b32 v98, 0
    v_mov_b32 v99, 0
    v_mov_b32 v100, 0
    v_mov_b32 v101, 0
    v_mov_b32 v102, 0
    v_mov_b32 v103, 0
    v_mov_b32 v104, 0
    v_mov_b32 v105, 0
    v_mov_b32 v106, 0
    v_mov_b32 v107, 0
    v_mov_b32 v108, 0
    v_mov_b32 v109, 0
    v_mov_b32 v110, 0
    v_mov_b32 v111, 0
    v_mov_b32 v112, 0
    v_mov_b32 v113, 0
    v_mov_b32 v114, 0
    v_mov_b32 v115, 0
    v_mov_b32 v116, 0
    v_mov_b32 v117, 0
    v_mov_b32 v118, 0
    v_mov_b32 v119, 0
    v_mov_b32 v120, 0
    v_mov_b32 v121, 0
    v_mov_b32 v122, 0
    v_mov_b32 v123, 0
    v_mov_b32 v124, 0
    v_mov_b32 v125, 0
    v_mov_b32 v126, 0
    v_mov_b32 v127, 0
    v_mov_b32 v128, 0
    v_mov_b32 v129, 0
    v_mov_b32 v130, 0
    v_mov_b32 v131, 0
    v_mov_b32 v132, 0
    v_mov_b32 v133, 0
    v_mov_b32 v134, 0
    v_mov_b32 v135, 0
    v_mov_b32 v136, 0
    v_mov_b32 v137, 0
    v_mov_b32 v138, 0
    v_mov_b32 v139, 0
    v_mov_b32 v140, 0
    v_mov_b32 v141, 0
    v_mov_b32 v142, 0
    v_mov_b32 v143, 0
    v_mov_b32 v144, 0
    v_mov_b32 v145, 0
    v_mov_b32 v146, 0
    v_mov_b32 v147, 0
    v_mov_b32 v148, 0
    v_mov_b32 v149, 0
    v_mov_b32 v150, 0
    v_mov_b32 v151, 0
    v_mov_b32 v152, 0
    v_mov_b32 v153, 0
    v_mov_b32 v154, 0
    v_mov_b32 v155, 0
    s_waitcnt lgkmcnt(0)
    s_barrier
    ds_read_b64_tr_b16 v[52:53], v16 offset:16384
    ds_read_b64_tr_b16 v[54:55], v16 offset:17408
    ds_read_b128 v[20:23], v8 offset:0
    ds_read_b64_tr_b16 v[56:57], v17 offset:16384
    ds_read_b64_tr_b16 v[58:59], v17 offset:17408
    ds_read_b128 v[24:27], v10 offset:0
    ds_read_b64_tr_b16 v[60:61], v18 offset:16384
    ds_read_b64_tr_b16 v[62:63], v18 offset:17408
    ds_read_b128 v[28:31], v12 offset:0
    ds_read_b64_tr_b16 v[64:65], v19 offset:16384
    ds_read_b64_tr_b16 v[66:67], v19 offset:17408
    ds_read_b128 v[32:35], v14 offset:0
    s_waitcnt lgkmcnt(0)
    ds_read_b64_tr_b16 v[68:69], v16 offset:24576
    v_mfma_f32_16x16x32_bf16 v[84:87], v[52:55], v[20:23], v[84:87]
    ds_read_b64_tr_b16 v[70:71], v16 offset:25600
    v_mfma_f32_16x16x32_bf16 v[100:103], v[56:59], v[20:23], v[100:103]
    ds_read_b128 v[36:39], v9 offset:0
    v_mfma_f32_16x16x32_bf16 v[116:119], v[60:63], v[20:23], v[116:119]
    ds_read_b64_tr_b16 v[72:73], v17 offset:24576
    v_mfma_f32_16x16x32_bf16 v[132:135], v[64:67], v[20:23], v[132:135]
    ds_read_b64_tr_b16 v[74:75], v17 offset:25600
    v_mfma_f32_16x16x32_bf16 v[88:91], v[52:55], v[24:27], v[88:91]
    ds_read_b128 v[40:43], v11 offset:0
    v_mfma_f32_16x16x32_bf16 v[104:107], v[56:59], v[24:27], v[104:107]
    ds_read_b64_tr_b16 v[76:77], v18 offset:24576
    v_mfma_f32_16x16x32_bf16 v[120:123], v[60:63], v[24:27], v[120:123]
    ds_read_b64_tr_b16 v[78:79], v18 offset:25600
    v_mfma_f32_16x16x32_bf16 v[136:139], v[64:67], v[24:27], v[136:139]
    ds_read_b128 v[44:47], v13 offset:0
    v_mfma_f32_16x16x32_bf16 v[92:95], v[52:55], v[28:31], v[92:95]
    ds_read_b64_tr_b16 v[80:81], v19 offset:24576
    v_mfma_f32_16x16x32_bf16 v[108:111], v[56:59], v[28:31], v[108:111]
    ds_read_b64_tr_b16 v[82:83], v19 offset:25600
    v_mfma_f32_16x16x32_bf16 v[124:127], v[60:63], v[28:31], v[124:127]
    ds_read_b128 v[48:51], v15 offset:0
    v_mfma_f32_16x16x32_bf16 v[140:143], v[64:67], v[28:31], v[140:143]
    v_mfma_f32_16x16x32_bf16 v[96:99], v[52:55], v[32:35], v[96:99]
    v_mfma_f32_16x16x32_bf16 v[112:115], v[56:59], v[32:35], v[112:115]
    v_mfma_f32_16x16x32_bf16 v[128:131], v[60:63], v[32:35], v[128:131]
    v_mfma_f32_16x16x32_bf16 v[144:147], v[64:67], v[32:35], v[144:147]
    v_mfma_f32_16x16x32_bf16 v[148:151], v[52:55], v[156:159], v[148:151]
    v_mfma_f32_16x16x32_bf16 v[152:155], v[56:59], v[156:159], v[152:155]
    s_waitcnt lgkmcnt(0)
    s_barrier
    ds_read_b64_tr_b16 v[52:53], v16 offset:49152
    v_mfma_f32_16x16x32_bf16 v[84:87], v[68:71], v[36:39], v[84:87]
    ds_read_b64_tr_b16 v[54:55], v16 offset:50176
    v_mfma_f32_16x16x32_bf16 v[100:103], v[72:75], v[36:39], v[100:103]
    ds_read_b128 v[20:23], v8 offset:32768
    v_mfma_f32_16x16x32_bf16 v[116:119], v[76:79], v[36:39], v[116:119]
    ds_read_b64_tr_b16 v[56:57], v17 offset:49152
    v_mfma_f32_16x16x32_bf16 v[132:135], v[80:83], v[36:39], v[132:135]
    ds_read_b64_tr_b16 v[58:59], v17 offset:50176
    v_mfma_f32_16x16x32_bf16 v[88:91], v[68:71], v[40:43], v[88:91]
    ds_read_b128 v[24:27], v10 offset:32768
    v_mfma_f32_16x16x32_bf16 v[104:107], v[72:75], v[40:43], v[104:107]
    ds_read_b64_tr_b16 v[60:61], v18 offset:49152
    v_mfma_f32_16x16x32_bf16 v[120:123], v[76:79], v[40:43], v[120:123]
    ds_read_b64_tr_b16 v[62:63], v18 offset:50176
    v_mfma_f32_16x16x32_bf16 v[136:139], v[80:83], v[40:43], v[136:139]
    ds_read_b128 v[28:31], v12 offset:32768
    v_mfma_f32_16x16x32_bf16 v[92:95], v[68:71], v[44:47], v[92:95]
    ds_read_b64_tr_b16 v[64:65], v19 offset:49152
    v_mfma_f32_16x16x32_bf16 v[108:111], v[72:75], v[44:47], v[108:111]
    ds_read_b64_tr_b16 v[66:67], v19 offset:50176
    v_mfma_f32_16x16x32_bf16 v[124:127], v[76:79], v[44:47], v[124:127]
    ds_read_b128 v[32:35], v14 offset:32768
    v_mfma_f32_16x16x32_bf16 v[140:143], v[80:83], v[44:47], v[140:143]
    v_mfma_f32_16x16x32_bf16 v[96:99], v[68:71], v[48:51], v[96:99]
    v_mfma_f32_16x16x32_bf16 v[112:115], v[72:75], v[48:51], v[112:115]
    v_mfma_f32_16x16x32_bf16 v[128:131], v[76:79], v[48:51], v[128:131]
    v_mfma_f32_16x16x32_bf16 v[144:147], v[80:83], v[48:51], v[144:147]
    v_mfma_f32_16x16x32_bf16 v[148:151], v[68:71], v[156:159], v[148:151]
    v_mfma_f32_16x16x32_bf16 v[152:155], v[72:75], v[156:159], v[152:155]
    s_waitcnt lgkmcnt(0)
    ds_read_b64_tr_b16 v[68:69], v16 offset:57344
    v_mfma_f32_16x16x32_bf16 v[84:87], v[52:55], v[20:23], v[84:87]
    ds_read_b64_tr_b16 v[70:71], v16 offset:58368
    v_mfma_f32_16x16x32_bf16 v[100:103], v[56:59], v[20:23], v[100:103]
    ds_read_b128 v[36:39], v9 offset:32768
    v_mfma_f32_16x16x32_bf16 v[116:119], v[60:63], v[20:23], v[116:119]
    ds_read_b64_tr_b16 v[72:73], v17 offset:57344
    v_mfma_f32_16x16x32_bf16 v[132:135], v[64:67], v[20:23], v[132:135]
    ds_read_b64_tr_b16 v[74:75], v17 offset:58368
    v_mfma_f32_16x16x32_bf16 v[88:91], v[52:55], v[24:27], v[88:91]
    ds_read_b128 v[40:43], v11 offset:32768
    v_mfma_f32_16x16x32_bf16 v[104:107], v[56:59], v[24:27], v[104:107]
    ds_read_b64_tr_b16 v[76:77], v18 offset:57344
    v_mfma_f32_16x16x32_bf16 v[120:123], v[60:63], v[24:27], v[120:123]
    ds_read_b64_tr_b16 v[78:79], v18 offset:58368
    v_mfma_f32_16x16x32_bf16 v[136:139], v[64:67], v[24:27], v[136:139]
    ds_read_b128 v[44:47], v13 offset:32768
    v_mfma_f32_16x16x32_bf16 v[92:95], v[52:55], v[28:31], v[92:95]
    ds_read_b64_tr_b16 v[80:81], v19 offset:57344
    v_mfma_f32_16x16x32_bf16 v[108:111], v[56:59], v[28:31], v[108:111]
    ds_read_b64_tr_b16 v[82:83], v19 offset:58368
    v_mfma_f32_16x16x32_bf16 v[124:127], v[60:63], v[28:31], v[124:127]
    ds_read_b128 v[48:51], v15 offset:32768
    v_mfma_f32_16x16x32_bf16 v[140:143], v[64:67], v[28:31], v[140:143]
    v_mfma_f32_16x16x32_bf16 v[96:99], v[52:55], v[32:35], v[96:99]
    v_mfma_f32_16x16x32_bf16 v[112:115], v[56:59], v[32:35], v[112:115]
    v_mfma_f32_16x16x32_bf16 v[128:131], v[60:63], v[32:35], v[128:131]
    v_mfma_f32_16x16x32_bf16 v[144:147], v[64:67], v[32:35], v[144:147]
    v_mfma_f32_16x16x32_bf16 v[148:151], v[52:55], v[156:159], v[148:151]
    v_mfma_f32_16x16x32_bf16 v[152:155], v[56:59], v[156:159], v[152:155]
    s_waitcnt lgkmcnt(0)
    s_barrier
    v_add_u32 v8, 65536, v8
    v_add_u32 v9, 65536, v9
    v_add_u32 v10, 65536, v10
    v_add_u32 v11, 65536, v11
    v_add_u32 v12, 65536, v12
    v_add_u32 v13, 65536, v13
    v_add_u32 v14, 65536, v14
    v_add_u32 v15, 65536, v15
    v_add_u32 v16, 65536, v16
    v_add_u32 v17, 65536, v17
    v_add_u32 v18, 65536, v18
    v_add_u32 v19, 65536, v19
    ds_read_b64_tr_b16 v[52:53], v16 offset:16384
    v_mfma_f32_16x16x32_bf16 v[84:87], v[68:71], v[36:39], v[84:87]
    ds_read_b64_tr_b16 v[54:55], v16 offset:17408
    v_mfma_f32_16x16x32_bf16 v[100:103], v[72:75], v[36:39], v[100:103]
    ds_read_b128 v[20:23], v8 offset:0
    v_mfma_f32_16x16x32_bf16 v[116:119], v[76:79], v[36:39], v[116:119]
    ds_read_b64_tr_b16 v[56:57], v17 offset:16384
    v_mfma_f32_16x16x32_bf16 v[132:135], v[80:83], v[36:39], v[132:135]
    ds_read_b64_tr_b16 v[58:59], v17 offset:17408
    v_mfma_f32_16x16x32_bf16 v[88:91], v[68:71], v[40:43], v[88:91]
    ds_read_b128 v[24:27], v10 offset:0
    v_mfma_f32_16x16x32_bf16 v[104:107], v[72:75], v[40:43], v[104:107]
    ds_read_b64_tr_b16 v[60:61], v18 offset:16384
    v_mfma_f32_16x16x32_bf16 v[120:123], v[76:79], v[40:43], v[120:123]
    ds_read_b64_tr_b16 v[62:63], v18 offset:17408
    v_mfma_f32_16x16x32_bf16 v[136:139], v[80:83], v[40:43], v[136:139]
    ds_read_b128 v[28:31], v12 offset:0
    v_mfma_f32_16x16x32_bf16 v[92:95], v[68:71], v[44:47], v[92:95]
    ds_read_b64_tr_b16 v[64:65], v19 offset:16384
    v_mfma_f32_16x16x32_bf16 v[108:111], v[72:75], v[44:47], v[108:111]
    ds_read_b64_tr_b16 v[66:67], v19 offset:17408
    v_mfma_f32_16x16x32_bf16 v[124:127], v[76:79], v[44:47], v[124:127]
    ds_read_b128 v[32:35], v14 offset:0
    v_mfma_f32_16x16x32_bf16 v[140:143], v[80:83], v[44:47], v[140:143]
    v_mfma_f32_16x16x32_bf16 v[96:99], v[68:71], v[48:51], v[96:99]
    v_mfma_f32_16x16x32_bf16 v[112:115], v[72:75], v[48:51], v[112:115]
    v_mfma_f32_16x16x32_bf16 v[128:131], v[76:79], v[48:51], v[128:131]
    v_mfma_f32_16x16x32_bf16 v[144:147], v[80:83], v[48:51], v[144:147]
    v_mfma_f32_16x16x32_bf16 v[148:151], v[68:71], v[156:159], v[148:151]
    v_mfma_f32_16x16x32_bf16 v[152:155], v[72:75], v[156:159], v[152:155]
    s_waitcnt lgkmcnt(0)
    ds_read_b64_tr_b16 v[68:69], v16 offset:24576
    v_mfma_f32_16x16x32_bf16 v[84:87], v[52:55], v[20:23], v[84:87]
    ds_read_b64_tr_b16 v[70:71], v16 offset:25600
    v_mfma_f32_16x16x32_bf16 v[100:103], v[56:59], v[20:23], v[100:103]
    ds_read_b128 v[36:39], v9 offset:0
    v_mfma_f32_16x16x32_bf16 v[116:119], v[60:63], v[20:23], v[116:119]
    ds_read_b64_tr_b16 v[72:73], v17 offset:24576
    v_mfma_f32_16x16x32_bf16 v[132:135], v[64:67], v[20:23], v[132:135]
    ds_read_b64_tr_b16 v[74:75], v17 offset:25600
    v_mfma_f32_16x16x32_bf16 v[88:91], v[52:55], v[24:27], v[88:91]
    ds_read_b128 v[40:43], v11 offset:0
    v_mfma_f32_16x16x32_bf16 v[104:107], v[56:59], v[24:27], v[104:107]
    ds_read_b64_tr_b16 v[76:77], v18 offset:24576
    v_mfma_f32_16x16x32_bf16 v[120:123], v[60:63], v[24:27], v[120:123]
    ds_read_b64_tr_b16 v[78:79], v18 offset:25600
    v_mfma_f32_16x16x32_bf16 v[136:139], v[64:67], v[24:27], v[136:139]
    ds_read_b128 v[44:47], v13 offset:0
    v_mfma_f32_16x16x32_bf16 v[92:95], v[52:55], v[28:31], v[92:95]
    ds_read_b64_tr_b16 v[80:81], v19 offset:24576
    v_mfma_f32_16x16x32_bf16 v[108:111], v[56:59], v[28:31], v[108:111]
    ds_read_b64_tr_b16 v[82:83], v19 offset:25600
    v_mfma_f32_16x16x32_bf16 v[124:127], v[60:63], v[28:31], v[124:127]
    ds_read_b128 v[48:51], v15 offset:0
    v_mfma_f32_16x16x32_bf16 v[140:143], v[64:67], v[28:31], v[140:143]
    v_mfma_f32_16x16x32_bf16 v[96:99], v[52:55], v[32:35], v[96:99]
    v_mfma_f32_16x16x32_bf16 v[112:115], v[56:59], v[32:35], v[112:115]
    v_mfma_f32_16x16x32_bf16 v[128:131], v[60:63], v[32:35], v[128:131]
    v_mfma_f32_16x16x32_bf16 v[144:147], v[64:67], v[32:35], v[144:147]
    v_mfma_f32_16x16x32_bf16 v[148:151], v[52:55], v[156:159], v[148:151]
    v_mfma_f32_16x16x32_bf16 v[152:155], v[56:59], v[156:159], v[152:155]
    s_waitcnt lgkmcnt(0)
    s_barrier
    ds_read_b64_tr_b16 v[52:53], v16 offset:49152
    v_mfma_f32_16x16x32_bf16 v[84:87], v[68:71], v[36:39], v[84:87]
    ds_read_b64_tr_b16 v[54:55], v16 offset:50176
    v_mfma_f32_16x16x32_bf16 v[100:103], v[72:75], v[36:39], v[100:103]
    ds_read_b128 v[20:23], v8 offset:32768
    v_mfma_f32_16x16x32_bf16 v[116:119], v[76:79], v[36:39], v[116:119]
    ds_read_b64_tr_b16 v[56:57], v17 offset:49152
    v_mfma_f32_16x16x32_bf16 v[132:135], v[80:83], v[36:39], v[132:135]
    ds_read_b64_tr_b16 v[58:59], v17 offset:50176
    v_mfma_f32_16x16x32_bf16 v[88:91], v[68:71], v[40:43], v[88:91]
    ds_read_b128 v[24:27], v10 offset:32768
    v_mfma_f32_16x16x32_bf16 v[104:107], v[72:75], v[40:43], v[104:107]
    ds_read_b64_tr_b16 v[60:61], v18 offset:49152
    v_mfma_f32_16x16x32_bf16 v[120:123], v[76:79], v[40:43], v[120:123]
    ds_read_b64_tr_b16 v[62:63], v18 offset:50176
    v_mfma_f32_16x16x32_bf16 v[136:139], v[80:83], v[40:43], v[136:139]
    ds_read_b128 v[28:31], v12 offset:32768
    v_mfma_f32_16x16x32_bf16 v[92:95], v[68:71], v[44:47], v[92:95]
    ds_read_b64_tr_b16 v[64:65], v19 offset:49152
    v_mfma_f32_16x16x32_bf16 v[108:111], v[72:75], v[44:47], v[108:111]
    ds_read_b64_tr_b16 v[66:67], v19 offset:50176
    v_mfma_f32_16x16x32_bf16 v[124:127], v[76:79], v[44:47], v[124:127]
    ds_read_b128 v[32:35], v14 offset:32768
    v_mfma_f32_16x16x32_bf16 v[140:143], v[80:83], v[44:47], v[140:143]
    v_mfma_f32_16x16x32_bf16 v[96:99], v[68:71], v[48:51], v[96:99]
    v_mfma_f32_16x16x32_bf16 v[112:115], v[72:75], v[48:51], v[112:115]
    v_mfma_f32_16x16x32_bf16 v[128:131], v[76:79], v[48:51], v[128:131]
    v_mfma_f32_16x16x32_bf16 v[144:147], v[80:83], v[48:51], v[144:147]
    v_mfma_f32_16x16x32_bf16 v[148:151], v[68:71], v[156:159], v[148:151]
    v_mfma_f32_16x16x32_bf16 v[152:155], v[72:75], v[156:159], v[152:155]
    s_waitcnt lgkmcnt(0)
    ds_read_b64_tr_b16 v[68:69], v16 offset:57344
    v_mfma_f32_16x16x32_bf16 v[84:87], v[52:55], v[20:23], v[84:87]
    ds_read_b64_tr_b16 v[70:71], v16 offset:58368
    v_mfma_f32_16x16x32_bf16 v[100:103], v[56:59], v[20:23], v[100:103]
    ds_read_b128 v[36:39], v9 offset:32768
    v_mfma_f32_16x16x32_bf16 v[116:119], v[60:63], v[20:23], v[116:119]
    ds_read_b64_tr_b16 v[72:73], v17 offset:57344
    v_mfma_f32_16x16x32_bf16 v[132:135], v[64:67], v[20:23], v[132:135]
    ds_read_b64_tr_b16 v[74:75], v17 offset:58368
    v_mfma_f32_16x16x32_bf16 v[88:91], v[52:55], v[24:27], v[88:91]
    ds_read_b128 v[40:43], v11 offset:32768
    v_mfma_f32_16x16x32_bf16 v[104:107], v[56:59], v[24:27], v[104:107]
    ds_read_b64_tr_b16 v[76:77], v18 offset:57344
    v_mfma_f32_16x16x32_bf16 v[120:123], v[60:63], v[24:27], v[120:123]
    ds_read_b64_tr_b16 v[78:79], v18 offset:58368
    v_mfma_f32_16x16x32_bf16 v[136:139], v[64:67], v[24:27], v[136:139]
    ds_read_b128 v[44:47], v13 offset:32768
    v_mfma_f32_16x16x32_bf16 v[92:95], v[52:55], v[28:31], v[92:95]
    ds_read_b64_tr_b16 v[80:81], v19 offset:57344
    v_mfma_f32_16x16x32_bf16 v[108:111], v[56:59], v[28:31], v[108:111]
    ds_read_b64_tr_b16 v[82:83], v19 offset:58368
    v_mfma_f32_16x16x32_bf16 v[124:127], v[60:63], v[28:31], v[124:127]
    ds_read_b128 v[48:51], v15 offset:32768
    v_mfma_f32_16x16x32_bf16 v[140:143], v[64:67], v[28:31], v[140:143]
    v_mfma_f32_16x16x32_bf16 v[96:99], v[52:55], v[32:35], v[96:99]
    v_mfma_f32_16x16x32_bf16 v[112:115], v[56:59], v[32:35], v[112:115]
    v_mfma_f32_16x16x32_bf16 v[128:131], v[60:63], v[32:35], v[128:131]
    v_mfma_f32_16x16x32_bf16 v[144:147], v[64:67], v[32:35], v[144:147]
    v_mfma_f32_16x16x32_bf16 v[148:151], v[52:55], v[156:159], v[148:151]
    v_mfma_f32_16x16x32_bf16 v[152:155], v[56:59], v[156:159], v[152:155]
    s_waitcnt lgkmcnt(0)
    s_barrier
    v_add_u32 v8, 4294901760, v8
    v_add_u32 v9, 4294901760, v9
    v_add_u32 v10, 4294901760, v10
    v_add_u32 v11, 4294901760, v11
    v_add_u32 v12, 4294901760, v12
    v_add_u32 v13, 4294901760, v13
    v_add_u32 v14, 4294901760, v14
    v_add_u32 v15, 4294901760, v15
    v_add_u32 v16, 4294901760, v16
    v_add_u32 v17, 4294901760, v17
    v_add_u32 v18, 4294901760, v18
    v_add_u32 v19, 4294901760, v19
    ds_read_b64_tr_b16 v[52:53], v16 offset:16384
    v_mfma_f32_16x16x32_bf16 v[84:87], v[68:71], v[36:39], v[84:87]
    ds_read_b64_tr_b16 v[54:55], v16 offset:17408
    v_mfma_f32_16x16x32_bf16 v[100:103], v[72:75], v[36:39], v[100:103]
    ds_read_b128 v[20:23], v8 offset:0
    v_mfma_f32_16x16x32_bf16 v[116:119], v[76:79], v[36:39], v[116:119]
    ds_read_b64_tr_b16 v[56:57], v17 offset:16384
    v_mfma_f32_16x16x32_bf16 v[132:135], v[80:83], v[36:39], v[132:135]
    ds_read_b64_tr_b16 v[58:59], v17 offset:17408
    v_mfma_f32_16x16x32_bf16 v[88:91], v[68:71], v[40:43], v[88:91]
    ds_read_b128 v[24:27], v10 offset:0
    v_mfma_f32_16x16x32_bf16 v[104:107], v[72:75], v[40:43], v[104:107]
    ds_read_b64_tr_b16 v[60:61], v18 offset:16384
    v_mfma_f32_16x16x32_bf16 v[120:123], v[76:79], v[40:43], v[120:123]
    ds_read_b64_tr_b16 v[62:63], v18 offset:17408
    v_mfma_f32_16x16x32_bf16 v[136:139], v[80:83], v[40:43], v[136:139]
    ds_read_b128 v[28:31], v12 offset:0
    v_mfma_f32_16x16x32_bf16 v[92:95], v[68:71], v[44:47], v[92:95]
    ds_read_b64_tr_b16 v[64:65], v19 offset:16384
    v_mfma_f32_16x16x32_bf16 v[108:111], v[72:75], v[44:47], v[108:111]
    ds_read_b64_tr_b16 v[66:67], v19 offset:17408
    v_mfma_f32_16x16x32_bf16 v[124:127], v[76:79], v[44:47], v[124:127]
    ds_read_b128 v[32:35], v14 offset:0
    v_mfma_f32_16x16x32_bf16 v[140:143], v[80:83], v[44:47], v[140:143]
    v_mfma_f32_16x16x32_bf16 v[96:99], v[68:71], v[48:51], v[96:99]
    v_mfma_f32_16x16x32_bf16 v[112:115], v[72:75], v[48:51], v[112:115]
    v_mfma_f32_16x16x32_bf16 v[128:131], v[76:79], v[48:51], v[128:131]
    v_mfma_f32_16x16x32_bf16 v[144:147], v[80:83], v[48:51], v[144:147]
    v_mfma_f32_16x16x32_bf16 v[148:151], v[68:71], v[156:159], v[148:151]
    v_mfma_f32_16x16x32_bf16 v[152:155], v[72:75], v[156:159], v[152:155]
    s_waitcnt lgkmcnt(0)
    ds_read_b64_tr_b16 v[68:69], v16 offset:24576
    v_mfma_f32_16x16x32_bf16 v[84:87], v[52:55], v[20:23], v[84:87]
    ds_read_b64_tr_b16 v[70:71], v16 offset:25600
    v_mfma_f32_16x16x32_bf16 v[100:103], v[56:59], v[20:23], v[100:103]
    ds_read_b128 v[36:39], v9 offset:0
    v_mfma_f32_16x16x32_bf16 v[116:119], v[60:63], v[20:23], v[116:119]
    ds_read_b64_tr_b16 v[72:73], v17 offset:24576
    v_mfma_f32_16x16x32_bf16 v[132:135], v[64:67], v[20:23], v[132:135]
    ds_read_b64_tr_b16 v[74:75], v17 offset:25600
    v_mfma_f32_16x16x32_bf16 v[88:91], v[52:55], v[24:27], v[88:91]
    ds_read_b128 v[40:43], v11 offset:0
    v_mfma_f32_16x16x32_bf16 v[104:107], v[56:59], v[24:27], v[104:107]
    ds_read_b64_tr_b16 v[76:77], v18 offset:24576
    v_mfma_f32_16x16x32_bf16 v[120:123], v[60:63], v[24:27], v[120:123]
    ds_read_b64_tr_b16 v[78:79], v18 offset:25600
    v_mfma_f32_16x16x32_bf16 v[136:139], v[64:67], v[24:27], v[136:139]
    ds_read_b128 v[44:47], v13 offset:0
    v_mfma_f32_16x16x32_bf16 v[92:95], v[52:55], v[28:31], v[92:95]
    ds_read_b64_tr_b16 v[80:81], v19 offset:24576
    v_mfma_f32_16x16x32_bf16 v[108:111], v[56:59], v[28:31], v[108:111]
    ds_read_b64_tr_b16 v[82:83], v19 offset:25600
    v_mfma_f32_16x16x32_bf16 v[124:127], v[60:63], v[28:31], v[124:127]
    ds_read_b128 v[48:51], v15 offset:0
    v_mfma_f32_16x16x32_bf16 v[140:143], v[64:67], v[28:31], v[140:143]
    v_mfma_f32_16x16x32_bf16 v[96:99], v[52:55], v[32:35], v[96:99]
    v_mfma_f32_16x16x32_bf16 v[112:115], v[56:59], v[32:35], v[112:115]
    v_mfma_f32_16x16x32_bf16 v[128:131], v[60:63], v[32:35], v[128:131]
    v_mfma_f32_16x16x32_bf16 v[144:147], v[64:67], v[32:35], v[144:147]
    v_mfma_f32_16x16x32_bf16 v[148:151], v[52:55], v[156:159], v[148:151]
    v_mfma_f32_16x16x32_bf16 v[152:155], v[56:59], v[156:159], v[152:155]
    s_waitcnt lgkmcnt(0)
    s_barrier
    ds_read_b64_tr_b16 v[52:53], v16 offset:49152
    v_mfma_f32_16x16x32_bf16 v[84:87], v[68:71], v[36:39], v[84:87]
    ds_read_b64_tr_b16 v[54:55], v16 offset:50176
    v_mfma_f32_16x16x32_bf16 v[100:103], v[72:75], v[36:39], v[100:103]
    ds_read_b128 v[20:23], v8 offset:32768
    v_mfma_f32_16x16x32_bf16 v[116:119], v[76:79], v[36:39], v[116:119]
    ds_read_b64_tr_b16 v[56:57], v17 offset:49152
    v_mfma_f32_16x16x32_bf16 v[132:135], v[80:83], v[36:39], v[132:135]
    ds_read_b64_tr_b16 v[58:59], v17 offset:50176
    v_mfma_f32_16x16x32_bf16 v[88:91], v[68:71], v[40:43], v[88:91]
    ds_read_b128 v[24:27], v10 offset:32768
    v_mfma_f32_16x16x32_bf16 v[104:107], v[72:75], v[40:43], v[104:107]
    ds_read_b64_tr_b16 v[60:61], v18 offset:49152
    v_mfma_f32_16x16x32_bf16 v[120:123], v[76:79], v[40:43], v[120:123]
    ds_read_b64_tr_b16 v[62:63], v18 offset:50176
    v_mfma_f32_16x16x32_bf16 v[136:139], v[80:83], v[40:43], v[136:139]
    ds_read_b128 v[28:31], v12 offset:32768
    v_mfma_f32_16x16x32_bf16 v[92:95], v[68:71], v[44:47], v[92:95]
    ds_read_b64_tr_b16 v[64:65], v19 offset:49152
    v_mfma_f32_16x16x32_bf16 v[108:111], v[72:75], v[44:47], v[108:111]
    ds_read_b64_tr_b16 v[66:67], v19 offset:50176
    v_mfma_f32_16x16x32_bf16 v[124:127], v[76:79], v[44:47], v[124:127]
    ds_read_b128 v[32:35], v14 offset:32768
    v_mfma_f32_16x16x32_bf16 v[140:143], v[80:83], v[44:47], v[140:143]
    v_mfma_f32_16x16x32_bf16 v[96:99], v[68:71], v[48:51], v[96:99]
    v_mfma_f32_16x16x32_bf16 v[112:115], v[72:75], v[48:51], v[112:115]
    v_mfma_f32_16x16x32_bf16 v[128:131], v[76:79], v[48:51], v[128:131]
    v_mfma_f32_16x16x32_bf16 v[144:147], v[80:83], v[48:51], v[144:147]
    v_mfma_f32_16x16x32_bf16 v[148:151], v[68:71], v[156:159], v[148:151]
    v_mfma_f32_16x16x32_bf16 v[152:155], v[72:75], v[156:159], v[152:155]
    s_waitcnt lgkmcnt(0)
    ds_read_b64_tr_b16 v[68:69], v16 offset:57344
    v_mfma_f32_16x16x32_bf16 v[84:87], v[52:55], v[20:23], v[84:87]
    ds_read_b64_tr_b16 v[70:71], v16 offset:58368
    v_mfma_f32_16x16x32_bf16 v[100:103], v[56:59], v[20:23], v[100:103]
    ds_read_b128 v[36:39], v9 offset:32768
    v_mfma_f32_16x16x32_bf16 v[116:119], v[60:63], v[20:23], v[116:119]
    ds_read_b64_tr_b16 v[72:73], v17 offset:57344
    v_mfma_f32_16x16x32_bf16 v[132:135], v[64:67], v[20:23], v[132:135]
    ds_read_b64_tr_b16 v[74:75], v17 offset:58368
    v_mfma_f32_16x16x32_bf16 v[88:91], v[52:55], v[24:27], v[88:91]
    ds_read_b128 v[40:43], v11 offset:32768
    v_mfma_f32_16x16x32_bf16 v[104:107], v[56:59], v[24:27], v[104:107]
    ds_read_b64_tr_b16 v[76:77], v18 offset:57344
    v_mfma_f32_16x16x32_bf16 v[120:123], v[60:63], v[24:27], v[120:123]
    ds_read_b64_tr_b16 v[78:79], v18 offset:58368
    v_mfma_f32_16x16x32_bf16 v[136:139], v[64:67], v[24:27], v[136:139]
    ds_read_b128 v[44:47], v13 offset:32768
    v_mfma_f32_16x16x32_bf16 v[92:95], v[52:55], v[28:31], v[92:95]
    ds_read_b64_tr_b16 v[80:81], v19 offset:57344
    v_mfma_f32_16x16x32_bf16 v[108:111], v[56:59], v[28:31], v[108:111]
    ds_read_b64_tr_b16 v[82:83], v19 offset:58368
    v_mfma_f32_16x16x32_bf16 v[124:127], v[60:63], v[28:31], v[124:127]
    ds_read_b128 v[48:51], v15 offset:32768
    v_mfma_f32_16x16x32_bf16 v[140:143], v[64:67], v[28:31], v[140:143]
    v_mfma_f32_16x16x32_bf16 v[96:99], v[52:55], v[32:35], v[96:99]
    v_mfma_f32_16x16x32_bf16 v[112:115], v[56:59], v[32:35], v[112:115]
    v_mfma_f32_16x16x32_bf16 v[128:131], v[60:63], v[32:35], v[128:131]
    v_mfma_f32_16x16x32_bf16 v[144:147], v[64:67], v[32:35], v[144:147]
    v_mfma_f32_16x16x32_bf16 v[148:151], v[52:55], v[156:159], v[148:151]
    v_mfma_f32_16x16x32_bf16 v[152:155], v[56:59], v[156:159], v[152:155]
    s_waitcnt lgkmcnt(0)
    s_barrier
    v_add_u32 v8, 65536, v8
    v_add_u32 v9, 65536, v9
    v_add_u32 v10, 65536, v10
    v_add_u32 v11, 65536, v11
    v_add_u32 v12, 65536, v12
    v_add_u32 v13, 65536, v13
    v_add_u32 v14, 65536, v14
    v_add_u32 v15, 65536, v15
    v_add_u32 v16, 65536, v16
    v_add_u32 v17, 65536, v17
    v_add_u32 v18, 65536, v18
    v_add_u32 v19, 65536, v19
    ds_read_b64_tr_b16 v[52:53], v16 offset:16384
    v_mfma_f32_16x16x32_bf16 v[84:87], v[68:71], v[36:39], v[84:87]
    ds_read_b64_tr_b16 v[54:55], v16 offset:17408
    v_mfma_f32_16x16x32_bf16 v[100:103], v[72:75], v[36:39], v[100:103]
    ds_read_b128 v[20:23], v8 offset:0
    v_mfma_f32_16x16x32_bf16 v[116:119], v[76:79], v[36:39], v[116:119]
    ds_read_b64_tr_b16 v[56:57], v17 offset:16384
    v_mfma_f32_16x16x32_bf16 v[132:135], v[80:83], v[36:39], v[132:135]
    ds_read_b64_tr_b16 v[58:59], v17 offset:17408
    v_mfma_f32_16x16x32_bf16 v[88:91], v[68:71], v[40:43], v[88:91]
    ds_read_b128 v[24:27], v10 offset:0
    v_mfma_f32_16x16x32_bf16 v[104:107], v[72:75], v[40:43], v[104:107]
    ds_read_b64_tr_b16 v[60:61], v18 offset:16384
    v_mfma_f32_16x16x32_bf16 v[120:123], v[76:79], v[40:43], v[120:123]
    ds_read_b64_tr_b16 v[62:63], v18 offset:17408
    v_mfma_f32_16x16x32_bf16 v[136:139], v[80:83], v[40:43], v[136:139]
    ds_read_b128 v[28:31], v12 offset:0
    v_mfma_f32_16x16x32_bf16 v[92:95], v[68:71], v[44:47], v[92:95]
    ds_read_b64_tr_b16 v[64:65], v19 offset:16384
    v_mfma_f32_16x16x32_bf16 v[108:111], v[72:75], v[44:47], v[108:111]
    ds_read_b64_tr_b16 v[66:67], v19 offset:17408
    v_mfma_f32_16x16x32_bf16 v[124:127], v[76:79], v[44:47], v[124:127]
    ds_read_b128 v[32:35], v14 offset:0
    v_mfma_f32_16x16x32_bf16 v[140:143], v[80:83], v[44:47], v[140:143]
    v_mfma_f32_16x16x32_bf16 v[96:99], v[68:71], v[48:51], v[96:99]
    v_mfma_f32_16x16x32_bf16 v[112:115], v[72:75], v[48:51], v[112:115]
    v_mfma_f32_16x16x32_bf16 v[128:131], v[76:79], v[48:51], v[128:131]
    v_mfma_f32_16x16x32_bf16 v[144:147], v[80:83], v[48:51], v[144:147]
    v_mfma_f32_16x16x32_bf16 v[148:151], v[68:71], v[156:159], v[148:151]
    v_mfma_f32_16x16x32_bf16 v[152:155], v[72:75], v[156:159], v[152:155]
    s_waitcnt lgkmcnt(0)
    ds_read_b64_tr_b16 v[68:69], v16 offset:24576
    v_mfma_f32_16x16x32_bf16 v[84:87], v[52:55], v[20:23], v[84:87]
    ds_read_b64_tr_b16 v[70:71], v16 offset:25600
    v_mfma_f32_16x16x32_bf16 v[100:103], v[56:59], v[20:23], v[100:103]
    ds_read_b128 v[36:39], v9 offset:0
    v_mfma_f32_16x16x32_bf16 v[116:119], v[60:63], v[20:23], v[116:119]
    ds_read_b64_tr_b16 v[72:73], v17 offset:24576
    v_mfma_f32_16x16x32_bf16 v[132:135], v[64:67], v[20:23], v[132:135]
    ds_read_b64_tr_b16 v[74:75], v17 offset:25600
    v_mfma_f32_16x16x32_bf16 v[88:91], v[52:55], v[24:27], v[88:91]
    ds_read_b128 v[40:43], v11 offset:0
    v_mfma_f32_16x16x32_bf16 v[104:107], v[56:59], v[24:27], v[104:107]
    ds_read_b64_tr_b16 v[76:77], v18 offset:24576
    v_mfma_f32_16x16x32_bf16 v[120:123], v[60:63], v[24:27], v[120:123]
    ds_read_b64_tr_b16 v[78:79], v18 offset:25600
    v_mfma_f32_16x16x32_bf16 v[136:139], v[64:67], v[24:27], v[136:139]
    ds_read_b128 v[44:47], v13 offset:0
    v_mfma_f32_16x16x32_bf16 v[92:95], v[52:55], v[28:31], v[92:95]
    ds_read_b64_tr_b16 v[80:81], v19 offset:24576
    v_mfma_f32_16x16x32_bf16 v[108:111], v[56:59], v[28:31], v[108:111]
    ds_read_b64_tr_b16 v[82:83], v19 offset:25600
    v_mfma_f32_16x16x32_bf16 v[124:127], v[60:63], v[28:31], v[124:127]
    ds_read_b128 v[48:51], v15 offset:0
    v_mfma_f32_16x16x32_bf16 v[140:143], v[64:67], v[28:31], v[140:143]
    v_mfma_f32_16x16x32_bf16 v[96:99], v[52:55], v[32:35], v[96:99]
    v_mfma_f32_16x16x32_bf16 v[112:115], v[56:59], v[32:35], v[112:115]
    v_mfma_f32_16x16x32_bf16 v[128:131], v[60:63], v[32:35], v[128:131]
    v_mfma_f32_16x16x32_bf16 v[144:147], v[64:67], v[32:35], v[144:147]
    v_mfma_f32_16x16x32_bf16 v[148:151], v[52:55], v[156:159], v[148:151]
    v_mfma_f32_16x16x32_bf16 v[152:155], v[56:59], v[156:159], v[152:155]
    s_waitcnt lgkmcnt(0)
    s_barrier
    ds_read_b64_tr_b16 v[52:53], v16 offset:49152
    v_mfma_f32_16x16x32_bf16 v[84:87], v[68:71], v[36:39], v[84:87]
    ds_read_b64_tr_b16 v[54:55], v16 offset:50176
    v_mfma_f32_16x16x32_bf16 v[100:103], v[72:75], v[36:39], v[100:103]
    ds_read_b128 v[20:23], v8 offset:32768
    v_mfma_f32_16x16x32_bf16 v[116:119], v[76:79], v[36:39], v[116:119]
    ds_read_b64_tr_b16 v[56:57], v17 offset:49152
    v_mfma_f32_16x16x32_bf16 v[132:135], v[80:83], v[36:39], v[132:135]
    ds_read_b64_tr_b16 v[58:59], v17 offset:50176
    v_mfma_f32_16x16x32_bf16 v[88:91], v[68:71], v[40:43], v[88:91]
    ds_read_b128 v[24:27], v10 offset:32768
    v_mfma_f32_16x16x32_bf16 v[104:107], v[72:75], v[40:43], v[104:107]
    ds_read_b64_tr_b16 v[60:61], v18 offset:49152
    v_mfma_f32_16x16x32_bf16 v[120:123], v[76:79], v[40:43], v[120:123]
    ds_read_b64_tr_b16 v[62:63], v18 offset:50176
    v_mfma_f32_16x16x32_bf16 v[136:139], v[80:83], v[40:43], v[136:139]
    ds_read_b128 v[28:31], v12 offset:32768
    v_mfma_f32_16x16x32_bf16 v[92:95], v[68:71], v[44:47], v[92:95]
    ds_read_b64_tr_b16 v[64:65], v19 offset:49152
    v_mfma_f32_16x16x32_bf16 v[108:111], v[72:75], v[44:47], v[108:111]
    ds_read_b64_tr_b16 v[66:67], v19 offset:50176
    v_mfma_f32_16x16x32_bf16 v[124:127], v[76:79], v[44:47], v[124:127]
    ds_read_b128 v[32:35], v14 offset:32768
    v_mfma_f32_16x16x32_bf16 v[140:143], v[80:83], v[44:47], v[140:143]
    v_mfma_f32_16x16x32_bf16 v[96:99], v[68:71], v[48:51], v[96:99]
    v_mfma_f32_16x16x32_bf16 v[112:115], v[72:75], v[48:51], v[112:115]
    v_mfma_f32_16x16x32_bf16 v[128:131], v[76:79], v[48:51], v[128:131]
    v_mfma_f32_16x16x32_bf16 v[144:147], v[80:83], v[48:51], v[144:147]
    v_mfma_f32_16x16x32_bf16 v[148:151], v[68:71], v[156:159], v[148:151]
    v_mfma_f32_16x16x32_bf16 v[152:155], v[72:75], v[156:159], v[152:155]
    s_waitcnt lgkmcnt(0)
    ds_read_b64_tr_b16 v[68:69], v16 offset:57344
    v_mfma_f32_16x16x32_bf16 v[84:87], v[52:55], v[20:23], v[84:87]
    ds_read_b64_tr_b16 v[70:71], v16 offset:58368
    v_mfma_f32_16x16x32_bf16 v[100:103], v[56:59], v[20:23], v[100:103]
    ds_read_b128 v[36:39], v9 offset:32768
    v_mfma_f32_16x16x32_bf16 v[116:119], v[60:63], v[20:23], v[116:119]
    ds_read_b64_tr_b16 v[72:73], v17 offset:57344
    v_mfma_f32_16x16x32_bf16 v[132:135], v[64:67], v[20:23], v[132:135]
    ds_read_b64_tr_b16 v[74:75], v17 offset:58368
    v_mfma_f32_16x16x32_bf16 v[88:91], v[52:55], v[24:27], v[88:91]
    ds_read_b128 v[40:43], v11 offset:32768
    v_mfma_f32_16x16x32_bf16 v[104:107], v[56:59], v[24:27], v[104:107]
    ds_read_b64_tr_b16 v[76:77], v18 offset:57344
    v_mfma_f32_16x16x32_bf16 v[120:123], v[60:63], v[24:27], v[120:123]
    ds_read_b64_tr_b16 v[78:79], v18 offset:58368
    v_mfma_f32_16x16x32_bf16 v[136:139], v[64:67], v[24:27], v[136:139]
    ds_read_b128 v[44:47], v13 offset:32768
    v_mfma_f32_16x16x32_bf16 v[92:95], v[52:55], v[28:31], v[92:95]
    ds_read_b64_tr_b16 v[80:81], v19 offset:57344
    v_mfma_f32_16x16x32_bf16 v[108:111], v[56:59], v[28:31], v[108:111]
    ds_read_b64_tr_b16 v[82:83], v19 offset:58368
    v_mfma_f32_16x16x32_bf16 v[124:127], v[60:63], v[28:31], v[124:127]
    ds_read_b128 v[48:51], v15 offset:32768
    v_mfma_f32_16x16x32_bf16 v[140:143], v[64:67], v[28:31], v[140:143]
    v_mfma_f32_16x16x32_bf16 v[96:99], v[52:55], v[32:35], v[96:99]
    v_mfma_f32_16x16x32_bf16 v[112:115], v[56:59], v[32:35], v[112:115]
    v_mfma_f32_16x16x32_bf16 v[128:131], v[60:63], v[32:35], v[128:131]
    v_mfma_f32_16x16x32_bf16 v[144:147], v[64:67], v[32:35], v[144:147]
    v_mfma_f32_16x16x32_bf16 v[148:151], v[52:55], v[156:159], v[148:151]
    v_mfma_f32_16x16x32_bf16 v[152:155], v[56:59], v[156:159], v[152:155]
    s_waitcnt lgkmcnt(0)
    s_barrier
    v_add_u32 v8, 4294901760, v8
    v_add_u32 v9, 4294901760, v9
    v_add_u32 v10, 4294901760, v10
    v_add_u32 v11, 4294901760, v11
    v_add_u32 v12, 4294901760, v12
    v_add_u32 v13, 4294901760, v13
    v_add_u32 v14, 4294901760, v14
    v_add_u32 v15, 4294901760, v15
    v_add_u32 v16, 4294901760, v16
    v_add_u32 v17, 4294901760, v17
    v_add_u32 v18, 4294901760, v18
    v_add_u32 v19, 4294901760, v19
    ds_read_b64_tr_b16 v[52:53], v16 offset:16384
    v_mfma_f32_16x16x32_bf16 v[84:87], v[68:71], v[36:39], v[84:87]
    ds_read_b64_tr_b16 v[54:55], v16 offset:17408
    v_mfma_f32_16x16x32_bf16 v[100:103], v[72:75], v[36:39], v[100:103]
    ds_read_b128 v[20:23], v8 offset:0
    v_mfma_f32_16x16x32_bf16 v[116:119], v[76:79], v[36:39], v[116:119]
    ds_read_b64_tr_b16 v[56:57], v17 offset:16384
    v_mfma_f32_16x16x32_bf16 v[132:135], v[80:83], v[36:39], v[132:135]
    ds_read_b64_tr_b16 v[58:59], v17 offset:17408
    v_mfma_f32_16x16x32_bf16 v[88:91], v[68:71], v[40:43], v[88:91]
    ds_read_b128 v[24:27], v10 offset:0
    v_mfma_f32_16x16x32_bf16 v[104:107], v[72:75], v[40:43], v[104:107]
    ds_read_b64_tr_b16 v[60:61], v18 offset:16384
    v_mfma_f32_16x16x32_bf16 v[120:123], v[76:79], v[40:43], v[120:123]
    ds_read_b64_tr_b16 v[62:63], v18 offset:17408
    v_mfma_f32_16x16x32_bf16 v[136:139], v[80:83], v[40:43], v[136:139]
    ds_read_b128 v[28:31], v12 offset:0
    v_mfma_f32_16x16x32_bf16 v[92:95], v[68:71], v[44:47], v[92:95]
    ds_read_b64_tr_b16 v[64:65], v19 offset:16384
    v_mfma_f32_16x16x32_bf16 v[108:111], v[72:75], v[44:47], v[108:111]
    ds_read_b64_tr_b16 v[66:67], v19 offset:17408
    v_mfma_f32_16x16x32_bf16 v[124:127], v[76:79], v[44:47], v[124:127]
    ds_read_b128 v[32:35], v14 offset:0
    v_mfma_f32_16x16x32_bf16 v[140:143], v[80:83], v[44:47], v[140:143]
    v_mfma_f32_16x16x32_bf16 v[96:99], v[68:71], v[48:51], v[96:99]
    v_mfma_f32_16x16x32_bf16 v[112:115], v[72:75], v[48:51], v[112:115]
    v_mfma_f32_16x16x32_bf16 v[128:131], v[76:79], v[48:51], v[128:131]
    v_mfma_f32_16x16x32_bf16 v[144:147], v[80:83], v[48:51], v[144:147]
    v_mfma_f32_16x16x32_bf16 v[148:151], v[68:71], v[156:159], v[148:151]
    v_mfma_f32_16x16x32_bf16 v[152:155], v[72:75], v[156:159], v[152:155]
    s_waitcnt lgkmcnt(0)
    ds_read_b64_tr_b16 v[68:69], v16 offset:24576
    v_mfma_f32_16x16x32_bf16 v[84:87], v[52:55], v[20:23], v[84:87]
    ds_read_b64_tr_b16 v[70:71], v16 offset:25600
    v_mfma_f32_16x16x32_bf16 v[100:103], v[56:59], v[20:23], v[100:103]
    ds_read_b128 v[36:39], v9 offset:0
    v_mfma_f32_16x16x32_bf16 v[116:119], v[60:63], v[20:23], v[116:119]
    ds_read_b64_tr_b16 v[72:73], v17 offset:24576
    v_mfma_f32_16x16x32_bf16 v[132:135], v[64:67], v[20:23], v[132:135]
    ds_read_b64_tr_b16 v[74:75], v17 offset:25600
    v_mfma_f32_16x16x32_bf16 v[88:91], v[52:55], v[24:27], v[88:91]
    ds_read_b128 v[40:43], v11 offset:0
    v_mfma_f32_16x16x32_bf16 v[104:107], v[56:59], v[24:27], v[104:107]
    ds_read_b64_tr_b16 v[76:77], v18 offset:24576
    v_mfma_f32_16x16x32_bf16 v[120:123], v[60:63], v[24:27], v[120:123]
    ds_read_b64_tr_b16 v[78:79], v18 offset:25600
    v_mfma_f32_16x16x32_bf16 v[136:139], v[64:67], v[24:27], v[136:139]
    ds_read_b128 v[44:47], v13 offset:0
    v_mfma_f32_16x16x32_bf16 v[92:95], v[52:55], v[28:31], v[92:95]
    ds_read_b64_tr_b16 v[80:81], v19 offset:24576
    v_mfma_f32_16x16x32_bf16 v[108:111], v[56:59], v[28:31], v[108:111]
    ds_read_b64_tr_b16 v[82:83], v19 offset:25600
    v_mfma_f32_16x16x32_bf16 v[124:127], v[60:63], v[28:31], v[124:127]
    ds_read_b128 v[48:51], v15 offset:0
    v_mfma_f32_16x16x32_bf16 v[140:143], v[64:67], v[28:31], v[140:143]
    v_mfma_f32_16x16x32_bf16 v[96:99], v[52:55], v[32:35], v[96:99]
    v_mfma_f32_16x16x32_bf16 v[112:115], v[56:59], v[32:35], v[112:115]
    v_mfma_f32_16x16x32_bf16 v[128:131], v[60:63], v[32:35], v[128:131]
    v_mfma_f32_16x16x32_bf16 v[144:147], v[64:67], v[32:35], v[144:147]
    v_mfma_f32_16x16x32_bf16 v[148:151], v[52:55], v[156:159], v[148:151]
    v_mfma_f32_16x16x32_bf16 v[152:155], v[56:59], v[156:159], v[152:155]
    s_waitcnt lgkmcnt(0)
    s_barrier
    ds_read_b64_tr_b16 v[52:53], v16 offset:49152
    v_mfma_f32_16x16x32_bf16 v[84:87], v[68:71], v[36:39], v[84:87]
    ds_read_b64_tr_b16 v[54:55], v16 offset:50176
    v_mfma_f32_16x16x32_bf16 v[100:103], v[72:75], v[36:39], v[100:103]
    ds_read_b128 v[20:23], v8 offset:32768
    v_mfma_f32_16x16x32_bf16 v[116:119], v[76:79], v[36:39], v[116:119]
    ds_read_b64_tr_b16 v[56:57], v17 offset:49152
    v_mfma_f32_16x16x32_bf16 v[132:135], v[80:83], v[36:39], v[132:135]
    ds_read_b64_tr_b16 v[58:59], v17 offset:50176
    v_mfma_f32_16x16x32_bf16 v[88:91], v[68:71], v[40:43], v[88:91]
    ds_read_b128 v[24:27], v10 offset:32768
    v_mfma_f32_16x16x32_bf16 v[104:107], v[72:75], v[40:43], v[104:107]
    ds_read_b64_tr_b16 v[60:61], v18 offset:49152
    v_mfma_f32_16x16x32_bf16 v[120:123], v[76:79], v[40:43], v[120:123]
    ds_read_b64_tr_b16 v[62:63], v18 offset:50176
    v_mfma_f32_16x16x32_bf16 v[136:139], v[80:83], v[40:43], v[136:139]
    ds_read_b128 v[28:31], v12 offset:32768
    v_mfma_f32_16x16x32_bf16 v[92:95], v[68:71], v[44:47], v[92:95]
    ds_read_b64_tr_b16 v[64:65], v19 offset:49152
    v_mfma_f32_16x16x32_bf16 v[108:111], v[72:75], v[44:47], v[108:111]
    ds_read_b64_tr_b16 v[66:67], v19 offset:50176
    v_mfma_f32_16x16x32_bf16 v[124:127], v[76:79], v[44:47], v[124:127]
    ds_read_b128 v[32:35], v14 offset:32768
    v_mfma_f32_16x16x32_bf16 v[140:143], v[80:83], v[44:47], v[140:143]
    v_mfma_f32_16x16x32_bf16 v[96:99], v[68:71], v[48:51], v[96:99]
    v_mfma_f32_16x16x32_bf16 v[112:115], v[72:75], v[48:51], v[112:115]
    v_mfma_f32_16x16x32_bf16 v[128:131], v[76:79], v[48:51], v[128:131]
    v_mfma_f32_16x16x32_bf16 v[144:147], v[80:83], v[48:51], v[144:147]
    v_mfma_f32_16x16x32_bf16 v[148:151], v[68:71], v[156:159], v[148:151]
    v_mfma_f32_16x16x32_bf16 v[152:155], v[72:75], v[156:159], v[152:155]
    s_waitcnt lgkmcnt(0)
    ds_read_b64_tr_b16 v[68:69], v16 offset:57344
    v_mfma_f32_16x16x32_bf16 v[84:87], v[52:55], v[20:23], v[84:87]
    ds_read_b64_tr_b16 v[70:71], v16 offset:58368
    v_mfma_f32_16x16x32_bf16 v[100:103], v[56:59], v[20:23], v[100:103]
    ds_read_b128 v[36:39], v9 offset:32768
    v_mfma_f32_16x16x32_bf16 v[116:119], v[60:63], v[20:23], v[116:119]
    ds_read_b64_tr_b16 v[72:73], v17 offset:57344
    v_mfma_f32_16x16x32_bf16 v[132:135], v[64:67], v[20:23], v[132:135]
    ds_read_b64_tr_b16 v[74:75], v17 offset:58368
    v_mfma_f32_16x16x32_bf16 v[88:91], v[52:55], v[24:27], v[88:91]
    ds_read_b128 v[40:43], v11 offset:32768
    v_mfma_f32_16x16x32_bf16 v[104:107], v[56:59], v[24:27], v[104:107]
    ds_read_b64_tr_b16 v[76:77], v18 offset:57344
    v_mfma_f32_16x16x32_bf16 v[120:123], v[60:63], v[24:27], v[120:123]
    ds_read_b64_tr_b16 v[78:79], v18 offset:58368
    v_mfma_f32_16x16x32_bf16 v[136:139], v[64:67], v[24:27], v[136:139]
    ds_read_b128 v[44:47], v13 offset:32768
    v_mfma_f32_16x16x32_bf16 v[92:95], v[52:55], v[28:31], v[92:95]
    ds_read_b64_tr_b16 v[80:81], v19 offset:57344
    v_mfma_f32_16x16x32_bf16 v[108:111], v[56:59], v[28:31], v[108:111]
    ds_read_b64_tr_b16 v[82:83], v19 offset:58368
    v_mfma_f32_16x16x32_bf16 v[124:127], v[60:63], v[28:31], v[124:127]
    ds_read_b128 v[48:51], v15 offset:32768
    v_mfma_f32_16x16x32_bf16 v[140:143], v[64:67], v[28:31], v[140:143]
    v_mfma_f32_16x16x32_bf16 v[96:99], v[52:55], v[32:35], v[96:99]
    v_mfma_f32_16x16x32_bf16 v[112:115], v[56:59], v[32:35], v[112:115]
    v_mfma_f32_16x16x32_bf16 v[128:131], v[60:63], v[32:35], v[128:131]
    v_mfma_f32_16x16x32_bf16 v[144:147], v[64:67], v[32:35], v[144:147]
    v_mfma_f32_16x16x32_bf16 v[148:151], v[52:55], v[156:159], v[148:151]
    v_mfma_f32_16x16x32_bf16 v[152:155], v[56:59], v[156:159], v[152:155]
    s_waitcnt lgkmcnt(0)
    v_mfma_f32_16x16x32_bf16 v[84:87], v[68:71], v[36:39], v[84:87]
    v_mfma_f32_16x16x32_bf16 v[100:103], v[72:75], v[36:39], v[100:103]
    v_mfma_f32_16x16x32_bf16 v[116:119], v[76:79], v[36:39], v[116:119]
    v_mfma_f32_16x16x32_bf16 v[132:135], v[80:83], v[36:39], v[132:135]
    v_mfma_f32_16x16x32_bf16 v[88:91], v[68:71], v[40:43], v[88:91]
    v_mfma_f32_16x16x32_bf16 v[104:107], v[72:75], v[40:43], v[104:107]
    v_mfma_f32_16x16x32_bf16 v[120:123], v[76:79], v[40:43], v[120:123]
    v_mfma_f32_16x16x32_bf16 v[136:139], v[80:83], v[40:43], v[136:139]
    v_mfma_f32_16x16x32_bf16 v[92:95], v[68:71], v[44:47], v[92:95]
    v_mfma_f32_16x16x32_bf16 v[108:111], v[72:75], v[44:47], v[108:111]
    v_mfma_f32_16x16x32_bf16 v[124:127], v[76:79], v[44:47], v[124:127]
    v_mfma_f32_16x16x32_bf16 v[140:143], v[80:83], v[44:47], v[140:143]
    v_mfma_f32_16x16x32_bf16 v[96:99], v[68:71], v[48:51], v[96:99]
    v_mfma_f32_16x16x32_bf16 v[112:115], v[72:75], v[48:51], v[112:115]
    v_mfma_f32_16x16x32_bf16 v[128:131], v[76:79], v[48:51], v[128:131]
    v_mfma_f32_16x16x32_bf16 v[144:147], v[80:83], v[48:51], v[144:147]
    v_mfma_f32_16x16x32_bf16 v[148:151], v[68:71], v[156:159], v[148:151]
    v_mfma_f32_16x16x32_bf16 v[152:155], v[72:75], v[156:159], v[152:155]
    s_nop 9
    s_lshl_b32 s3, s51, 6
    v_lshlrev_b32 v6, 4, v4
    v_add_u32 v6, s3, v6
    v_add_u32 v6, 0, v6
    ds_write_b128 v6, v[148:151]
    s_lshl_b32 s3, s52, 6
    v_lshlrev_b32 v6, 4, v4
    v_add_u32 v6, s3, v6
    v_add_u32 v6, 0, v6
    ds_write_b128 v6, v[152:155]
    s_waitcnt lgkmcnt(0)
    s_barrier
    s_mov_b32 s44, s24
    s_and_b32 s45, s25, 0xffff
    s_mov_b32 s46, 7864320
    s_mov_b32 s47, 0x20000
    s_lshl_b32 s27, s51, 6
    v_lshlrev_b32 v6, 4, v4
    v_add_u32 v6, s27, v6
    v_add_u32 v6, 0, v6
    ds_read_b128 v[20:23], v6
    s_lshl_b32 s27, s52, 6
    v_lshlrev_b32 v6, 4, v4
    v_add_u32 v6, s27, v6
    v_add_u32 v6, 0, v6
    ds_read_b128 v[24:27], v6
    s_lshl_b32 s27, s53, 6
    v_lshlrev_b32 v6, 4, v4
    v_add_u32 v6, s27, v6
    v_add_u32 v6, 0, v6
    ds_read_b128 v[28:31], v6
    s_lshl_b32 s27, s54, 6
    v_lshlrev_b32 v6, 4, v4
    v_add_u32 v6, s27, v6
    v_add_u32 v6, 0, v6
    ds_read_b128 v[32:35], v6
    s_lshl_b32 s3, s55, 7
    s_add_u32 s3, s3, 1024
    v_lshlrev_b32 v5, 3, v3
    v_add_u32 v5, s3, v5
    ds_read_b64 v[36:37], v5
    s_lshl_b32 s3, s30, 7
    s_lshl_b32 s27, s55, 4
    s_add_u32 s3, s3, s27
    v_add_u32 v5, s3, v3
    v_lshlrev_b32 v44, 4, v5
    s_lshl_b32 s3, s56, 7
    s_add_u32 s3, s3, 1024
    v_lshlrev_b32 v5, 3, v3
    v_add_u32 v5, s3, v5
    ds_read_b64 v[38:39], v5
    s_lshl_b32 s3, s30, 7
    s_lshl_b32 s27, s56, 4
    s_add_u32 s3, s3, s27
    v_add_u32 v5, s3, v3
    v_lshlrev_b32 v45, 4, v5
    s_lshl_b32 s3, s57, 7
    s_add_u32 s3, s3, 1024
    v_lshlrev_b32 v5, 3, v3
    v_add_u32 v5, s3, v5
    ds_read_b64 v[40:41], v5
    s_lshl_b32 s3, s30, 7
    s_lshl_b32 s27, s57, 4
    s_add_u32 s3, s3, s27
    v_add_u32 v5, s3, v3
    v_lshlrev_b32 v46, 4, v5
    s_lshl_b32 s3, s58, 7
    s_add_u32 s3, s3, 1024
    v_lshlrev_b32 v5, 3, v3
    v_add_u32 v5, s3, v5
    ds_read_b64 v[42:43], v5
    s_lshl_b32 s3, s30, 7
    s_lshl_b32 s27, s58, 4
    s_add_u32 s3, s3, s27
    v_add_u32 v5, s3, v3
    v_lshlrev_b32 v47, 4, v5
    s_lshl_b32 s3, s51, 1
    s_lshl_b32 s27, s31, 4
    s_add_u32 s3, s3, s27
    v_lshrrev_b32 v5, 1, v4
    v_add_u32 v5, s3, v5
    v_cmp_gt_u32 vcc, 80, v5
    v_mov_b32 v7, 0x3ea52b5c
    v_mov_b32 v48, 1.0
    s_nop 0
    v_cndmask_b32 v48, v48, v7, vcc
    s_lshl_b32 s3, s52, 1
    s_lshl_b32 s27, s31, 4
    s_add_u32 s3, s3, s27
    v_lshrrev_b32 v5, 1, v4
    v_add_u32 v5, s3, v5
    v_cmp_gt_u32 vcc, 80, v5
    v_mov_b32 v7, 0x3ea52b5c
    v_mov_b32 v49, 1.0
    s_nop 0
    v_cndmask_b32 v49, v49, v7, vcc
    s_lshl_b32 s3, s53, 1
    s_lshl_b32 s27, s31, 4
    s_add_u32 s3, s3, s27
    v_lshrrev_b32 v5, 1, v4
    v_add_u32 v5, s3, v5
    v_cmp_gt_u32 vcc, 80, v5
    v_mov_b32 v7, 0x3ea52b5c
    v_mov_b32 v50, 1.0
    s_nop 0
    v_cndmask_b32 v50, v50, v7, vcc
    s_lshl_b32 s3, s54, 1
    s_lshl_b32 s27, s31, 4
    s_add_u32 s3, s3, s27
    v_lshrrev_b32 v5, 1, v4
    v_add_u32 v5, s3, v5
    v_cmp_gt_u32 vcc, 80, v5
    v_mov_b32 v7, 0x3ea52b5c
    v_mov_b32 v51, 1.0
    s_nop 0
    v_cndmask_b32 v51, v51, v7, vcc
    s_lshl_b32 s3, s51, 1
    s_lshl_b32 s27, s52, 1
    v_mov_b32 v5, s3
    v_mov_b32 v6, s27
    v_and_b32 v7, 1, v4
    v_cmp_eq_u32 vcc, 1, v7
    v_lshrrev_b32 v7, 1, v4
    s_nop 0
    v_cndmask_b32 v5, v5, v6, vcc
    s_lshl_b32 s27, s31, 4
    v_add3_u32 v5, v5, v7, s27
    v_lshlrev_b32 v164, 15, v5
    s_lshl_b32 s3, s53, 1
    s_lshl_b32 s27, s54, 1
    v_mov_b32 v5, s3
    v_mov_b32 v6, s27
    v_and_b32 v7, 1, v4
    v_cmp_eq_u32 vcc, 1, v7
    v_lshrrev_b32 v7, 1, v4
    s_nop 0
    v_cndmask_b32 v5, v5, v6, vcc
    s_lshl_b32 s27, s31, 4
    v_add3_u32 v5, v5, v7, s27
    v_lshlrev_b32 v165, 15, v5
    s_waitcnt lgkmcnt(0)
    v_mul_f32 v36, 0x3acccccd, v36
    v_mul_f32 v37, 0x3acccccd, v37
    v_fma_f32 v37, -v36, v36, v37
    v_max_f32 v37, 0, v37
    v_add_f32 v37, 0x3727c5ac, v37
    v_rsq_f32 v37, v37
    v_mul_f32 v38, 0x3acccccd, v38
    v_mul_f32 v39, 0x3acccccd, v39
    v_fma_f32 v39, -v38, v38, v39
    v_max_f32 v39, 0, v39
    v_add_f32 v39, 0x3727c5ac, v39
    v_rsq_f32 v39, v39
    v_mul_f32 v40, 0x3acccccd, v40
    v_mul_f32 v41, 0x3acccccd, v41
    v_fma_f32 v41, -v40, v40, v41
    v_max_f32 v41, 0, v41
    v_add_f32 v41, 0x3727c5ac, v41
    v_rsq_f32 v41, v41
    v_mul_f32 v42, 0x3acccccd, v42
    v_mul_f32 v43, 0x3acccccd, v43
    v_fma_f32 v43, -v42, v42, v43
    v_max_f32 v43, 0, v43
    v_add_f32 v43, 0x3727c5ac, v43
    v_rsq_f32 v43, v43
    s_nop 0
    v_mul_f32 v160, v37, v48
    v_fma_f32 v84, -v36, v20, v84
    v_fma_f32 v85, -v36, v21, v85
    v_fma_f32 v86, -v36, v22, v86
    v_fma_f32 v87, -v36, v23, v87
    v_mul_f32 v84, v84, v160
    v_mul_f32 v85, v85, v160
    v_mul_f32 v86, v86, v160
    v_mul_f32 v87, v87, v160
    v_mul_f32 v160, v37, v49
    v_fma_f32 v100, -v36, v24, v100
    v_fma_f32 v101, -v36, v25, v101
    v_fma_f32 v102, -v36, v26, v102
    v_fma_f32 v103, -v36, v27, v103
    v_mul_f32 v100, v100, v160
    v_mul_f32 v101, v101, v160
    v_mul_f32 v102, v102, v160
    v_mul_f32 v103, v103, v160
    v_add_u32 v60, v164, v44
    v_cvt_pk_bf16_f32 v52, v84, v85
    v_cvt_pk_bf16_f32 v53, v86, v87
    v_cvt_pk_bf16_f32 v54, v100, v101
    v_cvt_pk_bf16_f32 v55, v102, v103
    s_nop 1
    v_permlane16_swap_b32 v52, v54
    v_permlane16_swap_b32 v53, v55
    s_nop 1
    buffer_store_dwordx4 v[52:55], v60, s[44:47], 0 offen sc1
    v_mul_f32 v160, v39, v48
    v_fma_f32 v88, -v38, v20, v88
    v_fma_f32 v89, -v38, v21, v89
    v_fma_f32 v90, -v38, v22, v90
    v_fma_f32 v91, -v38, v23, v91
    v_mul_f32 v88, v88, v160
    v_mul_f32 v89, v89, v160
    v_mul_f32 v90, v90, v160
    v_mul_f32 v91, v91, v160
    v_mul_f32 v160, v39, v49
    v_fma_f32 v104, -v38, v24, v104
    v_fma_f32 v105, -v38, v25, v105
    v_fma_f32 v106, -v38, v26, v106
    v_fma_f32 v107, -v38, v27, v107
    v_mul_f32 v104, v104, v160
    v_mul_f32 v105, v105, v160
    v_mul_f32 v106, v106, v160
    v_mul_f32 v107, v107, v160
    v_add_u32 v61, v164, v45
    v_cvt_pk_bf16_f32 v56, v88, v89
    v_cvt_pk_bf16_f32 v57, v90, v91
    v_cvt_pk_bf16_f32 v58, v104, v105
    v_cvt_pk_bf16_f32 v59, v106, v107
    s_nop 1
    v_permlane16_swap_b32 v56, v58
    v_permlane16_swap_b32 v57, v59
    s_nop 1
    buffer_store_dwordx4 v[56:59], v61, s[44:47], 0 offen sc1
    v_mul_f32 v160, v41, v48
    v_fma_f32 v92, -v40, v20, v92
    v_fma_f32 v93, -v40, v21, v93
    v_fma_f32 v94, -v40, v22, v94
    v_fma_f32 v95, -v40, v23, v95
    v_mul_f32 v92, v92, v160
    v_mul_f32 v93, v93, v160
    v_mul_f32 v94, v94, v160
    v_mul_f32 v95, v95, v160
    v_mul_f32 v160, v41, v49
    v_fma_f32 v108, -v40, v24, v108
    v_fma_f32 v109, -v40, v25, v109
    v_fma_f32 v110, -v40, v26, v110
    v_fma_f32 v111, -v40, v27, v111
    v_mul_f32 v108, v108, v160
    v_mul_f32 v109, v109, v160
    v_mul_f32 v110, v110, v160
    v_mul_f32 v111, v111, v160
    v_add_u32 v60, v164, v46
    v_cvt_pk_bf16_f32 v52, v92, v93
    v_cvt_pk_bf16_f32 v53, v94, v95
    v_cvt_pk_bf16_f32 v54, v108, v109
    v_cvt_pk_bf16_f32 v55, v110, v111
    s_nop 1
    v_permlane16_swap_b32 v52, v54
    v_permlane16_swap_b32 v53, v55
    s_nop 1
    buffer_store_dwordx4 v[52:55], v60, s[44:47], 0 offen sc1
    v_mul_f32 v160, v43, v48
    v_fma_f32 v96, -v42, v20, v96
    v_fma_f32 v97, -v42, v21, v97
    v_fma_f32 v98, -v42, v22, v98
    v_fma_f32 v99, -v42, v23, v99
    v_mul_f32 v96, v96, v160
    v_mul_f32 v97, v97, v160
    v_mul_f32 v98, v98, v160
    v_mul_f32 v99, v99, v160
    v_mul_f32 v160, v43, v49
    v_fma_f32 v112, -v42, v24, v112
    v_fma_f32 v113, -v42, v25, v113
    v_fma_f32 v114, -v42, v26, v114
    v_fma_f32 v115, -v42, v27, v115
    v_mul_f32 v112, v112, v160
    v_mul_f32 v113, v113, v160
    v_mul_f32 v114, v114, v160
    v_mul_f32 v115, v115, v160
    v_add_u32 v61, v164, v47
    v_cvt_pk_bf16_f32 v56, v96, v97
    v_cvt_pk_bf16_f32 v57, v98, v99
    v_cvt_pk_bf16_f32 v58, v112, v113
    v_cvt_pk_bf16_f32 v59, v114, v115
    s_nop 1
    v_permlane16_swap_b32 v56, v58
    v_permlane16_swap_b32 v57, v59
    s_nop 1
    buffer_store_dwordx4 v[56:59], v61, s[44:47], 0 offen sc1
    v_mul_f32 v160, v37, v50
    v_fma_f32 v116, -v36, v28, v116
    v_fma_f32 v117, -v36, v29, v117
    v_fma_f32 v118, -v36, v30, v118
    v_fma_f32 v119, -v36, v31, v119
    v_mul_f32 v116, v116, v160
    v_mul_f32 v117, v117, v160
    v_mul_f32 v118, v118, v160
    v_mul_f32 v119, v119, v160
    v_mul_f32 v160, v37, v51
    v_fma_f32 v132, -v36, v32, v132
    v_fma_f32 v133, -v36, v33, v133
    v_fma_f32 v134, -v36, v34, v134
    v_fma_f32 v135, -v36, v35, v135
    v_mul_f32 v132, v132, v160
    v_mul_f32 v133, v133, v160
    v_mul_f32 v134, v134, v160
    v_mul_f32 v135, v135, v160
    v_add_u32 v60, v165, v44
    v_cvt_pk_bf16_f32 v52, v116, v117
    v_cvt_pk_bf16_f32 v53, v118, v119
    v_cvt_pk_bf16_f32 v54, v132, v133
    v_cvt_pk_bf16_f32 v55, v134, v135
    s_nop 1
    v_permlane16_swap_b32 v52, v54
    v_permlane16_swap_b32 v53, v55
    s_nop 1
    buffer_store_dwordx4 v[52:55], v60, s[44:47], 0 offen sc1
    v_mul_f32 v160, v39, v50
    v_fma_f32 v120, -v38, v28, v120
    v_fma_f32 v121, -v38, v29, v121
    v_fma_f32 v122, -v38, v30, v122
    v_fma_f32 v123, -v38, v31, v123
    v_mul_f32 v120, v120, v160
    v_mul_f32 v121, v121, v160
    v_mul_f32 v122, v122, v160
    v_mul_f32 v123, v123, v160
    v_mul_f32 v160, v39, v51
    v_fma_f32 v136, -v38, v32, v136
    v_fma_f32 v137, -v38, v33, v137
    v_fma_f32 v138, -v38, v34, v138
    v_fma_f32 v139, -v38, v35, v139
    v_mul_f32 v136, v136, v160
    v_mul_f32 v137, v137, v160
    v_mul_f32 v138, v138, v160
    v_mul_f32 v139, v139, v160
    v_add_u32 v61, v165, v45
    v_cvt_pk_bf16_f32 v56, v120, v121
    v_cvt_pk_bf16_f32 v57, v122, v123
    v_cvt_pk_bf16_f32 v58, v136, v137
    v_cvt_pk_bf16_f32 v59, v138, v139
    s_nop 1
    v_permlane16_swap_b32 v56, v58
    v_permlane16_swap_b32 v57, v59
    s_nop 1
    buffer_store_dwordx4 v[56:59], v61, s[44:47], 0 offen sc1
    v_mul_f32 v160, v41, v50
    v_fma_f32 v124, -v40, v28, v124
    v_fma_f32 v125, -v40, v29, v125
    v_fma_f32 v126, -v40, v30, v126
    v_fma_f32 v127, -v40, v31, v127
    v_mul_f32 v124, v124, v160
    v_mul_f32 v125, v125, v160
    v_mul_f32 v126, v126, v160
    v_mul_f32 v127, v127, v160
    v_mul_f32 v160, v41, v51
    v_fma_f32 v140, -v40, v32, v140
    v_fma_f32 v141, -v40, v33, v141
    v_fma_f32 v142, -v40, v34, v142
    v_fma_f32 v143, -v40, v35, v143
    v_mul_f32 v140, v140, v160
    v_mul_f32 v141, v141, v160
    v_mul_f32 v142, v142, v160
    v_mul_f32 v143, v143, v160
    v_add_u32 v60, v165, v46
    v_cvt_pk_bf16_f32 v52, v124, v125
    v_cvt_pk_bf16_f32 v53, v126, v127
    v_cvt_pk_bf16_f32 v54, v140, v141
    v_cvt_pk_bf16_f32 v55, v142, v143
    s_nop 1
    v_permlane16_swap_b32 v52, v54
    v_permlane16_swap_b32 v53, v55
    s_nop 1
    buffer_store_dwordx4 v[52:55], v60, s[44:47], 0 offen sc1
    v_mul_f32 v160, v43, v50
    v_fma_f32 v128, -v42, v28, v128
    v_fma_f32 v129, -v42, v29, v129
    v_fma_f32 v130, -v42, v30, v130
    v_fma_f32 v131, -v42, v31, v131
    v_mul_f32 v128, v128, v160
    v_mul_f32 v129, v129, v160
    v_mul_f32 v130, v130, v160
    v_mul_f32 v131, v131, v160
    v_mul_f32 v160, v43, v51
    v_fma_f32 v144, -v42, v32, v144
    v_fma_f32 v145, -v42, v33, v145
    v_fma_f32 v146, -v42, v34, v146
    v_fma_f32 v147, -v42, v35, v147
    v_mul_f32 v144, v144, v160
    v_mul_f32 v145, v145, v160
    v_mul_f32 v146, v146, v160
    v_mul_f32 v147, v147, v160
    v_add_u32 v61, v165, v47
    v_cvt_pk_bf16_f32 v56, v128, v129
    v_cvt_pk_bf16_f32 v57, v130, v131
    v_cvt_pk_bf16_f32 v58, v144, v145
    v_cvt_pk_bf16_f32 v59, v146, v147
    s_nop 1
    v_permlane16_swap_b32 v56, v58
    v_permlane16_swap_b32 v57, v59
    s_nop 1
    buffer_store_dwordx4 v[56:59], v61, s[44:47], 0 offen sc1
k1_qkv_kernel_p1end6:
k1_qkv_kernel_end1:
    s_endpgm
.globl k2_attn_kernel
.p2align 8
.type k2_attn_kernel,@function
k2_attn_kernel:
    s_cmp_ge_u32 s2, 256
    s_cbranch_scc1 k2_attn_kernel_end1
    s_load_dwordx16 s[4:19], s[0:1], 0
    s_load_dwordx4 s[20:23], s[0:1], 64
    s_load_dwordx2 s[24:25], s[0:1], 80
    v_lshrrev_b32 v5, 6, v0
    v_and_b32 v2, 63, v0
    v_readfirstlane_b32 s26, v5
    v_and_b32 v3, 15, v2
    v_lshrrev_b32 v4, 4, v2
    s_and_b32 s29, s26, 3
    s_and_b32 s27, s2, 7
    s_lshr_b32 s28, s2, 3
    s_and_b32 s3, s28, 1
    s_lshl_b32 s3, s3, 3
    s_add_u32 s31, s27, s3
    s_lshr_b32 s30, s28, 1
    v_and_b32 v8, 31, v2
    v_lshrrev_b32 v9, 5, v2
    s_mov_b32 s35, s30
    s_mov_b32 s34, s31
    s_and_b32 s32, s26, 1
    s_lshr_b32 s33, s26, 1
    v_mov_b32 v12, 0x3f803f80
    v_mov_b32 v13, 0x3f803f80
    v_mov_b32 v14, 0x3f803f80
    v_mov_b32 v15, 0x3f803f80
    v_lshlrev_b32 v5, 4, v0
    v_add_u32 v5, 64192, v5
    v_cmp_gt_u32 vcc, 384, v0
    s_and_saveexec_b64 s[48:49], vcc
    s_cbranch_execz k2_attn_kernel_sk2
    ds_write_b128 v5, v[12:15]
k2_attn_kernel_sk2:
    s_mov_b64 exec, s[48:49]
    s_waitcnt lgkmcnt(0)
    s_mov_b32 s52, s24
    s_and_b32 s53, s25, 0xffff
    s_mov_b32 s54, 7864320
    s_mov_b32 s55, 0x20000
    s_add_u32 s40, s24, 8388608
    s_addc_u32 s41, s25, 0
    s_and_b32 s41, s41, 0xffff
    s_mov_b32 s42, 2621440
    s_mov_b32 s43, 0x20000
    v_lshlrev_b32 v10, 4, v2
    s_mul_i32 s27, s34, 5
    s_mul_i32 s28, s32, 3
    s_add_u32 s28, s28, s27
    v_add_u32 v5, s28, v9
    v_lshlrev_b32 v20, 15, v5
    s_lshl_b32 s3, s35, 7
    s_lshl_b32 s28, s33, 5
    s_add_u32 s3, s3, s28
    v_add_u32 v6, s3, v8
    v_lshlrev_b32 v21, 4, v6
    v_add_u32 v20, v20, v21
    buffer_load_dwordx4 v[12:15], v20, s[52:55], 0 offen
    s_add_u32 s27, s27, 2
    s_lshl_b32 s27, s27, 15
    v_add_u32 v22, s27, v21
    buffer_load_dwordx4 v[16:19], v22, s[52:55], 0 offen
    s_lshl_b32 s27, s35, 7
    s_lshl_b32 s28, s26, 6
    s_add_u32 s27, s27, s28
    s_sub_i32 s27, s27, 256
    s_lshl_b32 s58, s27, 4
    s_mul_i32 s3, s34, 163840
    s_add_u32 s58, s58, s3
    s_cmp_lt_i32 s27, 0
    s_cselect_b32 s58, 0x40000000, s58
    s_lshl_b32 s56, s26, 10
    s_cmp_ge_u32 s26, 6
    s_cbranch_scc1 k2_attn_kernel_nodma3
    s_add_u32 s57, s58, 2621440
    s_add_u32 m0, s56, 0
    s_nop 0
    buffer_load_dwordx4 v10, s[52:55], s57 offen lds
    s_add_u32 s57, s58, 2654208
    s_add_u32 m0, s56, 6464
    s_nop 0
    buffer_load_dwordx4 v10, s[52:55], s57 offen lds
    s_add_u32 s57, s58, 2686976
    s_add_u32 m0, s56, 12928
    s_nop 0
    buffer_load_dwordx4 v10, s[52:55], s57 offen lds
    s_add_u32 s57, s58, 2719744
    s_add_u32 m0, s56, 19200
    s_nop 0
    buffer_load_dwordx4 v10, s[52:55], s57 offen lds
    s_add_u32 s57, s58, 2752512
    s_add_u32 m0, s56, 25664
    s_nop 0
    buffer_load_dwordx4 v10, s[52:55], s57 offen lds
k2_attn_kernel_nodma3:
    s_cmp_ge_u32 s26, 6
    s_cbranch_scc1 k2_attn_kernel_nodma24
    s_add_u32 s57, s58, 5242880
    s_add_u32 m0, s56, 32000
    s_nop 0
    buffer_load_dwordx4 v10, s[52:55], s57 offen lds
    s_add_u32 s57, s58, 5275648
    s_add_u32 m0, s56, 38464
    s_nop 0
    buffer_load_dwordx4 v10, s[52:55], s57 offen lds
    s_add_u32 s57, s58, 5308416
    s_add_u32 m0, s56, 44928
    s_nop 0
    buffer_load_dwordx4 v10, s[52:55], s57 offen lds
    s_add_u32 s57, s58, 5341184
    s_add_u32 m0, s56, 51200
    s_nop 0
    buffer_load_dwordx4 v10, s[52:55], s57 offen lds
    s_add_u32 s57, s58, 5373952
    s_add_u32 m0, s56, 57664
    s_nop 0
    buffer_load_dwordx4 v10, s[52:55], s57 offen lds
k2_attn_kernel_nodma24:
    s_mul_i32 s27, s32, 19200
    s_lshl_b32 s28, s33, 9
    s_add_u32 s27, s27, s28
    v_mul_u32_u24 v5, 6464, v9
    v_lshl_add_u32 v5, v8, 4, v5
    v_add_u32 v23, s27, v5
    v_lshlrev_b32 v5, 4, v8
    v_add_u32 v5, s28, v5
    v_add_u32 v24, 12928, v5
    v_lshrrev_b32 v26, 4, v2
    v_and_b32 v26, 1, v26
    v_lshrrev_b32 v27, 2, v2
    v_and_b32 v27, 3, v27
    v_and_b32 v28, 3, v2
    v_lshl_add_u32 v5, v9, 2, v27
    v_lshlrev_b32 v5, 4, v5
    v_and_b32 v6, 1, v28
    v_mul_u32_u24 v6, 6464, v6
    v_lshrrev_b32 v7, 1, v28
    v_lshl_add_u32 v6, v7, 3, v6
    s_mul_i32 s27, s32, 19200
    s_add_u32 s27, s27, 32000
    s_add_u32 s27, s27, s28
    v_add_u32 v6, s27, v6
    s_lshl_b32 s27, s32, 3
    s_add_u32 s27, s27, 44928
    s_add_u32 s27, s27, s28
    v_mov_b32 v7, s27
    v_cmp_eq_u32 vcc, 1, v26
    s_nop 0
    v_cndmask_b32 v6, v6, v7, vcc
    v_lshl_add_u32 v7, v26, 2, v28
    v_cmp_lt_u32 vcc, 4, v7
    v_mov_b32 v7, 64192
    s_nop 0
    v_cndmask_b32 v6, v6, v7, vcc
    v_add_u32 v25, v6, v5
    s_lshl_b32 s27, s35, 2
    s_add_u32 s27, s27, s33
    s_sub_i32 s36, 8, s27
    v_mov_b32 v228, 0xf149f2ca
    v_mov_b32 v212, 0
    v_mov_b32 v213, 0
    v_mov_b32 v214, 0
    v_mov_b32 v215, 0
    v_mov_b32 v216, 0
    v_mov_b32 v217, 0
    v_mov_b32 v218, 0
    v_mov_b32 v219, 0
    v_mov_b32 v220, 0
    v_mov_b32 v221, 0
    v_mov_b32 v222, 0
    v_mov_b32 v223, 0
    v_mov_b32 v224, 0
    v_mov_b32 v225, 0
    v_mov_b32 v226, 0
    v_mov_b32 v227, 0
    v_mov_b32 v229, v228
    v_mov_b32 v230, v228
    v_mov_b32 v231, v228
    v_mov_b32 v232, v228
    s_cmp_eq_u32 s32, 0
    s_cselect_b32 s44, -1, 0
    s_mov_b32 s45, 0
    s_cselect_b32 s46, 0, -1
    s_mov_b32 s47, 0
    s_cmp_ge_u32 s26, 6
    s_cbranch_scc1 k2_attn_kernel_w66
    s_waitcnt vmcnt(5)
    s_branch k2_attn_kernel_wj7
k2_attn_kernel_w66:
    s_waitcnt vmcnt(0)
k2_attn_kernel_wj7:
    s_waitcnt lgkmcnt(0)
    s_barrier
    v_lshlrev_b32 v5, 2, v9
    v_sub_u32 v5, v8, v5
    v_cmp_gt_i32 s[48:49], 0, v5
    v_cmp_gt_i32 s[50:51], 1, v5
    v_cmp_gt_i32 s[52:53], 2, v5
    v_cmp_gt_i32 s[54:55], 3, v5
    v_cmp_gt_i32 s[56:57], 8, v5
    v_cmp_gt_i32 s[58:59], 9, v5
    v_cmp_gt_i32 s[60:61], 10, v5
    v_cmp_gt_i32 s[62:63], 11, v5
    v_cmp_gt_i32 s[64:65], 16, v5
    v_cmp_gt_i32 s[66:67], 17, v5
    v_cmp_gt_i32 s[68:69], 18, v5
    v_cmp_gt_i32 s[70:71], 19, v5
    v_cmp_gt_i32 s[72:73], 24, v5
    v_cmp_gt_i32 s[74:75], 25, v5
    v_cmp_gt_i32 s[76:77], 26, v5
    v_cmp_gt_i32 s[78:79], 27, v5
    v_cndmask_b32 v16, 0, v16, s[44:45]
    v_cndmask_b32 v17, 0, v17, s[44:45]
    v_cndmask_b32 v18, 0, v18, s[46:47]
    v_cndmask_b32 v19, 0, v19, s[46:47]
    ds_read_b128 v[172:175], v23 offset:0
    ds_read_b128 v[176:179], v24 offset:0
    ds_read_b128 v[180:183], v23 offset:512
    ds_read_b128 v[184:187], v24 offset:512
    ds_read_b128 v[188:191], v23 offset:1024
    ds_read_b128 v[192:195], v24 offset:1024
    s_waitcnt lgkmcnt(4)
    v_mfma_f32_32x32x16_bf16 v[28:43], v[172:175], v[12:15], 0
    v_mfma_f32_32x32x16_bf16 v[28:43], v[176:179], v[16:19], v[28:43]
    ds_read_b128 v[172:175], v23 offset:1536
    ds_read_b128 v[176:179], v24 offset:1536
    s_waitcnt lgkmcnt(4)
    v_mfma_f32_32x32x16_bf16 v[44:59], v[180:183], v[12:15], 0
    v_mfma_f32_32x32x16_bf16 v[44:59], v[184:187], v[16:19], v[44:59]
    ds_read_b128 v[180:183], v23 offset:2048
    ds_read_b128 v[184:187], v24 offset:2048
    s_waitcnt lgkmcnt(4)
    v_mfma_f32_32x32x16_bf16 v[60:75], v[188:191], v[12:15], 0
    v_mfma_f32_32x32x16_bf16 v[60:75], v[192:195], v[16:19], v[60:75]
    s_cmp_le_i32 s36, 0
    s_cbranch_scc1 k2_attn_kernel_ok8
    v_mov_b32 v28, v228
    v_mov_b32 v29, v228
    v_mov_b32 v30, v228
    v_mov_b32 v31, v228
    v_mov_b32 v32, v228
    v_mov_b32 v33, v228
    v_mov_b32 v34, v228
    v_mov_b32 v35, v228
    v_mov_b32 v36, v228
    v_mov_b32 v37, v228
    v_mov_b32 v38, v228
    v_mov_b32 v39, v228
    v_mov_b32 v40, v228
    v_mov_b32 v41, v228
    v_mov_b32 v42, v228
    v_mov_b32 v43, v228
k2_attn_kernel_ok8:
    v_cndmask_b32 v28, v228, v28, s[48:49]
    v_cndmask_b32 v29, v228, v29, s[50:51]
    v_cndmask_b32 v30, v228, v30, s[52:53]
    v_cndmask_b32 v31, v228, v31, s[54:55]
    v_cndmask_b32 v32, v228, v32, s[56:57]
    v_cndmask_b32 v33, v228, v33, s[58:59]
    v_cndmask_b32 v34, v228, v34, s[60:61]
    v_cndmask_b32 v35, v228, v35, s[62:63]
    v_cndmask_b32 v36, v228, v36, s[64:65]
    v_cndmask_b32 v37, v228, v37, s[66:67]
    v_cndmask_b32 v38, v228, v38, s[68:69]
    v_cndmask_b32 v39, v228, v39, s[70:71]
    v_cndmask_b32 v40, v228, v40, s[72:73]
    v_cndmask_b32 v41, v228, v41, s[74:75]
    v_cndmask_b32 v42, v228, v42, s[76:77]
    v_cndmask_b32 v43, v228, v43, s[78:79]
    v_max3_f32 v229, v28, v29, v229
    v_max3_f32 v230, v30, v31, v230
    v_max3_f32 v231, v32, v33, v231
    v_max3_f32 v232, v34, v35, v232
    v_max3_f32 v229, v36, v37, v229
    v_max3_f32 v230, v38, v39, v230
    v_max3_f32 v231, v40, v41, v231
    v_max3_f32 v232, v42, v43, v232
    ds_read_b128 v[188:191], v23 offset:2560
    ds_read_b128 v[192:195], v24 offset:2560
    s_waitcnt lgkmcnt(4)
    v_mfma_f32_32x32x16_bf16 v[76:91], v[172:175], v[12:15], 0
    v_mfma_f32_32x32x16_bf16 v[76:91], v[176:179], v[16:19], v[76:91]
    s_cmp_le_i32 s36, 1
    s_cbranch_scc1 k2_attn_kernel_ok9
    v_mov_b32 v44, v228
    v_mov_b32 v45, v228
    v_mov_b32 v46, v228
    v_mov_b32 v47, v228
    v_mov_b32 v48, v228
    v_mov_b32 v49, v228
    v_mov_b32 v50, v228
    v_mov_b32 v51, v228
    v_mov_b32 v52, v228
    v_mov_b32 v53, v228
    v_mov_b32 v54, v228
    v_mov_b32 v55, v228
    v_mov_b32 v56, v228
    v_mov_b32 v57, v228
    v_mov_b32 v58, v228
    v_mov_b32 v59, v228
k2_attn_kernel_ok9:
    v_max3_f32 v229, v44, v45, v229
    v_max3_f32 v230, v46, v47, v230
    v_max3_f32 v231, v48, v49, v231
    v_max3_f32 v232, v50, v51, v232
    v_max3_f32 v229, v52, v53, v229
    v_max3_f32 v230, v54, v55, v230
    v_max3_f32 v231, v56, v57, v231
    v_max3_f32 v232, v58, v59, v232
    ds_read_b128 v[172:175], v23 offset:3072
    ds_read_b128 v[176:179], v24 offset:3072
    s_waitcnt lgkmcnt(4)
    v_mfma_f32_32x32x16_bf16 v[92:107], v[180:183], v[12:15], 0
    v_mfma_f32_32x32x16_bf16 v[92:107], v[184:187], v[16:19], v[92:107]
    s_cmp_le_i32 s36, 2
    s_cbranch_scc1 k2_attn_kernel_ok10
    v_mov_b32 v60, v228
    v_mov_b32 v61, v228
    v_mov_b32 v62, v228
    v_mov_b32 v63, v228
    v_mov_b32 v64, v228
    v_mov_b32 v65, v228
    v_mov_b32 v66, v228
    v_mov_b32 v67, v228
    v_mov_b32 v68, v228
    v_mov_b32 v69, v228
    v_mov_b32 v70, v228
    v_mov_b32 v71, v228
    v_mov_b32 v72, v228
    v_mov_b32 v73, v228
    v_mov_b32 v74, v228
    v_mov_b32 v75, v228
k2_attn_kernel_ok10:
    v_max3_f32 v229, v60, v61, v229
    v_max3_f32 v230, v62, v63, v230
    v_max3_f32 v231, v64, v65, v231
    v_max3_f32 v232, v66, v67, v232
    v_max3_f32 v229, v68, v69, v229
    v_max3_f32 v230, v70, v71, v230
    v_max3_f32 v231, v72, v73, v231
    v_max3_f32 v232, v74, v75, v232
    ds_read_b128 v[180:183], v23 offset:3584
    ds_read_b128 v[184:187], v24 offset:3584
    s_waitcnt lgkmcnt(4)
    v_mfma_f32_32x32x16_bf16 v[108:123], v[188:191], v[12:15], 0
    v_mfma_f32_32x32x16_bf16 v[108:123], v[192:195], v[16:19], v[108:123]
    s_cmp_le_i32 s36, 3
    s_cbranch_scc1 k2_attn_kernel_ok11
    v_mov_b32 v76, v228
    v_mov_b32 v77, v228
    v_mov_b32 v78, v228
    v_mov_b32 v79, v228
    v_mov_b32 v80, v228
    v_mov_b32 v81, v228
    v_mov_b32 v82, v228
    v_mov_b32 v83, v228
    v_mov_b32 v84, v228
    v_mov_b32 v85, v228
    v_mov_b32 v86, v228
    v_mov_b32 v87, v228
    v_mov_b32 v88, v228
    v_mov_b32 v89, v228
    v_mov_b32 v90, v228
    v_mov_b32 v91, v228
k2_attn_kernel_ok11:
    v_max3_f32 v229, v76, v77, v229
    v_max3_f32 v230, v78, v79, v230
    v_max3_f32 v231, v80, v81, v231
    v_max3_f32 v232, v82, v83, v232
    v_max3_f32 v229, v84, v85, v229
    v_max3_f32 v230, v86, v87, v230
    v_max3_f32 v231, v88, v89, v231
    v_max3_f32 v232, v90, v91, v232
    ds_read_b128 v[188:191], v23 offset:4096
    ds_read_b128 v[192:195], v24 offset:4096
    s_waitcnt lgkmcnt(4)
    v_mfma_f32_32x32x16_bf16 v[124:139], v[172:175], v[12:15], 0
    v_mfma_f32_32x32x16_bf16 v[124:139], v[176:179], v[16:19], v[124:139]
    s_cmp_le_i32 s36, 4
    s_cbranch_scc1 k2_attn_kernel_ok12
    v_mov_b32 v92, v228
    v_mov_b32 v93, v228
    v_mov_b32 v94, v228
    v_mov_b32 v95, v228
    v_mov_b32 v96, v228
    v_mov_b32 v97, v228
    v_mov_b32 v98, v228
    v_mov_b32 v99, v228
    v_mov_b32 v100, v228
    v_mov_b32 v101, v228
    v_mov_b32 v102, v228
    v_mov_b32 v103, v228
    v_mov_b32 v104, v228
    v_mov_b32 v105, v228
    v_mov_b32 v106, v228
    v_mov_b32 v107, v228
k2_attn_kernel_ok12:
    v_max3_f32 v229, v92, v93, v229
    v_max3_f32 v230, v94, v95, v230
    v_max3_f32 v231, v96, v97, v231
    v_max3_f32 v232, v98, v99, v232
    v_max3_f32 v229, v100, v101, v229
    v_max3_f32 v230, v102, v103, v230
    v_max3_f32 v231, v104, v105, v231
    v_max3_f32 v232, v106, v107, v232
    s_waitcnt lgkmcnt(2)
    v_mfma_f32_32x32x16_bf16 v[140:155], v[180:183], v[12:15], 0
    v_mfma_f32_32x32x16_bf16 v[140:155], v[184:187], v[16:19], v[140:155]
    s_cmp_le_i32 s36, 5
    s_cbranch_scc1 k2_attn_kernel_ok13
    v_mov_b32 v108, v228
    v_mov_b32 v109, v228
    v_mov_b32 v110, v228
    v_mov_b32 v111, v228
    v_mov_b32 v112, v228
    v_mov_b32 v113, v228
    v_mov_b32 v114, v228
    v_mov_b32 v115, v228
    v_mov_b32 v116, v228
    v_mov_b32 v117, v228
    v_mov_b32 v118, v228
    v_mov_b32 v119, v228
    v_mov_b32 v120, v228
    v_mov_b32 v121, v228
    v_mov_b32 v122, v228
    v_mov_b32 v123, v228
k2_attn_kernel_ok13:
    v_max3_f32 v229, v108, v109, v229
    v_max3_f32 v230, v110, v111, v230
    v_max3_f32 v231, v112, v113, v231
    v_max3_f32 v232, v114, v115, v232
    v_max3_f32 v229, v116, v117, v229
    v_max3_f32 v230, v118, v119, v230
    v_max3_f32 v231, v120, v121, v231
    v_max3_f32 v232, v122, v123, v232
    s_waitcnt lgkmcnt(0)
    v_mfma_f32_32x32x16_bf16 v[156:171], v[188:191], v[12:15], 0
    v_mfma_f32_32x32x16_bf16 v[156:171], v[192:195], v[16:19], v[156:171]
    s_cmp_le_i32 s36, 6
    s_cbranch_scc1 k2_attn_kernel_ok14
    v_mov_b32 v124, v228
    v_mov_b32 v125, v228
    v_mov_b32 v126, v228
    v_mov_b32 v127, v228
    v_mov_b32 v128, v228
    v_mov_b32 v129, v228
    v_mov_b32 v130, v228
    v_mov_b32 v131, v228
    v_mov_b32 v132, v228
    v_mov_b32 v133, v228
    v_mov_b32 v134, v228
    v_mov_b32 v135, v228
    v_mov_b32 v136, v228
    v_mov_b32 v137, v228
    v_mov_b32 v138, v228
    v_mov_b32 v139, v228
k2_attn_kernel_ok14:
    v_max3_f32 v229, v124, v125, v229
    v_max3_f32 v230, v126, v127, v230
    v_max3_f32 v231, v128, v129, v231
    v_max3_f32 v232, v130, v131, v232
    v_max3_f32 v229, v132, v133, v229
    v_max3_f32 v230, v134, v135, v230
    v_max3_f32 v231, v136, v137, v231
    v_max3_f32 v232, v138, v139, v232
    s_nop 7
    s_cmp_le_i32 s36, 7
    s_cbranch_scc1 k2_attn_kernel_ok15
    v_mov_b32 v140, v228
    v_mov_b32 v141, v228
    v_mov_b32 v142, v228
    v_mov_b32 v143, v228
    v_mov_b32 v144, v228
    v_mov_b32 v145, v228
    v_mov_b32 v146, v228
    v_mov_b32 v147, v228
    v_mov_b32 v148, v228
    v_mov_b32 v149, v228
    v_mov_b32 v150, v228
    v_mov_b32 v151, v228
    v_mov_b32 v152, v228
    v_mov_b32 v153, v228
    v_mov_b32 v154, v228
    v_mov_b32 v155, v228
k2_attn_kernel_ok15:
    v_max3_f32 v229, v140, v141, v229
    v_max3_f32 v230, v142, v143, v230
    v_max3_f32 v231, v144, v145, v231
    v_max3_f32 v232, v146, v147, v232
    v_max3_f32 v229, v148, v149, v229
    v_max3_f32 v230, v150, v151, v230
    v_max3_f32 v231, v152, v153, v231
    v_max3_f32 v232, v154, v155, v232
    s_nop 3
    v_cndmask_b32 v156, v156, v228, s[48:49]
    v_cndmask_b32 v157, v157, v228, s[50:51]
    v_cndmask_b32 v158, v158, v228, s[52:53]
    v_cndmask_b32 v159, v159, v228, s[54:55]
    v_cndmask_b32 v160, v160, v228, s[56:57]
    v_cndmask_b32 v161, v161, v228, s[58:59]
    v_cndmask_b32 v162, v162, v228, s[60:61]
    v_cndmask_b32 v163, v163, v228, s[62:63]
    v_cndmask_b32 v164, v164, v228, s[64:65]
    v_cndmask_b32 v165, v165, v228, s[66:67]
    v_cndmask_b32 v166, v166, v228, s[68:69]
    v_cndmask_b32 v167, v167, v228, s[70:71]
    v_cndmask_b32 v168, v168, v228, s[72:73]
    v_cndmask_b32 v169, v169, v228, s[74:75]
    v_cndmask_b32 v170, v170, v228, s[76:77]
    v_cndmask_b32 v171, v171, v228, s[78:79]
    v_max3_f32 v229, v156, v157, v229
    v_max3_f32 v230, v158, v159, v230
    v_max3_f32 v231, v160, v161, v231
    v_max3_f32 v232, v162, v163, v232
    v_max3_f32 v229, v164, v165, v229
    v_max3_f32 v230, v166, v167, v230
    v_max3_f32 v231, v168, v169, v231
    v_max3_f32 v232, v170, v171, v232
    v_max3_f32 v229, v229, v230, v231
    v_max_f32 v229, v229, v232
    v_mov_b32 v230, v229
    s_nop 1
    v_permlane32_swap_b32 v229, v230
    s_nop 1
    v_max_f32 v229, v229, v230
    s_waitcnt vmcnt(0)
    s_barrier
    ds_read_b64_tr_b16 v[196:197], v25 offset:0
    ds_read_b64_tr_b16 v[198:199], v25 offset:128
    ds_read_b64_tr_b16 v[200:201], v25 offset:256
    ds_read_b64_tr_b16 v[202:203], v25 offset:384
    v_sub_f32 v28, v28, v229
    v_sub_f32 v29, v29, v229
    v_sub_f32 v30, v30, v229
    v_sub_f32 v31, v31, v229
    v_sub_f32 v32, v32, v229
    v_sub_f32 v33, v33, v229
    v_sub_f32 v34, v34, v229
    v_sub_f32 v35, v35, v229
    v_sub_f32 v36, v36, v229
    v_sub_f32 v37, v37, v229
    v_sub_f32 v38, v38, v229
    v_sub_f32 v39, v39, v229
    v_sub_f32 v40, v40, v229
    v_sub_f32 v41, v41, v229
    v_sub_f32 v42, v42, v229
    v_sub_f32 v43, v43, v229
    v_exp_f32 v28, v28
    v_exp_f32 v29, v29
    v_exp_f32 v30, v30
    v_exp_f32 v31, v31
    v_exp_f32 v32, v32
    v_exp_f32 v33, v33
    v_exp_f32 v34, v34
    v_exp_f32 v35, v35
    v_exp_f32 v36, v36
    v_exp_f32 v37, v37
    v_exp_f32 v38, v38
    v_exp_f32 v39, v39
    v_exp_f32 v40, v40
    v_exp_f32 v41, v41
    v_exp_f32 v42, v42
    v_exp_f32 v43, v43
    s_nop 0
    v_cvt_pk_bf16_f32 v28, v28, v29
    v_cvt_pk_bf16_f32 v29, v30, v31
    v_cvt_pk_bf16_f32 v30, v32, v33
    v_cvt_pk_bf16_f32 v31, v34, v35
    v_cvt_pk_bf16_f32 v32, v36, v37
    v_cvt_pk_bf16_f32 v33, v38, v39
    v_cvt_pk_bf16_f32 v34, v40, v41
    v_cvt_pk_bf16_f32 v35, v42, v43
    ds_read_b64_tr_b16 v[204:205], v25 offset:512
    ds_read_b64_tr_b16 v[206:207], v25 offset:640
    ds_read_b64_tr_b16 v[208:209], v25 offset:768
    ds_read_b64_tr_b16 v[210:211], v25 offset:896
    s_waitcnt lgkmcnt(4)
    s_nop 1
    v_mfma_f32_32x32x16_bf16 v[212:227], v[196:199], v[28:31], v[212:227]
    v_mfma_f32_32x32x16_bf16 v[212:227], v[200:203], v[32:35], v[212:227]
    v_sub_f32 v44, v44, v229
    v_sub_f32 v45, v45, v229
    v_sub_f32 v46, v46, v229
    v_sub_f32 v47, v47, v229
    v_sub_f32 v48, v48, v229
    v_sub_f32 v49, v49, v229
    v_sub_f32 v50, v50, v229
    v_sub_f32 v51, v51, v229
    v_sub_f32 v52, v52, v229
    v_sub_f32 v53, v53, v229
    v_sub_f32 v54, v54, v229
    v_sub_f32 v55, v55, v229
    v_sub_f32 v56, v56, v229
    v_sub_f32 v57, v57, v229
    v_sub_f32 v58, v58, v229
    v_sub_f32 v59, v59, v229
    v_exp_f32 v44, v44
    v_exp_f32 v45, v45
    v_exp_f32 v46, v46
    v_exp_f32 v47, v47
    v_exp_f32 v48, v48
    v_exp_f32 v49, v49
    v_exp_f32 v50, v50
    v_exp_f32 v51, v51
    v_exp_f32 v52, v52
    v_exp_f32 v53, v53
    v_exp_f32 v54, v54
    v_exp_f32 v55, v55
    v_exp_f32 v56, v56
    v_exp_f32 v57, v57
    v_exp_f32 v58, v58
    v_exp_f32 v59, v59
    s_nop 0
    v_cvt_pk_bf16_f32 v44, v44, v45
    v_cvt_pk_bf16_f32 v45, v46, v47
    v_cvt_pk_bf16_f32 v46, v48, v49
    v_cvt_pk_bf16_f32 v47, v50, v51
    v_cvt_pk_bf16_f32 v48, v52, v53
    v_cvt_pk_bf16_f32 v49, v54, v55
    v_cvt_pk_bf16_f32 v50, v56, v57
    v_cvt_pk_bf16_f32 v51, v58, v59
    ds_read_b64_tr_b16 v[196:197], v25 offset:1024
    ds_read_b64_tr_b16 v[198:199], v25 offset:1152
    ds_read_b64_tr_b16 v[200:201], v25 offset:1280
    ds_read_b64_tr_b16 v[202:203], v25 offset:1408
    s_waitcnt lgkmcnt(4)
    s_nop 1
    v_mfma_f32_32x32x16_bf16 v[212:227], v[204:207], v[44:47], v[212:227]
    v_mfma_f32_32x32x16_bf16 v[212:227], v[208:211], v[48:51], v[212:227]
    v_sub_f32 v60, v60, v229
    v_sub_f32 v61, v61, v229
    v_sub_f32 v62, v62, v229
    v_sub_f32 v63, v63, v229
    v_sub_f32 v64, v64, v229
    v_sub_f32 v65, v65, v229
    v_sub_f32 v66, v66, v229
    v_sub_f32 v67, v67, v229
    v_sub_f32 v68, v68, v229
    v_sub_f32 v69, v69, v229
    v_sub_f32 v70, v70, v229
    v_sub_f32 v71, v71, v229
    v_sub_f32 v72, v72, v229
    v_sub_f32 v73, v73, v229
    v_sub_f32 v74, v74, v229
    v_sub_f32 v75, v75, v229
    v_exp_f32 v60, v60
    v_exp_f32 v61, v61
    v_exp_f32 v62, v62
    v_exp_f32 v63, v63
    v_exp_f32 v64, v64
    v_exp_f32 v65, v65
    v_exp_f32 v66, v66
    v_exp_f32 v67, v67
    v_exp_f32 v68, v68
    v_exp_f32 v69, v69
    v_exp_f32 v70, v70
    v_exp_f32 v71, v71
    v_exp_f32 v72, v72
    v_exp_f32 v73, v73
    v_exp_f32 v74, v74
    v_exp_f32 v75, v75
    s_nop 0
    v_cvt_pk_bf16_f32 v60, v60, v61
    v_cvt_pk_bf16_f32 v61, v62, v63
    v_cvt_pk_bf16_f32 v62, v64, v65
    v_cvt_pk_bf16_f32 v63, v66, v67
    v_cvt_pk_bf16_f32 v64, v68, v69
    v_cvt_pk_bf16_f32 v65, v70, v71
    v_cvt_pk_bf16_f32 v66, v72, v73
    v_cvt_pk_bf16_f32 v67, v74, v75
    ds_read_b64_tr_b16 v[204:205], v25 offset:1536
    ds_read_b64_tr_b16 v[206:207], v25 offset:1664
    ds_read_b64_tr_b16 v[208:209], v25 offset:1792
    ds_read_b64_tr_b16 v[210:211], v25 offset:1920
    s_waitcnt lgkmcnt(4)
    s_nop 1
    v_mfma_f32_32x32x16_bf16 v[212:227], v[196:199], v[60:63], v[212:227]
    v_mfma_f32_32x32x16_bf16 v[212:227], v[200:203], v[64:67], v[212:227]
    v_sub_f32 v76, v76, v229
    v_sub_f32 v77, v77, v229
    v_sub_f32 v78, v78, v229
    v_sub_f32 v79, v79, v229
    v_sub_f32 v80, v80, v229
    v_sub_f32 v81, v81, v229
    v_sub_f32 v82, v82, v229
    v_sub_f32 v83, v83, v229
    v_sub_f32 v84, v84, v229
    v_sub_f32 v85, v85, v229
    v_sub_f32 v86, v86, v229
    v_sub_f32 v87, v87, v229
    v_sub_f32 v88, v88, v229
    v_sub_f32 v89, v89, v229
    v_sub_f32 v90, v90, v229
    v_sub_f32 v91, v91, v229
    v_exp_f32 v76, v76
    v_exp_f32 v77, v77
    v_exp_f32 v78, v78
    v_exp_f32 v79, v79
    v_exp_f32 v80, v80
    v_exp_f32 v81, v81
    v_exp_f32 v82, v82
    v_exp_f32 v83, v83
    v_exp_f32 v84, v84
    v_exp_f32 v85, v85
    v_exp_f32 v86, v86
    v_exp_f32 v87, v87
    v_exp_f32 v88, v88
    v_exp_f32 v89, v89
    v_exp_f32 v90, v90
    v_exp_f32 v91, v91
    s_nop 0
    v_cvt_pk_bf16_f32 v76, v76, v77
    v_cvt_pk_bf16_f32 v77, v78, v79
    v_cvt_pk_bf16_f32 v78, v80, v81
    v_cvt_pk_bf16_f32 v79, v82, v83
    v_cvt_pk_bf16_f32 v80, v84, v85
    v_cvt_pk_bf16_f32 v81, v86, v87
    v_cvt_pk_bf16_f32 v82, v88, v89
    v_cvt_pk_bf16_f32 v83, v90, v91
    ds_read_b64_tr_b16 v[196:197], v25 offset:2048
    ds_read_b64_tr_b16 v[198:199], v25 offset:2176
    ds_read_b64_tr_b16 v[200:201], v25 offset:2304
    ds_read_b64_tr_b16 v[202:203], v25 offset:2432
    s_waitcnt lgkmcnt(4)
    s_nop 1
    v_mfma_f32_32x32x16_bf16 v[212:227], v[204:207], v[76:79], v[212:227]
    v_mfma_f32_32x32x16_bf16 v[212:227], v[208:211], v[80:83], v[212:227]
    v_sub_f32 v92, v92, v229
    v_sub_f32 v93, v93, v229
    v_sub_f32 v94, v94, v229
    v_sub_f32 v95, v95, v229
    v_sub_f32 v96, v96, v229
    v_sub_f32 v97, v97, v229
    v_sub_f32 v98, v98, v229
    v_sub_f32 v99, v99, v229
    v_sub_f32 v100, v100, v229
    v_sub_f32 v101, v101, v229
    v_sub_f32 v102, v102, v229
    v_sub_f32 v103, v103, v229
    v_sub_f32 v104, v104, v229
    v_sub_f32 v105, v105, v229
    v_sub_f32 v106, v106, v229
    v_sub_f32 v107, v107, v229
    v_exp_f32 v92, v92
    v_exp_f32 v93, v93
    v_exp_f32 v94, v94
    v_exp_f32 v95, v95
    v_exp_f32 v96, v96
    v_exp_f32 v97, v97
    v_exp_f32 v98, v98
    v_exp_f32 v99, v99
    v_exp_f32 v100, v100
    v_exp_f32 v101, v101
    v_exp_f32 v102, v102
    v_exp_f32 v103, v103
    v_exp_f32 v104, v104
    v_exp_f32 v105, v105
    v_exp_f32 v106, v106
    v_exp_f32 v107, v107
    s_nop 0
    v_cvt_pk_bf16_f32 v92, v92, v93
    v_cvt_pk_bf16_f32 v93, v94, v95
    v_cvt_pk_bf16_f32 v94, v96, v97
    v_cvt_pk_bf16_f32 v95, v98, v99
    v_cvt_pk_bf16_f32 v96, v100, v101
    v_cvt_pk_bf16_f32 v97, v102, v103
    v_cvt_pk_bf16_f32 v98, v104, v105
    v_cvt_pk_bf16_f32 v99, v106, v107
    ds_read_b64_tr_b16 v[204:205], v25 offset:2560
    ds_read_b64_tr_b16 v[206:207], v25 offset:2688
    ds_read_b64_tr_b16 v[208:209], v25 offset:2816
    ds_read_b64_tr_b16 v[210:211], v25 offset:2944
    s_waitcnt lgkmcnt(4)
    s_nop 1
    v_mfma_f32_32x32x16_bf16 v[212:227], v[196:199], v[92:95], v[212:227]
    v_mfma_f32_32x32x16_bf16 v[212:227], v[200:203], v[96:99], v[212:227]
    v_sub_f32 v108, v108, v229
    v_sub_f32 v109, v109, v229
    v_sub_f32 v110, v110, v229
    v_sub_f32 v111, v111, v229
    v_sub_f32 v112, v112, v229
    v_sub_f32 v113, v113, v229
    v_sub_f32 v114, v114, v229
    v_sub_f32 v115, v115, v229
    v_sub_f32 v116, v116, v229
    v_sub_f32 v117, v117, v229
    v_sub_f32 v118, v118, v229
    v_sub_f32 v119, v119, v229
    v_sub_f32 v120, v120, v229
    v_sub_f32 v121, v121, v229
    v_sub_f32 v122, v122, v229
    v_sub_f32 v123, v123, v229
    v_exp_f32 v108, v108
    v_exp_f32 v109, v109
    v_exp_f32 v110, v110
    v_exp_f32 v111, v111
    v_exp_f32 v112, v112
    v_exp_f32 v113, v113
    v_exp_f32 v114, v114
    v_exp_f32 v115, v115
    v_exp_f32 v116, v116
    v_exp_f32 v117, v117
    v_exp_f32 v118, v118
    v_exp_f32 v119, v119
    v_exp_f32 v120, v120
    v_exp_f32 v121, v121
    v_exp_f32 v122, v122
    v_exp_f32 v123, v123
    s_nop 0
    v_cvt_pk_bf16_f32 v108, v108, v109
    v_cvt_pk_bf16_f32 v109, v110, v111
    v_cvt_pk_bf16_f32 v110, v112, v113
    v_cvt_pk_bf16_f32 v111, v114, v115
    v_cvt_pk_bf16_f32 v112, v116, v117
    v_cvt_pk_bf16_f32 v113, v118, v119
    v_cvt_pk_bf16_f32 v114, v120, v121
    v_cvt_pk_bf16_f32 v115, v122, v123
    ds_read_b64_tr_b16 v[196:197], v25 offset:3072
    ds_read_b64_tr_b16 v[198:199], v25 offset:3200
    ds_read_b64_tr_b16 v[200:201], v25 offset:3328
    ds_read_b64_tr_b16 v[202:203], v25 offset:3456
    s_waitcnt lgkmcnt(4)
    s_nop 1
    v_mfma_f32_32x32x16_bf16 v[212:227], v[204:207], v[108:111], v[212:227]
    v_mfma_f32_32x32x16_bf16 v[212:227], v[208:211], v[112:115], v[212:227]
    v_sub_f32 v124, v124, v229
    v_sub_f32 v125, v125, v229
    v_sub_f32 v126, v126, v229
    v_sub_f32 v127, v127, v229
    v_sub_f32 v128, v128, v229
    v_sub_f32 v129, v129, v229
    v_sub_f32 v130, v130, v229
    v_sub_f32 v131, v131, v229
    v_sub_f32 v132, v132, v229
    v_sub_f32 v133, v133, v229
    v_sub_f32 v134, v134, v229
    v_sub_f32 v135, v135, v229
    v_sub_f32 v136, v136, v229
    v_sub_f32 v137, v137, v229
    v_sub_f32 v138, v138, v229
    v_sub_f32 v139, v139, v229
    v_exp_f32 v124, v124
    v_exp_f32 v125, v125
    v_exp_f32 v126, v126
    v_exp_f32 v127, v127
    v_exp_f32 v128, v128
    v_exp_f32 v129, v129
    v_exp_f32 v130, v130
    v_exp_f32 v131, v131
    v_exp_f32 v132, v132
    v_exp_f32 v133, v133
    v_exp_f32 v134, v134
    v_exp_f32 v135, v135
    v_exp_f32 v136, v136
    v_exp_f32 v137, v137
    v_exp_f32 v138, v138
    v_exp_f32 v139, v139
    s_nop 0
    v_cvt_pk_bf16_f32 v124, v124, v125
    v_cvt_pk_bf16_f32 v125, v126, v127
    v_cvt_pk_bf16_f32 v126, v128, v129
    v_cvt_pk_bf16_f32 v127, v130, v131
    v_cvt_pk_bf16_f32 v128, v132, v133
    v_cvt_pk_bf16_f32 v129, v134, v135
    v_cvt_pk_bf16_f32 v130, v136, v137
    v_cvt_pk_bf16_f32 v131, v138, v139
    ds_read_b64_tr_b16 v[204:205], v25 offset:3584
    ds_read_b64_tr_b16 v[206:207], v25 offset:3712
    ds_read_b64_tr_b16 v[208:209], v25 offset:3840
    ds_read_b64_tr_b16 v[210:211], v25 offset:3968
    s_waitcnt lgkmcnt(4)
    s_nop 1
    v_mfma_f32_32x32x16_bf16 v[212:227], v[196:199], v[124:127], v[212:227]
    v_mfma_f32_32x32x16_bf16 v[212:227], v[200:203], v[128:131], v[212:227]
    v_sub_f32 v140, v140, v229
    v_sub_f32 v141, v141, v229
    v_sub_f32 v142, v142, v229
    v_sub_f32 v143, v143, v229
    v_sub_f32 v144, v144, v229
    v_sub_f32 v145, v145, v229
    v_sub_f32 v146, v146, v229
    v_sub_f32 v147, v147, v229
    v_sub_f32 v148, v148, v229
    v_sub_f32 v149, v149, v229
    v_sub_f32 v150, v150, v229
    v_sub_f32 v151, v151, v229
    v_sub_f32 v152, v152, v229
    v_sub_f32 v153, v153, v229
    v_sub_f32 v154, v154, v229
    v_sub_f32 v155, v155, v229
    v_exp_f32 v140, v140
    v_exp_f32 v141, v141
    v_exp_f32 v142, v142
    v_exp_f32 v143, v143
    v_exp_f32 v144, v144
    v_exp_f32 v145, v145
    v_exp_f32 v146, v146
    v_exp_f32 v147, v147
    v_exp_f32 v148, v148
    v_exp_f32 v149, v149
    v_exp_f32 v150, v150
    v_exp_f32 v151, v151
    v_exp_f32 v152, v152
    v_exp_f32 v153, v153
    v_exp_f32 v154, v154
    v_exp_f32 v155, v155
    s_nop 0
    v_cvt_pk_bf16_f32 v140, v140, v141
    v_cvt_pk_bf16_f32 v141, v142, v143
    v_cvt_pk_bf16_f32 v142, v144, v145
    v_cvt_pk_bf16_f32 v143, v146, v147
    v_cvt_pk_bf16_f32 v144, v148, v149
    v_cvt_pk_bf16_f32 v145, v150, v151
    v_cvt_pk_bf16_f32 v146, v152, v153
    v_cvt_pk_bf16_f32 v147, v154, v155
    ds_read_b64_tr_b16 v[196:197], v25 offset:4096
    ds_read_b64_tr_b16 v[198:199], v25 offset:4224
    ds_read_b64_tr_b16 v[200:201], v25 offset:4352
    ds_read_b64_tr_b16 v[202:203], v25 offset:4480
    s_waitcnt lgkmcnt(4)
    s_nop 1
    v_mfma_f32_32x32x16_bf16 v[212:227], v[204:207], v[140:143], v[212:227]
    v_mfma_f32_32x32x16_bf16 v[212:227], v[208:211], v[144:147], v[212:227]
    v_sub_f32 v156, v156, v229
    v_sub_f32 v157, v157, v229
    v_sub_f32 v158, v158, v229
    v_sub_f32 v159, v159, v229
    v_sub_f32 v160, v160, v229
    v_sub_f32 v161, v161, v229
    v_sub_f32 v162, v162, v229
    v_sub_f32 v163, v163, v229
    v_sub_f32 v164, v164, v229
    v_sub_f32 v165, v165, v229
    v_sub_f32 v166, v166, v229
    v_sub_f32 v167, v167, v229
    v_sub_f32 v168, v168, v229
    v_sub_f32 v169, v169, v229
    v_sub_f32 v170, v170, v229
    v_sub_f32 v171, v171, v229
    v_exp_f32 v156, v156
    v_exp_f32 v157, v157
    v_exp_f32 v158, v158
    v_exp_f32 v159, v159
    v_exp_f32 v160, v160
    v_exp_f32 v161, v161
    v_exp_f32 v162, v162
    v_exp_f32 v163, v163
    v_exp_f32 v164, v164
    v_exp_f32 v165, v165
    v_exp_f32 v166, v166
    v_exp_f32 v167, v167
    v_exp_f32 v168, v168
    v_exp_f32 v169, v169
    v_exp_f32 v170, v170
    v_exp_f32 v171, v171
    s_nop 0
    v_cvt_pk_bf16_f32 v156, v156, v157
    v_cvt_pk_bf16_f32 v157, v158, v159
    v_cvt_pk_bf16_f32 v158, v160, v161
    v_cvt_pk_bf16_f32 v159, v162, v163
    v_cvt_pk_bf16_f32 v160, v164, v165
    v_cvt_pk_bf16_f32 v161, v166, v167
    v_cvt_pk_bf16_f32 v162, v168, v169
    v_cvt_pk_bf16_f32 v163, v170, v171
    s_waitcnt lgkmcnt(0)
    s_nop 1
    v_mfma_f32_32x32x16_bf16 v[212:227], v[196:199], v[156:159], v[212:227]
    v_mfma_f32_32x32x16_bf16 v[212:227], v[200:203], v[160:163], v[212:227]
    s_nop 13
    v_rcp_f32 v233, v224
    s_nop 0
    v_mul_f32 v212, v212, v233
    v_mul_f32 v213, v213, v233
    v_mul_f32 v214, v214, v233
    v_mul_f32 v215, v215, v233
    v_mul_f32 v216, v216, v233
    v_mul_f32 v217, v217, v233
    v_mul_f32 v218, v218, v233
    v_mul_f32 v219, v219, v233
    v_mul_f32 v220, v220, v233
    v_mul_f32 v221, v221, v233
    v_mul_f32 v222, v222, v233
    v_mul_f32 v223, v223, v233
    v_cvt_pk_bf16_f32 v236, v212, v213
    v_cvt_pk_bf16_f32 v237, v214, v215
    v_cvt_pk_bf16_f32 v238, v216, v217
    v_cvt_pk_bf16_f32 v239, v218, v219
    v_cvt_pk_bf16_f32 v240, v220, v221
    v_cvt_pk_bf16_f32 v241, v222, v223
    buffer_store_dwordx4 v[236:239], v20, s[40:43], 0 offen sc1
    s_lshl_b32 s27, s32, 3
    v_add_u32 v22, s27, v22
    v_lshlrev_b32 v5, 30, v9
    v_or_b32 v22, v22, v5
    buffer_store_dwordx2 v[240:241], v22, s[40:43], 0 offen sc1
k2_attn_kernel_end1:
    s_endpgm
.globl k3_wo_kernel
.p2align 8
.type k3_wo_kernel,@function
k3_wo_kernel:
    s_cmp_ge_u32 s2, 256
    s_cbranch_scc1 k3_wo_kernel_end1
    s_load_dwordx16 s[4:19], s[0:1], 0
    s_load_dwordx4 s[20:23], s[0:1], 64
    s_load_dwordx2 s[24:25], s[0:1], 80
    v_lshrrev_b32 v5, 6, v0
    v_and_b32 v2, 63, v0
    v_readfirstlane_b32 s26, v5
    v_and_b32 v3, 15, v2
    v_lshrrev_b32 v4, 4, v2
    s_and_b32 s29, s26, 3
    s_and_b32 s27, s2, 7
    s_lshr_b32 s28, s2, 3
    s_lshl_b32 s30, s27, 1
    s_and_b32 s3, s28, 1
    s_add_u32 s30, s30, s3
    s_lshr_b32 s31, s28, 1
    s_lshl_b32 s32, s30, 1
    s_and_b32 s3, s31, 1
    s_add_u32 s32, s32, s3
    s_lshr_b32 s33, s31, 1
    s_and_b32 s34, s29, 1
    s_lshr_b32 s35, s29, 1
    v_lshlrev_b32 v8, 4, v2
    s_cmp_lt_u32 s26, 4
    s_cbranch_scc1 k3_wo_kernel_cons2
    s_mul_i32 s60, s33, 102400
    s_mul_i32 s3, s29, 5120
    s_add_u32 s60, s60, s3
    s_mul_i32 s62, s29, 5120
    s_lshl_b32 s63, s29, 12
    s_lshl_b32 s61, s29, 17
    s_lshl_b32 s3, s32, 10
    s_add_u32 s61, s61, s3
    s_waitcnt lgkmcnt(0)
    s_add_u32 s36, s24, 25165824
    s_addc_u32 s37, s25, 0
    s_and_b32 s37, s37, 0xffff
    s_mov_b32 s38, 819200
    s_mov_b32 s39, 0x20000
    s_add_u32 s40, s24, 8388608
    s_addc_u32 s41, s25, 0
    s_and_b32 s41, s41, 0xffff
    s_mov_b32 s42, 2621440
    s_mov_b32 s43, 0x20000
    s_add_u32 m0, s63, 0
    s_add_u32 s3, s61, 0
    buffer_load_dwordx4 v8, s[40:43], s3 offen lds
    s_add_u32 m0, s63, 1024
    s_add_u32 s3, s61, 32768
    buffer_load_dwordx4 v8, s[40:43], s3 offen lds
    s_add_u32 m0, s63, 2048
    s_add_u32 s3, s61, 65536
    buffer_load_dwordx4 v8, s[40:43], s3 offen lds
    s_add_u32 m0, s63, 3072
    s_add_u32 s3, s61, 98304
    buffer_load_dwordx4 v8, s[40:43], s3 offen lds
    s_add_u32 s61, s61, 524288
    s_add_u32 m0, s62, 16384
    s_nop 0
    buffer_load_dwordx4 v8, s[36:39], s60 offen offset:0 lds
    buffer_load_dwordx4 v8, s[36:39], s60 offen offset:1024 lds
    buffer_load_dwordx4 v8, s[36:39], s60 offen offset:2048 lds
    buffer_load_dwordx4 v8, s[36:39], s60 offen offset:3072 lds
    s_add_u32 m0, s62, 20480
    s_add_u32 s3, s60, 4096
    buffer_load_dwordx4 v8, s[36:39], s3 offen lds
    s_add_u32 s60, s60, 20480
    s_add_u32 m0, s63, 36864
    s_add_u32 s3, s61, 0
    buffer_load_dwordx4 v8, s[40:43], s3 offen lds
    s_add_u32 m0, s63, 37888
    s_add_u32 s3, s61, 32768
    buffer_load_dwordx4 v8, s[40:43], s3 offen lds
    s_add_u32 m0, s63, 38912
    s_add_u32 s3, s61, 65536
    buffer_load_dwordx4 v8, s[40:43], s3 offen lds
    s_add_u32 m0, s63, 39936
    s_add_u32 s3, s61, 98304
    buffer_load_dwordx4 v8, s[40:43], s3 offen lds
    s_add_u32 s61, s61, 524288
    s_add_u32 m0, s62, 53248
    s_nop 0
    buffer_load_dwordx4 v8, s[36:39], s60 offen offset:0 lds
    buffer_load_dwordx4 v8, s[36:39], s60 offen offset:1024 lds
    buffer_load_dwordx4 v8, s[36:39], s60 offen offset:2048 lds
    buffer_load_dwordx4 v8, s[36:39], s60 offen offset:3072 lds
    s_add_u32 m0, s62, 57344
    s_add_u32 s3, s60, 4096
    buffer_load_dwordx4 v8, s[36:39], s3 offen lds
    s_add_u32 s60, s60, 20480
    s_waitcnt vmcnt(9)
    s_barrier
    s_add_u32 m0, s63, 73728
    s_add_u32 s3, s61, 0
    buffer_load_dwordx4 v8, s[40:43], s3 offen lds
    s_add_u32 m0, s63, 74752
    s_add_u32 s3, s61, 32768
    buffer_load_dwordx4 v8, s[40:43], s3 offen lds
    s_add_u32 m0, s63, 75776
    s_add_u32 s3, s61, 65536
    buffer_load_dwordx4 v8, s[40:43], s3 offen lds
    s_add_u32 m0, s63, 76800
    s_add_u32 s3, s61, 98304
    buffer_load_dwordx4 v8, s[40:43], s3 offen lds
    s_add_u32 s61, s61, 524288
    s_add_u32 m0, s62, 90112
    s_nop 0
    buffer_load_dwordx4 v8, s[36:39], s60 offen offset:0 lds
    buffer_load_dwordx4 v8, s[36:39], s60 offen offset:1024 lds
    buffer_load_dwordx4 v8, s[36:39], s60 offen offset:2048 lds
    buffer_load_dwordx4 v8, s[36:39], s60 offen offset:3072 lds
    s_add_u32 m0, s62, 94208
    s_add_u32 s3, s60, 4096
    buffer_load_dwordx4 v8, s[36:39], s3 offen lds
    s_add_u32 s60, s60, 20480
    s_add_u32 m0, s63, 110592
    s_add_u32 s3, s61, 0
    buffer_load_dwordx4 v8, s[40:43], s3 offen lds
    s_add_u32 m0, s63, 111616
    s_add_u32 s3, s61, 32768
    buffer_load_dwordx4 v8, s[40:43], s3 offen lds
    s_add_u32 m0, s63, 112640
    s_add_u32 s3, s61, 65536
    buffer_load_dwordx4 v8, s[40:43], s3 offen lds
    s_add_u32 m0, s63, 113664
    s_add_u32 s3, s61, 98304
    buffer_load_dwordx4 v8, s[40:43], s3 offen lds
    s_add_u32 s61, s61, 524288
    s_add_u32 m0, s62, 126976
    s_nop 0
    buffer_load_dwordx4 v8, s[36:39], s60 offen offset:0 lds
    buffer_load_dwordx4 v8, s[36:39], s60 offen offset:1024 lds
    buffer_load_dwordx4 v8, s[36:39], s60 offen offset:2048 lds
    buffer_load_dwordx4 v8, s[36:39], s60 offen offset:3072 lds
    s_add_u32 m0, s62, 131072
    s_add_u32 s3, s60, 4096
    buffer_load_dwordx4 v8, s[36:39], s3 offen lds
    s_add_u32 s60, s60, 20480
    s_waitcnt vmcnt(18)
    s_barrier
    s_add_u32 m0, s63, 0
    s_add_u32 s3, s61, 0
    buffer_load_dwordx4 v8, s[40:43], s3 offen lds
    s_add_u32 m0, s63, 1024
    s_add_u32 s3, s61, 32768
    buffer_load_dwordx4 v8, s[40:43], s3 offen lds
    s_add_u32 m0, s63, 2048
    s_add_u32 s3, s61, 65536
    buffer_load_dwordx4 v8, s[40:43], s3 offen lds
    s_add_u32 m0, s63, 3072
    s_add_u32 s3, s61, 98304
    buffer_load_dwordx4 v8, s[40:43], s3 offen lds
    s_add_u32 s61, s61, 524288
    s_add_u32 m0, s62, 16384
    s_nop 0
    buffer_load_dwordx4 v8, s[36:39], s60 offen offset:0 lds
    buffer_load_dwordx4 v8, s[36:39], s60 offen offset:1024 lds
    buffer_load_dwordx4 v8, s[36:39], s60 offen offset:2048 lds
    buffer_load_dwordx4 v8, s[36:39], s60 offen offset:3072 lds
    s_add_u32 m0, s62, 20480
    s_add_u32 s3, s60, 4096
    buffer_load_dwordx4 v8, s[36:39], s3 offen lds
    s_add_u32 s60, s60, 20480
    s_waitcnt vmcnt(18)
    s_barrier
    s_waitcnt vmcnt(9)
    s_barrier
    s_waitcnt vmcnt(0)
    s_barrier
    s_branch k3_wo_kernel_after3
k3_wo_kernel_cons2:
    s_lshl_b32 s3, s32, 6
    s_lshl_b32 s27, s34, 5
    s_add_u32 s3, s3, s27
    v_add_u32 v9, s3, v3
    v_add_u32 v10, 16, v9
    s_lshl_b32 s3, s34, 9
    s_lshl_b32 s27, s35, 12
    s_add_u32 s3, s3, s27
    v_lshlrev_b32 v11, 10, v4
    v_lshl_add_u32 v11, v3, 4, v11
    v_add_u32 v11, s3, v11
    s_mul_i32 s3, s35, 5120
    s_add_u32 s3, s3, 16384
    v_add_u32 v12, s3, v8
    v_mov_b32 v72, 0
    v_mov_b32 v73, 0
    v_mov_b32 v74, 0
    v_mov_b32 v75, 0
    v_mov_b32 v76, 0
    v_mov_b32 v77, 0
    v_mov_b32 v78, 0
    v_mov_b32 v79, 0
    v_mov_b32 v80, 0
    v_mov_b32 v81, 0
    v_mov_b32 v82, 0
    v_mov_b32 v83, 0
    v_mov_b32 v84, 0
    v_mov_b32 v85, 0
    v_mov_b32 v86, 0
    v_mov_b32 v87, 0
    v_mov_b32 v88, 0
    v_mov_b32 v89, 0
    v_mov_b32 v90, 0
    v_mov_b32 v91, 0
    v_mov_b32 v92, 0
    v_mov_b32 v93, 0
    v_mov_b32 v94, 0
    v_mov_b32 v95, 0
    v_mov_b32 v96, 0
    v_mov_b32 v97, 0
    v_mov_b32 v98, 0
    v_mov_b32 v99, 0
    v_mov_b32 v100, 0
    v_mov_b32 v101, 0
    v_mov_b32 v102, 0
    v_mov_b32 v103, 0
    v_mov_b32 v104, 0
    v_mov_b32 v105, 0
    v_mov_b32 v106, 0
    v_mov_b32 v107, 0
    v_mov_b32 v108, 0
    v_mov_b32 v109, 0
    v_mov_b32 v110, 0
    v_mov_b32 v111, 0
    s_lshl_b32 s3, s34, 10
    v_add_u32 v145, s3, v8
    v_mul_u32_u24 v142, 1280, v9
    s_mul_i32 s3, s33, 160
    v_lshl_add_u32 v142, v4, 3, v142
    v_add_u32 v142, s3, v142
    s_mul_i32 s3, s33, 10
    v_lshrrev_b32 v5, 1, v4
    v_add_u32 v5, s3, v5
    v_lshlrev_b32 v143, 15, v5
    v_lshl_add_u32 v143, v9, 4, v143
    v_and_b32 v5, 1, v4
    v_lshl_add_u32 v143, v5, 3, v143
    s_waitcnt lgkmcnt(0)
    s_mov_b32 s44, s4
    s_and_b32 s45, s5, 0xffff
    s_mov_b32 s46, 2621440
    s_mov_b32 s47, 0x20000
    s_add_u32 s48, s24, 11534336
    s_addc_u32 s49, s25, 0
    s_and_b32 s49, s49, 0xffff
    s_mov_b32 s50, 2621440
    s_mov_b32 s51, 0x20000
    s_add_u32 s52, s24, 14680064
    s_addc_u32 s53, s25, 0
    s_and_b32 s53, s53, 0xffff
    s_mov_b32 s54, 131072
    s_mov_b32 s55, 0x20000
    s_cmp_lg_u32 s35, 0
    s_cbranch_scc1 k3_wo_kernel_noload4
    v_add_u32 v5, 20480, v142
    buffer_load_dwordx2 v[112:113], v142, s[44:47], 0 offen offset:0
    buffer_load_dwordx2 v[114:115], v5, s[44:47], 0 offen offset:0
    buffer_load_dwordx2 v[116:117], v142, s[44:47], 0 offen offset:32
    buffer_load_dwordx2 v[118:119], v5, s[44:47], 0 offen offset:32
    buffer_load_dwordx2 v[120:121], v142, s[44:47], 0 offen offset:64
    buffer_load_dwordx2 v[122:123], v5, s[44:47], 0 offen offset:64
    buffer_load_dwordx2 v[124:125], v142, s[44:47], 0 offen offset:96
    buffer_load_dwordx2 v[126:127], v5, s[44:47], 0 offen offset:96
    buffer_load_dwordx2 v[128:129], v142, s[44:47], 0 offen offset:128
    buffer_load_dwordx2 v[130:131], v5, s[44:47], 0 offen offset:128
k3_wo_kernel_noload4:
    s_waitcnt lgkmcnt(0)
    s_barrier
    v_add_u32 v14, 0, v12
    v_add_u32 v13, 0, v11
    ds_read_b128 v[16:19], v13 offset:0
    ds_read_b128 v[20:23], v13 offset:256
    ds_read_b128 v[32:35], v14 offset:0
    ds_read_b128 v[36:39], v14 offset:1024
    ds_read_b128 v[40:43], v14 offset:2048
    ds_read_b128 v[44:47], v14 offset:3072
    ds_read_b128 v[48:51], v14 offset:4096
    s_waitcnt lgkmcnt(0)
    ds_read_b128 v[24:27], v13 offset:8192
    v_mfma_f32_16x16x32_bf16 v[72:75], v[32:35], v[16:19], v[72:75]
    ds_read_b128 v[28:31], v13 offset:8448
    v_mfma_f32_16x16x32_bf16 v[76:79], v[32:35], v[20:23], v[76:79]
    ds_read_b128 v[52:55], v14 offset:10240
    v_mfma_f32_16x16x32_bf16 v[80:83], v[36:39], v[16:19], v[80:83]
    ds_read_b128 v[56:59], v14 offset:11264
    v_mfma_f32_16x16x32_bf16 v[84:87], v[36:39], v[20:23], v[84:87]
    ds_read_b128 v[60:63], v14 offset:12288
    v_mfma_f32_16x16x32_bf16 v[88:91], v[40:43], v[16:19], v[88:91]
    ds_read_b128 v[64:67], v14 offset:13312
    v_mfma_f32_16x16x32_bf16 v[92:95], v[40:43], v[20:23], v[92:95]
    ds_read_b128 v[68:71], v14 offset:14336
    v_mfma_f32_16x16x32_bf16 v[96:99], v[44:47], v[16:19], v[96:99]
    v_mfma_f32_16x16x32_bf16 v[100:103], v[44:47], v[20:23], v[100:103]
    v_mfma_f32_16x16x32_bf16 v[104:107], v[48:51], v[16:19], v[104:107]
    v_mfma_f32_16x16x32_bf16 v[108:111], v[48:51], v[20:23], v[108:111]
    s_waitcnt lgkmcnt(0)
    s_barrier
    v_add_u32 v14, 32768, v12
    v_add_u32 v13, 32768, v11
    ds_read_b128 v[16:19], v13 offset:4096
    v_mfma_f32_16x16x32_bf16 v[72:75], v[52:55], v[24:27], v[72:75]
    ds_read_b128 v[20:23], v13 offset:4352
    v_mfma_f32_16x16x32_bf16 v[76:79], v[52:55], v[28:31], v[76:79]
    ds_read_b128 v[32:35], v14 offset:4096
    v_mfma_f32_16x16x32_bf16 v[80:83], v[56:59], v[24:27], v[80:83]
    ds_read_b128 v[36:39], v14 offset:5120
    v_mfma_f32_16x16x32_bf16 v[84:87], v[56:59], v[28:31], v[84:87]
    ds_read_b128 v[40:43], v14 offset:6144
    v_mfma_f32_16x16x32_bf16 v[88:91], v[60:63], v[24:27], v[88:91]
    ds_read_b128 v[44:47], v14 offset:7168
    v_mfma_f32_16x16x32_bf16 v[92:95], v[60:63], v[28:31], v[92:95]
    ds_read_b128 v[48:51], v14 offset:8192
    v_mfma_f32_16x16x32_bf16 v[96:99], v[64:67], v[24:27], v[96:99]
    v_mfma_f32_16x16x32_bf16 v[100:103], v[64:67], v[28:31], v[100:103]
    v_mfma_f32_16x16x32_bf16 v[104:107], v[68:71], v[24:27], v[104:107]
    v_mfma_f32_16x16x32_bf16 v[108:111], v[68:71], v[28:31], v[108:111]
    s_waitcnt lgkmcnt(0)
    ds_read_b128 v[24:27], v13 offset:12288
    v_mfma_f32_16x16x32_bf16 v[72:75], v[32:35], v[16:19], v[72:75]
    ds_read_b128 v[28:31], v13 offset:12544
    v_mfma_f32_16x16x32_bf16 v[76:79], v[32:35], v[20:23], v[76:79]
    ds_read_b128 v[52:55], v14 offset:14336
    v_mfma_f32_16x16x32_bf16 v[80:83], v[36:39], v[16:19], v[80:83]
    ds_read_b128 v[56:59], v14 offset:15360
    v_mfma_f32_16x16x32_bf16 v[84:87], v[36:39], v[20:23], v[84:87]
    ds_read_b128 v[60:63], v14 offset:16384
    v_mfma_f32_16x16x32_bf16 v[88:91], v[40:43], v[16:19], v[88:91]
    ds_read_b128 v[64:67], v14 offset:17408
    v_mfma_f32_16x16x32_bf16 v[92:95], v[40:43], v[20:23], v[92:95]
    ds_read_b128 v[68:71], v14 offset:18432
    v_mfma_f32_16x16x32_bf16 v[96:99], v[44:47], v[16:19], v[96:99]
    v_mfma_f32_16x16x32_bf16 v[100:103], v[44:47], v[20:23], v[100:103]
    v_mfma_f32_16x16x32_bf16 v[104:107], v[48:51], v[16:19], v[104:107]
    v_mfma_f32_16x16x32_bf16 v[108:111], v[48:51], v[20:23], v[108:111]
    s_waitcnt lgkmcnt(0)
    s_barrier
    v_add_u32 v14, 65536, v12
    v_add_u32 v13, 65536, v11
    ds_read_b128 v[16:19], v13 offset:8192
    v_mfma_f32_16x16x32_bf16 v[72:75], v[52:55], v[24:27], v[72:75]
    ds_read_b128 v[20:23], v13 offset:8448
    v_mfma_f32_16x16x32_bf16 v[76:79], v[52:55], v[28:31], v[76:79]
    ds_read_b128 v[32:35], v14 offset:8192
    v_mfma_f32_16x16x32_bf16 v[80:83], v[56:59], v[24:27], v[80:83]
    ds_read_b128 v[36:39], v14 offset:9216
    v_mfma_f32_16x16x32_bf16 v[84:87], v[56:59], v[28:31], v[84:87]
    ds_read_b128 v[40:43], v14 offset:10240
    v_mfma_f32_16x16x32_bf16 v[88:91], v[60:63], v[24:27], v[88:91]
    ds_read_b128 v[44:47], v14 offset:11264
    v_mfma_f32_16x16x32_bf16 v[92:95], v[60:63], v[28:31], v[92:95]
    ds_read_b128 v[48:51], v14 offset:12288
    v_mfma_f32_16x16x32_bf16 v[96:99], v[64:67], v[24:27], v[96:99]
    v_mfma_f32_16x16x32_bf16 v[100:103], v[64:67], v[28:31], v[100:103]
    v_mfma_f32_16x16x32_bf16 v[104:107], v[68:71], v[24:27], v[104:107]
    v_mfma_f32_16x16x32_bf16 v[108:111], v[68:71], v[28:31], v[108:111]
    s_waitcnt lgkmcnt(0)
    ds_read_b128 v[24:27], v13 offset:16384
    v_mfma_f32_16x16x32_bf16 v[72:75], v[32:35], v[16:19], v[72:75]
    ds_read_b128 v[28:31], v13 offset:16640
    v_mfma_f32_16x16x32_bf16 v[76:79], v[32:35], v[20:23], v[76:79]
    ds_read_b128 v[52:55], v14 offset:18432
    v_mfma_f32_16x16x32_bf16 v[80:83], v[36:39], v[16:19], v[80:83]
    ds_read_b128 v[56:59], v14 offset:19456
    v_mfma_f32_16x16x32_bf16 v[84:87], v[36:39], v[20:23], v[84:87]
    ds_read_b128 v[60:63], v14 offset:20480
    v_mfma_f32_16x16x32_bf16 v[88:91], v[40:43], v[16:19], v[88:91]
    ds_read_b128 v[64:67], v14 offset:21504
    v_mfma_f32_16x16x32_bf16 v[92:95], v[40:43], v[20:23], v[92:95]
    ds_read_b128 v[68:71], v14 offset:22528
    v_mfma_f32_16x16x32_bf16 v[96:99], v[44:47], v[16:19], v[96:99]
    v_mfma_f32_16x16x32_bf16 v[100:103], v[44:47], v[20:23], v[100:103]
    v_mfma_f32_16x16x32_bf16 v[104:107], v[48:51], v[16:19], v[104:107]
    v_mfma_f32_16x16x32_bf16 v[108:111], v[48:51], v[20:23], v[108:111]
    s_waitcnt lgkmcnt(0)
    s_barrier
    v_add_u32 v14, 98304, v12
    v_add_u32 v13, 98304, v11
    ds_read_b128 v[16:19], v13 offset:12288
    v_mfma_f32_16x16x32_bf16 v[72:75], v[52:55], v[24:27], v[72:75]
    ds_read_b128 v[20:23], v13 offset:12544
    v_mfma_f32_16x16x32_bf16 v[76:79], v[52:55], v[28:31], v[76:79]
    ds_read_b128 v[32:35], v14 offset:12288
    v_mfma_f32_16x16x32_bf16 v[80:83], v[56:59], v[24:27], v[80:83]
    ds_read_b128 v[36:39], v14 offset:13312
    v_mfma_f32_16x16x32_bf16 v[84:87], v[56:59], v[28:31], v[84:87]
    ds_read_b128 v[40:43], v14 offset:14336
    v_mfma_f32_16x16x32_bf16 v[88:91], v[60:63], v[24:27], v[88:91]
    ds_read_b128 v[44:47], v14 offset:15360
    v_mfma_f32_16x16x32_bf16 v[92:95], v[60:63], v[28:31], v[92:95]
    ds_read_b128 v[48:51], v14 offset:16384
    v_mfma_f32_16x16x32_bf16 v[96:99], v[64:67], v[24:27], v[96:99]
    v_mfma_f32_16x16x32_bf16 v[100:103], v[64:67], v[28:31], v[100:103]
    v_mfma_f32_16x16x32_bf16 v[104:107], v[68:71], v[24:27], v[104:107]
    v_mfma_f32_16x16x32_bf16 v[108:111], v[68:71], v[28:31], v[108:111]
    s_waitcnt lgkmcnt(0)
    ds_read_b128 v[24:27], v13 offset:20480
    v_mfma_f32_16x16x32_bf16 v[72:75], v[32:35], v[16:19], v[72:75]
    ds_read_b128 v[28:31], v13 offset:20736
    v_mfma_f32_16x16x32_bf16 v[76:79], v[32:35], v[20:23], v[76:79]
    ds_read_b128 v[52:55], v14 offset:22528
    v_mfma_f32_16x16x32_bf16 v[80:83], v[36:39], v[16:19], v[80:83]
    ds_read_b128 v[56:59], v14 offset:23552
    v_mfma_f32_16x16x32_bf16 v[84:87], v[36:39], v[20:23], v[84:87]
    ds_read_b128 v[60:63], v14 offset:24576
    v_mfma_f32_16x16x32_bf16 v[88:91], v[40:43], v[16:19], v[88:91]
    ds_read_b128 v[64:67], v14 offset:25600
    v_mfma_f32_16x16x32_bf16 v[92:95], v[40:43], v[20:23], v[92:95]
    ds_read_b128 v[68:71], v14 offset:26624
    v_mfma_f32_16x16x32_bf16 v[96:99], v[44:47], v[16:19], v[96:99]
    v_mfma_f32_16x16x32_bf16 v[100:103], v[44:47], v[20:23], v[100:103]
    v_mfma_f32_16x16x32_bf16 v[104:107], v[48:51], v[16:19], v[104:107]
    v_mfma_f32_16x16x32_bf16 v[108:111], v[48:51], v[20:23], v[108:111]
    s_waitcnt lgkmcnt(0)
    s_barrier
    v_add_u32 v14, 0, v12
    v_add_u32 v13, 0, v11
    ds_read_b128 v[16:19], v13 offset:0
    v_mfma_f32_16x16x32_bf16 v[72:75], v[52:55], v[24:27], v[72:75]
    ds_read_b128 v[20:23], v13 offset:256
    v_mfma_f32_16x16x32_bf16 v[76:79], v[52:55], v[28:31], v[76:79]
    ds_read_b128 v[32:35], v14 offset:0
    v_mfma_f32_16x16x32_bf16 v[80:83], v[56:59], v[24:27], v[80:83]
    ds_read_b128 v[36:39], v14 offset:1024
    v_mfma_f32_16x16x32_bf16 v[84:87], v[56:59], v[28:31], v[84:87]
    ds_read_b128 v[40:43], v14 offset:2048
    v_mfma_f32_16x16x32_bf16 v[88:91], v[60:63], v[24:27], v[88:91]
    ds_read_b128 v[44:47], v14 offset:3072
    v_mfma_f32_16x16x32_bf16 v[92:95], v[60:63], v[28:31], v[92:95]
    ds_read_b128 v[48:51], v14 offset:4096
    v_mfma_f32_16x16x32_bf16 v[96:99], v[64:67], v[24:27], v[96:99]
    v_mfma_f32_16x16x32_bf16 v[100:103], v[64:67], v[28:31], v[100:103]
    v_mfma_f32_16x16x32_bf16 v[104:107], v[68:71], v[24:27], v[104:107]
    v_mfma_f32_16x16x32_bf16 v[108:111], v[68:71], v[28:31], v[108:111]
    s_waitcnt lgkmcnt(0)
    ds_read_b128 v[24:27], v13 offset:8192
    v_mfma_f32_16x16x32_bf16 v[72:75], v[32:35], v[16:19], v[72:75]
    ds_read_b128 v[28:31], v13 offset:8448
    v_mfma_f32_16x16x32_bf16 v[76:79], v[32:35], v[20:23], v[76:79]
    ds_read_b128 v[52:55], v14 offset:10240
    v_mfma_f32_16x16x32_bf16 v[80:83], v[36:39], v[16:19], v[80:83]
    ds_read_b128 v[56:59], v14 offset:11264
    v_mfma_f32_16x16x32_bf16 v[84:87], v[36:39], v[20:23], v[84:87]
    ds_read_b128 v[60:63], v14 offset:12288
    v_mfma_f32_16x16x32_bf16 v[88:91], v[40:43], v[16:19], v[88:91]
    ds_read_b128 v[64:67], v14 offset:13312
    v_mfma_f32_16x16x32_bf16 v[92:95], v[40:43], v[20:23], v[92:95]
    ds_read_b128 v[68:71], v14 offset:14336
    v_mfma_f32_16x16x32_bf16 v[96:99], v[44:47], v[16:19], v[96:99]
    v_mfma_f32_16x16x32_bf16 v[100:103], v[44:47], v[20:23], v[100:103]
    v_mfma_f32_16x16x32_bf16 v[104:107], v[48:51], v[16:19], v[104:107]
    v_mfma_f32_16x16x32_bf16 v[108:111], v[48:51], v[20:23], v[108:111]
    s_waitcnt lgkmcnt(0)
    v_mfma_f32_16x16x32_bf16 v[72:75], v[52:55], v[24:27], v[72:75]
    v_mfma_f32_16x16x32_bf16 v[76:79], v[52:55], v[28:31], v[76:79]
    v_mfma_f32_16x16x32_bf16 v[80:83], v[56:59], v[24:27], v[80:83]
    v_mfma_f32_16x16x32_bf16 v[84:87], v[56:59], v[28:31], v[84:87]
    v_mfma_f32_16x16x32_bf16 v[88:91], v[60:63], v[24:27], v[88:91]
    v_mfma_f32_16x16x32_bf16 v[92:95], v[60:63], v[28:31], v[92:95]
    v_mfma_f32_16x16x32_bf16 v[96:99], v[64:67], v[24:27], v[96:99]
    v_mfma_f32_16x16x32_bf16 v[100:103], v[64:67], v[28:31], v[100:103]
    v_mfma_f32_16x16x32_bf16 v[104:107], v[68:71], v[24:27], v[104:107]
    v_mfma_f32_16x16x32_bf16 v[108:111], v[68:71], v[28:31], v[108:111]
    s_nop 7
k3_wo_kernel_after3:
    s_barrier
    s_cmp_ge_u32 s26, 4
    s_cbranch_scc1 k3_wo_kernel_b27
    s_cmp_eq_u32 s35, 0
    s_cbranch_scc1 k3_wo_kernel_h05
    ds_write_b128 v145, v[72:75] offset:0
    ds_write_b128 v145, v[76:79] offset:2048
    ds_write_b128 v145, v[80:83] offset:4096
    ds_write_b128 v145, v[84:87] offset:6144
    ds_write_b128 v145, v[88:91] offset:8192
    ds_write_b128 v145, v[92:95] offset:10240
    ds_write_b128 v145, v[96:99] offset:12288
    ds_write_b128 v145, v[100:103] offset:14336
    ds_write_b128 v145, v[104:107] offset:16384
    ds_write_b128 v145, v[108:111] offset:18432
    s_waitcnt lgkmcnt(0)
    s_branch k3_wo_kernel_b27
k3_wo_kernel_h05:
k3_wo_kernel_b27:
    s_barrier
    s_cmp_ge_u32 s26, 2
    s_cbranch_scc1 k3_wo_kernel_fin6
    ds_read_b128 v[32:35], v145 offset:0
    ds_read_b128 v[52:55], v145 offset:2048
    ds_read_b128 v[36:39], v145 offset:4096
    ds_read_b128 v[56:59], v145 offset:6144
    ds_read_b128 v[40:43], v145 offset:8192
    ds_read_b128 v[60:63], v145 offset:10240
    ds_read_b128 v[44:47], v145 offset:12288
    ds_read_b128 v[64:67], v145 offset:14336
    ds_read_b128 v[48:51], v145 offset:16384
    ds_read_b128 v[68:71], v145 offset:18432
    s_waitcnt vmcnt(0) lgkmcnt(0)
    v_add_f32 v72, v72, v32
    v_add_f32 v73, v73, v33
    v_add_f32 v74, v74, v34
    v_add_f32 v75, v75, v35
    v_lshlrev_b32 v146, 16, v112
    v_and_b32 v147, 0xffff0000, v112
    v_lshlrev_b32 v148, 16, v113
    v_and_b32 v149, 0xffff0000, v113
    v_add_f32 v72, v72, v146
    v_add_f32 v73, v73, v147
    v_add_f32 v74, v74, v148
    v_add_f32 v75, v75, v149
    v_add_f32 v76, v76, v52
    v_add_f32 v77, v77, v53
    v_add_f32 v78, v78, v54
    v_add_f32 v79, v79, v55
    v_lshlrev_b32 v146, 16, v114
    v_and_b32 v147, 0xffff0000, v114
    v_lshlrev_b32 v148, 16, v115
    v_and_b32 v149, 0xffff0000, v115
    v_add_f32 v76, v76, v146
    v_add_f32 v77, v77, v147
    v_add_f32 v78, v78, v148
    v_add_f32 v79, v79, v149
    v_add_f32 v80, v80, v36
    v_add_f32 v81, v81, v37
    v_add_f32 v82, v82, v38
    v_add_f32 v83, v83, v39
    v_lshlrev_b32 v146, 16, v116
    v_and_b32 v147, 0xffff0000, v116
    v_lshlrev_b32 v148, 16, v117
    v_and_b32 v149, 0xffff0000, v117
    v_add_f32 v80, v80, v146
    v_add_f32 v81, v81, v147
    v_add_f32 v82, v82, v148
    v_add_f32 v83, v83, v149
    v_add_f32 v84, v84, v56
    v_add_f32 v85, v85, v57
    v_add_f32 v86, v86, v58
    v_add_f32 v87, v87, v59
    v_lshlrev_b32 v146, 16, v118
    v_and_b32 v147, 0xffff0000, v118
    v_lshlrev_b32 v148, 16, v119
    v_and_b32 v149, 0xffff0000, v119
    v_add_f32 v84, v84, v146
    v_add_f32 v85, v85, v147
    v_add_f32 v86, v86, v148
    v_add_f32 v87, v87, v149
    v_add_f32 v88, v88, v40
    v_add_f32 v89, v89, v41
    v_add_f32 v90, v90, v42
    v_add_f32 v91, v91, v43
    v_lshlrev_b32 v146, 16, v120
    v_and_b32 v147, 0xffff0000, v120
    v_lshlrev_b32 v148, 16, v121
    v_and_b32 v149, 0xffff0000, v121
    v_add_f32 v88, v88, v146
    v_add_f32 v89, v89, v147
    v_add_f32 v90, v90, v148
    v_add_f32 v91, v91, v149
    v_add_f32 v92, v92, v60
    v_add_f32 v93, v93, v61
    v_add_f32 v94, v94, v62
    v_add_f32 v95, v95, v63
    v_lshlrev_b32 v146, 16, v122
    v_and_b32 v147, 0xffff0000, v122
    v_lshlrev_b32 v148, 16, v123
    v_and_b32 v149, 0xffff0000, v123
    v_add_f32 v92, v92, v146
    v_add_f32 v93, v93, v147
    v_add_f32 v94, v94, v148
    v_add_f32 v95, v95, v149
    v_add_f32 v96, v96, v44
    v_add_f32 v97, v97, v45
    v_add_f32 v98, v98, v46
    v_add_f32 v99, v99, v47
    v_lshlrev_b32 v146, 16, v124
    v_and_b32 v147, 0xffff0000, v124
    v_lshlrev_b32 v148, 16, v125
    v_and_b32 v149, 0xffff0000, v125
    v_add_f32 v96, v96, v146
    v_add_f32 v97, v97, v147
    v_add_f32 v98, v98, v148
    v_add_f32 v99, v99, v149
    v_add_f32 v100, v100, v64
    v_add_f32 v101, v101, v65
    v_add_f32 v102, v102, v66
    v_add_f32 v103, v103, v67
    v_lshlrev_b32 v146, 16, v126
    v_and_b32 v147, 0xffff0000, v126
    v_lshlrev_b32 v148, 16, v127
    v_and_b32 v149, 0xffff0000, v127
    v_add_f32 v100, v100, v146
    v_add_f32 v101, v101, v147
    v_add_f32 v102, v102, v148
    v_add_f32 v103, v103, v149
    v_add_f32 v104, v104, v48
    v_add_f32 v105, v105, v49
    v_add_f32 v106, v106, v50
    v_add_f32 v107, v107, v51
    v_lshlrev_b32 v146, 16, v128
    v_and_b32 v147, 0xffff0000, v128
    v_lshlrev_b32 v148, 16, v129
    v_and_b32 v149, 0xffff0000, v129
    v_add_f32 v104, v104, v146
    v_add_f32 v105, v105, v147
    v_add_f32 v106, v106, v148
    v_add_f32 v107, v107, v149
    v_add_f32 v108, v108, v68
    v_add_f32 v109, v109, v69
    v_add_f32 v110, v110, v70
    v_add_f32 v111, v111, v71
    v_lshlrev_b32 v146, 16, v130
    v_and_b32 v147, 0xffff0000, v130
    v_lshlrev_b32 v148, 16, v131
    v_and_b32 v149, 0xffff0000, v131
    v_add_f32 v108, v108, v146
    v_add_f32 v109, v109, v147
    v_add_f32 v110, v110, v148
    v_add_f32 v111, v111, v149
    v_and_b32 v5, 1, v4
    v_lshlrev_b32 v5, 1, v5
    v_lshrrev_b32 v6, 1, v4
    v_add_u32 v5, v5, v6
    s_mul_i32 s3, s33, 10
    v_add_u32 v6, s3, v5
    v_lshlrev_b32 v164, 15, v6
    v_lshl_add_u32 v164, v9, 4, v164
    v_mov_b32 v165, 0
    v_mov_b32 v166, 0
    v_mov_b32 v167, 0
    v_mov_b32 v168, 0
    v_cvt_pk_bf16_f32 v152, v72, v73
    v_cvt_pk_bf16_f32 v153, v74, v75
    v_cvt_pk_bf16_f32 v154, v80, v81
    v_cvt_pk_bf16_f32 v155, v82, v83
    v_lshlrev_b32 v146, 16, v152
    v_and_b32 v147, 0xffff0000, v152
    v_add_f32 v165, v165, v146
    v_fmac_f32 v167, v146, v146
    v_add_f32 v165, v165, v147
    v_fmac_f32 v167, v147, v147
    v_lshlrev_b32 v146, 16, v153
    v_and_b32 v147, 0xffff0000, v153
    v_add_f32 v165, v165, v146
    v_fmac_f32 v167, v146, v146
    v_add_f32 v165, v165, v147
    v_fmac_f32 v167, v147, v147
    v_lshlrev_b32 v146, 16, v154
    v_and_b32 v147, 0xffff0000, v154
    v_add_f32 v165, v165, v146
    v_fmac_f32 v167, v146, v146
    v_add_f32 v165, v165, v147
    v_fmac_f32 v167, v147, v147
    v_lshlrev_b32 v146, 16, v155
    v_and_b32 v147, 0xffff0000, v155
    v_add_f32 v165, v165, v146
    v_fmac_f32 v167, v146, v146
    v_add_f32 v165, v165, v147
    v_fmac_f32 v167, v147, v147
    v_permlane16_swap_b32 v152, v154
    v_permlane16_swap_b32 v153, v155
    s_nop 1
    s_mov_b32 s64, 0
    buffer_store_dwordx4 v[152:155], v164, s[48:51], s64 offen offset:0 sc1
    v_cvt_pk_bf16_f32 v156, v88, v89
    v_cvt_pk_bf16_f32 v157, v90, v91
    v_cvt_pk_bf16_f32 v158, v96, v97
    v_cvt_pk_bf16_f32 v159, v98, v99
    v_lshlrev_b32 v146, 16, v156
    v_and_b32 v147, 0xffff0000, v156
    v_add_f32 v165, v165, v146
    v_fmac_f32 v167, v146, v146
    v_add_f32 v165, v165, v147
    v_fmac_f32 v167, v147, v147
    v_lshlrev_b32 v146, 16, v157
    v_and_b32 v147, 0xffff0000, v157
    v_add_f32 v165, v165, v146
    v_fmac_f32 v167, v146, v146
    v_add_f32 v165, v165, v147
    v_fmac_f32 v167, v147, v147
    v_lshlrev_b32 v146, 16, v158
    v_and_b32 v147, 0xffff0000, v158
    v_add_f32 v165, v165, v146
    v_fmac_f32 v167, v146, v146
    v_add_f32 v165, v165, v147
    v_fmac_f32 v167, v147, v147
    v_lshlrev_b32 v146, 16, v159
    v_and_b32 v147, 0xffff0000, v159
    v_add_f32 v165, v165, v146
    v_fmac_f32 v167, v146, v146
    v_add_f32 v165, v165, v147
    v_fmac_f32 v167, v147, v147
    v_permlane16_swap_b32 v156, v158
    v_permlane16_swap_b32 v157, v159
    s_nop 1
    s_mov_b32 s64, 131072
    buffer_store_dwordx4 v[156:159], v164, s[48:51], s64 offen offset:0 sc1
    v_cvt_pk_bf16_f32 v160, v104, v105
    v_cvt_pk_bf16_f32 v161, v106, v107
    s_mov_b32 s64, 262144
    buffer_store_dwordx2 v[160:161], v143, s[48:51], s64 offen offset:0 sc1
    v_lshlrev_b32 v146, 16, v160
    v_and_b32 v147, 0xffff0000, v160
    v_add_f32 v165, v165, v146
    v_fmac_f32 v167, v146, v146
    v_add_f32 v165, v165, v147
    v_fmac_f32 v167, v147, v147
    v_lshlrev_b32 v146, 16, v161
    v_and_b32 v147, 0xffff0000, v161
    v_add_f32 v165, v165, v146
    v_fmac_f32 v167, v146, v146
    v_add_f32 v165, v165, v147
    v_fmac_f32 v167, v147, v147
    v_cvt_pk_bf16_f32 v152, v76, v77
    v_cvt_pk_bf16_f32 v153, v78, v79
    v_cvt_pk_bf16_f32 v154, v84, v85
    v_cvt_pk_bf16_f32 v155, v86, v87
    v_lshlrev_b32 v146, 16, v152
    v_and_b32 v147, 0xffff0000, v152
    v_add_f32 v166, v166, v146
    v_fmac_f32 v168, v146, v146
    v_add_f32 v166, v166, v147
    v_fmac_f32 v168, v147, v147
    v_lshlrev_b32 v146, 16, v153
    v_and_b32 v147, 0xffff0000, v153
    v_add_f32 v166, v166, v146
    v_fmac_f32 v168, v146, v146
    v_add_f32 v166, v166, v147
    v_fmac_f32 v168, v147, v147
    v_lshlrev_b32 v146, 16, v154
    v_and_b32 v147, 0xffff0000, v154
    v_add_f32 v166, v166, v146
    v_fmac_f32 v168, v146, v146
    v_add_f32 v166, v166, v147
    v_fmac_f32 v168, v147, v147
    v_lshlrev_b32 v146, 16, v155
    v_and_b32 v147, 0xffff0000, v155
    v_add_f32 v166, v166, v146
    v_fmac_f32 v168, v146, v146
    v_add_f32 v166, v166, v147
    v_fmac_f32 v168, v147, v147
    v_permlane16_swap_b32 v152, v154
    v_permlane16_swap_b32 v153, v155
    s_nop 1
    s_mov_b32 s64, 0
    buffer_store_dwordx4 v[152:155], v164, s[48:51], s64 offen offset:256 sc1
    v_cvt_pk_bf16_f32 v156, v92, v93
    v_cvt_pk_bf16_f32 v157, v94, v95
    v_cvt_pk_bf16_f32 v158, v100, v101
    v_cvt_pk_bf16_f32 v159, v102, v103
    v_lshlrev_b32 v146, 16, v156
    v_and_b32 v147, 0xffff0000, v156
    v_add_f32 v166, v166, v146
    v_fmac_f32 v168, v146, v146
    v_add_f32 v166, v166, v147
    v_fmac_f32 v168, v147, v147
    v_lshlrev_b32 v146, 16, v157
    v_and_b32 v147, 0xffff0000, v157
    v_add_f32 v166, v166, v146
    v_fmac_f32 v168, v146, v146
    v_add_f32 v166, v166, v147
    v_fmac_f32 v168, v147, v147
    v_lshlrev_b32 v146, 16, v158
    v_and_b32 v147, 0xffff0000, v158
    v_add_f32 v166, v166, v146
    v_fmac_f32 v168, v146, v146
    v_add_f32 v166, v166, v147
    v_fmac_f32 v168, v147, v147
    v_lshlrev_b32 v146, 16, v159
    v_and_b32 v147, 0xffff0000, v159
    v_add_f32 v166, v166, v146
    v_fmac_f32 v168, v146, v146
    v_add_f32 v166, v166, v147
    v_fmac_f32 v168, v147, v147
    v_permlane16_swap_b32 v156, v158
    v_permlane16_swap_b32 v157, v159
    s_nop 1
    s_mov_b32 s64, 131072
    buffer_store_dwordx4 v[156:159], v164, s[48:51], s64 offen offset:256 sc1
    v_cvt_pk_bf16_f32 v160, v108, v109
    v_cvt_pk_bf16_f32 v161, v110, v111
    s_mov_b32 s64, 262144
    buffer_store_dwordx2 v[160:161], v143, s[48:51], s64 offen offset:256 sc1
    v_lshlrev_b32 v146, 16, v160
    v_and_b32 v147, 0xffff0000, v160
    v_add_f32 v166, v166, v146
    v_fmac_f32 v168, v146, v146
    v_add_f32 v166, v166, v147
    v_fmac_f32 v168, v147, v147
    v_lshlrev_b32 v146, 16, v161
    v_and_b32 v147, 0xffff0000, v161
    v_add_f32 v166, v166, v146
    v_fmac_f32 v168, v146, v146
    v_add_f32 v166, v166, v147
    v_fmac_f32 v168, v147, v147
    v_mov_b32 v146, v165
    v_mov_b32 v147, v166
    v_mov_b32 v148, v167
    v_mov_b32 v149, v168
    s_nop 1
    v_permlane16_swap_b32 v165, v146
    v_permlane16_swap_b32 v166, v147
    v_permlane16_swap_b32 v167, v148
    v_permlane16_swap_b32 v168, v149
    s_nop 1
    v_add_f32 v165, v165, v146
    v_add_f32 v166, v166, v147
    v_add_f32 v167, v167, v148
    v_add_f32 v168, v168, v149
    v_mov_b32 v146, v165
    v_mov_b32 v147, v166
    v_mov_b32 v148, v167
    v_mov_b32 v149, v168
    s_nop 1
    v_permlane32_swap_b32 v165, v146
    v_permlane32_swap_b32 v166, v147
    v_permlane32_swap_b32 v167, v148
    v_permlane32_swap_b32 v168, v149
    s_nop 1
    v_add_f32 v165, v165, v146
    v_add_f32 v166, v166, v147
    v_add_f32 v167, v167, v148
    v_add_f32 v168, v168, v149
    v_mov_b32 v152, v165
    v_mov_b32 v153, v167
    s_lshl_b32 s3, s33, 14
    v_lshlrev_b32 v5, 3, v9
    v_add_u32 v5, s3, v5
    v_lshl_or_b32 v5, v4, 28, v5
    buffer_store_dwordx2 v[152:153], v5, s[52:55], 0 offen sc1
    v_mov_b32 v156, v166
    v_mov_b32 v157, v168
    s_lshl_b32 s3, s33, 14
    v_lshlrev_b32 v5, 3, v10
    v_add_u32 v5, s3, v5
    v_lshl_or_b32 v5, v4, 28, v5
    buffer_store_dwordx2 v[156:157], v5, s[52:55], 0 offen sc1
k3_wo_kernel_fin6:
k3_wo_kernel_end1:
    s_endpgm
.globl k4_w1_kernel
.p2align 8
.type k4_w1_kernel,@function
k4_w1_kernel:
    s_cmp_ge_u32 s2, 256
    s_cbranch_scc1 k4_w1_kernel_end1
    s_load_dwordx16 s[4:19], s[0:1], 0
    s_load_dwordx4 s[20:23], s[0:1], 64
    s_load_dwordx2 s[24:25], s[0:1], 80
    v_lshrrev_b32 v5, 6, v0
    v_and_b32 v2, 63, v0
    v_readfirstlane_b32 s26, v5
    v_and_b32 v3, 15, v2
    v_lshrrev_b32 v4, 4, v2
    s_and_b32 s29, s26, 3
    s_and_b32 s27, s2, 7
    s_lshr_b32 s28, s2, 3
    s_lshl_b32 s30, s27, 1
    s_and_b32 s3, s28, 1
    s_add_u32 s30, s30, s3
    s_lshr_b32 s31, s28, 1
    s_lshr_b32 s32, s29, 1
    s_and_b32 s33, s29, 1
    v_lshlrev_b32 v8, 4, v2
    s_cmp_lt_u32 s26, 4
    s_cbranch_scc1 k4_w1_kernel_cons2
    s_lshl_b32 s58, s29, 12
    s_mul_i32 s59, s29, 3072
    s_lshl_b32 s56, s29, 16
    s_lshl_b32 s3, s30, 11
    s_add_u32 s56, s56, s3
    s_mul_i32 s57, s31, 122880
    s_add_u32 s57, s57, s59
    s_waitcnt lgkmcnt(0)
    s_add_u32 s36, s24, 11534336
    s_addc_u32 s37, s25, 0
    s_and_b32 s37, s37, 0xffff
    s_mov_b32 s38, 2621440
    s_mov_b32 s39, 0x20000
    s_add_u32 s40, s24, 26214400
    s_addc_u32 s41, s25, 0
    s_and_b32 s41, s41, 0xffff
    s_mov_b32 s42, 1966080
    s_mov_b32 s43, 0x20000
    s_add_u32 m0, s58, 0
    s_add_u32 s3, s56, 0
    buffer_load_dwordx4 v8, s[36:39], s3 offen lds
    buffer_load_dwordx4 v8, s[36:39], s3 offen offset:1024 lds
    s_add_u32 m0, s58, 2048
    s_add_u32 s3, s56, 32768
    buffer_load_dwordx4 v8, s[36:39], s3 offen lds
    buffer_load_dwordx4 v8, s[36:39], s3 offen offset:1024 lds
    s_add_u32 m0, s59, 16384
    s_nop 0
    buffer_load_dwordx4 v8, s[40:43], s57 offen offset:0 lds
    buffer_load_dwordx4 v8, s[40:43], s57 offen offset:1024 lds
    buffer_load_dwordx4 v8, s[40:43], s57 offen offset:2048 lds
    s_add_u32 s56, s56, 262144
    s_add_u32 s57, s57, 12288
    s_add_u32 m0, s58, 28672
    s_add_u32 s3, s56, 0
    buffer_load_dwordx4 v8, s[36:39], s3 offen lds
    buffer_load_dwordx4 v8, s[36:39], s3 offen offset:1024 lds
    s_add_u32 m0, s58, 30720
    s_add_u32 s3, s56, 32768
    buffer_load_dwordx4 v8, s[36:39], s3 offen lds
    buffer_load_dwordx4 v8, s[36:39], s3 offen offset:1024 lds
    s_add_u32 m0, s59, 45056
    s_nop 0
    buffer_load_dwordx4 v8, s[40:43], s57 offen offset:0 lds
    buffer_load_dwordx4 v8, s[40:43], s57 offen offset:1024 lds
    buffer_load_dwordx4 v8, s[40:43], s57 offen offset:2048 lds
    s_add_u32 s56, s56, 262144
    s_add_u32 s57, s57, 12288
    s_waitcnt vmcnt(7)
    s_barrier
    s_add_u32 m0, s58, 57344
    s_add_u32 s3, s56, 0
    buffer_load_dwordx4 v8, s[36:39], s3 offen lds
    buffer_load_dwordx4 v8, s[36:39], s3 offen offset:1024 lds
    s_add_u32 m0, s58, 59392
    s_add_u32 s3, s56, 32768
    buffer_load_dwordx4 v8, s[36:39], s3 offen lds
    buffer_load_dwordx4 v8, s[36:39], s3 offen offset:1024 lds
    s_add_u32 m0, s59, 73728
    s_nop 0
    buffer_load_dwordx4 v8, s[40:43], s57 offen offset:0 lds
    buffer_load_dwordx4 v8, s[40:43], s57 offen offset:1024 lds
    buffer_load_dwordx4 v8, s[40:43], s57 offen offset:2048 lds
    s_add_u32 s56, s56, 262144
    s_add_u32 s57, s57, 12288
    s_add_u32 m0, s58, 86016
    s_add_u32 s3, s56, 0
    buffer_load_dwordx4 v8, s[36:39], s3 offen lds
    buffer_load_dwordx4 v8, s[36:39], s3 offen offset:1024 lds
    s_add_u32 m0, s58, 88064
    s_add_u32 s3, s56, 32768
    buffer_load_dwordx4 v8, s[36:39], s3 offen lds
    buffer_load_dwordx4 v8, s[36:39], s3 offen offset:1024 lds
    s_add_u32 m0, s59, 102400
    s_nop 0
    buffer_load_dwordx4 v8, s[40:43], s57 offen offset:0 lds
    buffer_load_dwordx4 v8, s[40:43], s57 offen offset:1024 lds
    buffer_load_dwordx4 v8, s[40:43], s57 offen offset:2048 lds
    s_add_u32 s56, s56, 262144
    s_add_u32 s57, s57, 12288
    s_waitcnt vmcnt(14)
    s_barrier
    s_add_u32 m0, s58, 0
    s_add_u32 s3, s56, 0
    buffer_load_dwordx4 v8, s[36:39], s3 offen lds
    buffer_load_dwordx4 v8, s[36:39], s3 offen offset:1024 lds
    s_add_u32 m0, s58, 2048
    s_add_u32 s3, s56, 32768
    buffer_load_dwordx4 v8, s[36:39], s3 offen lds
    buffer_load_dwordx4 v8, s[36:39], s3 offen offset:1024 lds
    s_add_u32 m0, s59, 16384
    s_nop 0
    buffer_load_dwordx4 v8, s[40:43], s57 offen offset:0 lds
    buffer_load_dwordx4 v8, s[40:43], s57 offen offset:1024 lds
    buffer_load_dwordx4 v8, s[40:43], s57 offen offset:2048 lds
    s_add_u32 s56, s56, 262144
    s_add_u32 s57, s57, 12288
    s_waitcnt vmcnt(14)
    s_barrier
    s_add_u32 m0, s58, 28672
    s_add_u32 s3, s56, 0
    buffer_load_dwordx4 v8, s[36:39], s3 offen lds
    buffer_load_dwordx4 v8, s[36:39], s3 offen offset:1024 lds
    s_add_u32 m0, s58, 30720
    s_add_u32 s3, s56, 32768
    buffer_load_dwordx4 v8, s[36:39], s3 offen lds
    buffer_load_dwordx4 v8, s[36:39], s3 offen offset:1024 lds
    s_add_u32 m0, s59, 45056
    s_nop 0
    buffer_load_dwordx4 v8, s[40:43], s57 offen offset:0 lds
    buffer_load_dwordx4 v8, s[40:43], s57 offen offset:1024 lds
    buffer_load_dwordx4 v8, s[40:43], s57 offen offset:2048 lds
    s_add_u32 s56, s56, 262144
    s_add_u32 s57, s57, 12288
    s_waitcnt vmcnt(14)
    s_barrier
    s_add_u32 m0, s58, 57344
    s_add_u32 s3, s56, 0
    buffer_load_dwordx4 v8, s[36:39], s3 offen lds
    buffer_load_dwordx4 v8, s[36:39], s3 offen offset:1024 lds
    s_add_u32 m0, s58, 59392
    s_add_u32 s3, s56, 32768
    buffer_load_dwordx4 v8, s[36:39], s3 offen lds
    buffer_load_dwordx4 v8, s[36:39], s3 offen offset:1024 lds
    s_add_u32 m0, s59, 73728
    s_nop 0
    buffer_load_dwordx4 v8, s[40:43], s57 offen offset:0 lds
    buffer_load_dwordx4 v8, s[40:43], s57 offen offset:1024 lds
    buffer_load_dwordx4 v8, s[40:43], s57 offen offset:2048 lds
    s_add_u32 s56, s56, 262144
    s_add_u32 s57, s57, 12288
    s_waitcnt vmcnt(14)
    s_barrier
    s_add_u32 m0, s58, 86016
    s_add_u32 s3, s56, 0
    buffer_load_dwordx4 v8, s[36:39], s3 offen lds
    buffer_load_dwordx4 v8, s[36:39], s3 offen offset:1024 lds
    s_add_u32 m0, s58, 88064
    s_add_u32 s3, s56, 32768
    buffer_load_dwordx4 v8, s[36:39], s3 offen lds
    buffer_load_dwordx4 v8, s[36:39], s3 offen offset:1024 lds
    s_add_u32 m0, s59, 102400
    s_nop 0
    buffer_load_dwordx4 v8, s[40:43], s57 offen offset:0 lds
    buffer_load_dwordx4 v8, s[40:43], s57 offen offset:1024 lds
    buffer_load_dwordx4 v8, s[40:43], s57 offen offset:2048 lds
    s_add_u32 s56, s56, 262144
    s_add_u32 s57, s57, 12288
    s_waitcnt vmcnt(14)
    s_barrier
    s_add_u32 m0, s58, 0
    s_add_u32 s3, s56, 0
    buffer_load_dwordx4 v8, s[36:39], s3 offen lds
    buffer_load_dwordx4 v8, s[36:39], s3 offen offset:1024 lds
    s_add_u32 m0, s58, 2048
    s_add_u32 s3, s56, 32768
    buffer_load_dwordx4 v8, s[36:39], s3 offen lds
    buffer_load_dwordx4 v8, s[36:39], s3 offen offset:1024 lds
    s_add_u32 m0, s59, 16384
    s_nop 0
    buffer_load_dwordx4 v8, s[40:43], s57 offen offset:0 lds
    buffer_load_dwordx4 v8, s[40:43], s57 offen offset:1024 lds
    buffer_load_dwordx4 v8, s[40:43], s57 offen offset:2048 lds
    s_add_u32 s56, s56, 262144
    s_add_u32 s57, s57, 12288
    s_waitcnt vmcnt(14)
    s_barrier
    s_add_u32 m0, s58, 28672
    s_add_u32 s3, s56, 0
    buffer_load_dwordx4 v8, s[36:39], s3 offen lds
    buffer_load_dwordx4 v8, s[36:39], s3 offen offset:1024 lds
    s_add_u32 m0, s58, 30720
    s_add_u32 s3, s56, 32768
    buffer_load_dwordx4 v8, s[36:39], s3 offen lds
    buffer_load_dwordx4 v8, s[36:39], s3 offen offset:1024 lds
    s_add_u32 m0, s59, 45056
    s_nop 0
    buffer_load_dwordx4 v8, s[40:43], s57 offen offset:0 lds
    buffer_load_dwordx4 v8, s[40:43], s57 offen offset:1024 lds
    buffer_load_dwordx4 v8, s[40:43], s57 offen offset:2048 lds
    s_add_u32 s56, s56, 262144
    s_add_u32 s57, s57, 12288
    s_waitcnt vmcnt(14)
    s_barrier
    s_waitcnt vmcnt(7)
    s_barrier
    s_waitcnt vmcnt(0)
    s_barrier
    s_branch k4_w1_kernel_after3
k4_w1_kernel_cons2:
    v_mov_b32 v132, 0x3f803f80
    v_mov_b32 v133, 0x3f803f80
    v_mov_b32 v134, 0x3f803f80
    v_mov_b32 v135, 0x3f803f80
    v_lshlrev_b32 v5, 11, v4
    s_lshl_b32 s3, s32, 6
    v_add_u32 v6, s3, v3
    v_lshl_add_u32 v9, v6, 4, v5
    s_lshl_b32 s3, s32, 1
    s_add_u32 s3, s3, 0
    s_cmp_ge_u32 s3, 3
    s_cselect_b32 s27, 3, 0
    s_sub_u32 s3, s3, s27
    s_cmp_ge_u32 s3, 3
    s_cselect_b32 s27, 3, 0
    s_sub_u32 s3, s3, s27
    s_mul_i32 s27, s33, 3
    s_add_u32 s60, s3, s27
    s_lshl_b32 s3, s60, 10
    s_add_u32 s3, s3, 16384
    v_add_u32 v10, s3, v8
    s_lshl_b32 s3, s32, 1
    s_add_u32 s3, s3, 1
    s_cmp_ge_u32 s3, 3
    s_cselect_b32 s27, 3, 0
    s_sub_u32 s3, s3, s27
    s_cmp_ge_u32 s3, 3
    s_cselect_b32 s27, 3, 0
    s_sub_u32 s3, s3, s27
    s_mul_i32 s27, s33, 3
    s_add_u32 s61, s3, s27
    s_lshl_b32 s3, s61, 10
    s_add_u32 s3, s3, 16384
    v_add_u32 v11, s3, v8
    s_lshl_b32 s3, s32, 1
    s_add_u32 s3, s3, 2
    s_cmp_ge_u32 s3, 3
    s_cselect_b32 s27, 3, 0
    s_sub_u32 s3, s3, s27
    s_cmp_ge_u32 s3, 3
    s_cselect_b32 s27, 3, 0
    s_sub_u32 s3, s3, s27
    s_mul_i32 s27, s33, 3
    s_add_u32 s62, s3, s27
    s_lshl_b32 s3, s62, 10
    s_add_u32 s3, s3, 16384
    v_add_u32 v12, s3, v8
    v_mov_b32 v76, 0
    v_mov_b32 v77, 0
    v_mov_b32 v78, 0
    v_mov_b32 v79, 0
    v_mov_b32 v80, 0
    v_mov_b32 v81, 0
    v_mov_b32 v82, 0
    v_mov_b32 v83, 0
    v_mov_b32 v84, 0
    v_mov_b32 v85, 0
    v_mov_b32 v86, 0
    v_mov_b32 v87, 0
    v_mov_b32 v88, 0
    v_mov_b32 v89, 0
    v_mov_b32 v90, 0
    v_mov_b32 v91, 0
    v_mov_b32 v92, 0
    v_mov_b32 v93, 0
    v_mov_b32 v94, 0
    v_mov_b32 v95, 0
    v_mov_b32 v96, 0
    v_mov_b32 v97, 0
    v_mov_b32 v98, 0
    v_mov_b32 v99, 0
    v_mov_b32 v100, 0
    v_mov_b32 v101, 0
    v_mov_b32 v102, 0
    v_mov_b32 v103, 0
    v_mov_b32 v104, 0
    v_mov_b32 v105, 0
    v_mov_b32 v106, 0
    v_mov_b32 v107, 0
    v_mov_b32 v108, 0
    v_mov_b32 v109, 0
    v_mov_b32 v110, 0
    v_mov_b32 v111, 0
    v_mov_b32 v112, 0
    v_mov_b32 v113, 0
    v_mov_b32 v114, 0
    v_mov_b32 v115, 0
    v_mov_b32 v116, 0
    v_mov_b32 v117, 0
    v_mov_b32 v118, 0
    v_mov_b32 v119, 0
    v_mov_b32 v120, 0
    v_mov_b32 v121, 0
    v_mov_b32 v122, 0
    v_mov_b32 v123, 0
    v_mov_b32 v124, 0
    v_mov_b32 v125, 0
    v_mov_b32 v126, 0
    v_mov_b32 v127, 0
    v_mov_b32 v128, 0
    v_mov_b32 v129, 0
    v_mov_b32 v130, 0
    v_mov_b32 v131, 0
    s_lshl_b32 s3, s30, 7
    s_lshl_b32 s27, s32, 6
    s_add_u32 s3, s3, s27
    v_add_u32 v136, s3, v3
    s_waitcnt lgkmcnt(0)
    s_add_u32 s44, s24, 16777216
    s_addc_u32 s45, s25, 0
    s_and_b32 s45, s45, 0xffff
    s_mov_b32 s46, 6291456
    s_mov_b32 s47, 0x20000
    s_add_u32 s48, s24, 14680064
    s_addc_u32 s49, s25, 0
    s_and_b32 s49, s49, 0xffff
    s_mov_b32 s50, 131072
    s_mov_b32 s51, 0x20000
    s_mov_b32 s52, s14
    s_and_b32 s53, s15, 0xffff
    s_mov_b32 s54, 3072
    s_mov_b32 s55, 0x20000
    s_mul_i32 s3, s31, 192
    s_lshl_b32 s27, s60, 5
    s_add_u32 s3, s3, s27
    v_lshlrev_b32 v6, 3, v4
    v_add_u32 v6, s3, v6
    buffer_load_dwordx2 v[154:155], v6, s[52:55], 0 offen
    s_mul_i32 s3, s31, 192
    s_lshl_b32 s27, s61, 5
    s_add_u32 s3, s3, s27
    v_lshlrev_b32 v6, 3, v4
    v_add_u32 v6, s3, v6
    buffer_load_dwordx2 v[156:157], v6, s[52:55], 0 offen
    s_mul_i32 s3, s31, 192
    s_lshl_b32 s27, s62, 5
    s_add_u32 s3, s3, s27
    v_lshlrev_b32 v6, 3, v4
    v_add_u32 v6, s3, v6
    buffer_load_dwordx2 v[158:159], v6, s[52:55], 0 offen
    s_waitcnt lgkmcnt(0)
    s_barrier
    v_lshlrev_b32 v5, 15, v4
    v_lshl_add_u32 v5, v136, 3, v5
    v_add_u32 v6, 0, v5
    buffer_load_dwordx2 v[138:139], v6, s[48:51], 0 offen
    v_add_u32 v6, 16384, v5
    buffer_load_dwordx2 v[140:141], v6, s[48:51], 0 offen
    v_add_u32 v6, 128, v5
    buffer_load_dwordx2 v[142:143], v6, s[48:51], 0 offen
    v_add_u32 v6, 16512, v5
    buffer_load_dwordx2 v[144:145], v6, s[48:51], 0 offen
    v_add_u32 v6, 256, v5
    buffer_load_dwordx2 v[146:147], v6, s[48:51], 0 offen
    v_add_u32 v6, 16640, v5
    buffer_load_dwordx2 v[148:149], v6, s[48:51], 0 offen
    v_add_u32 v6, 384, v5
    buffer_load_dwordx2 v[150:151], v6, s[48:51], 0 offen
    v_add_u32 v6, 16768, v5
    buffer_load_dwordx2 v[152:153], v6, s[48:51], 0 offen
    v_add_u32 v13, 0, v9
    v_add_u32 v14, 0, v10
    v_add_u32 v15, 0, v11
    v_add_u32 v16, 0, v12
    ds_read_b128 v[20:23], v13 offset:0
    ds_read_b128 v[52:55], v14 offset:0
    ds_read_b128 v[24:27], v13 offset:256
    ds_read_b128 v[56:59], v15 offset:0
    ds_read_b128 v[28:31], v13 offset:512
    ds_read_b128 v[60:63], v16 offset:0
    ds_read_b128 v[32:35], v13 offset:768
    s_waitcnt lgkmcnt(0)
    ds_read_b128 v[36:39], v13 offset:8192
    v_mfma_f32_16x16x32_bf16 v[76:79], v[52:55], v[20:23], v[76:79]
    ds_read_b128 v[64:67], v14 offset:6144
    v_mfma_f32_16x16x32_bf16 v[92:95], v[56:59], v[20:23], v[92:95]
    ds_read_b128 v[40:43], v13 offset:8448
    v_mfma_f32_16x16x32_bf16 v[108:111], v[60:63], v[20:23], v[108:111]
    ds_read_b128 v[68:71], v15 offset:6144
    v_mfma_f32_16x16x32_bf16 v[80:83], v[52:55], v[24:27], v[80:83]
    ds_read_b128 v[44:47], v13 offset:8704
    v_mfma_f32_16x16x32_bf16 v[96:99], v[56:59], v[24:27], v[96:99]
    ds_read_b128 v[72:75], v16 offset:6144
    v_mfma_f32_16x16x32_bf16 v[112:115], v[60:63], v[24:27], v[112:115]
    ds_read_b128 v[48:51], v13 offset:8960
    v_mfma_f32_16x16x32_bf16 v[84:87], v[52:55], v[28:31], v[84:87]
    v_mfma_f32_16x16x32_bf16 v[100:103], v[56:59], v[28:31], v[100:103]
    v_mfma_f32_16x16x32_bf16 v[116:119], v[60:63], v[28:31], v[116:119]
    v_mfma_f32_16x16x32_bf16 v[88:91], v[52:55], v[32:35], v[88:91]
    v_mfma_f32_16x16x32_bf16 v[104:107], v[56:59], v[32:35], v[104:107]
    v_mfma_f32_16x16x32_bf16 v[120:123], v[60:63], v[32:35], v[120:123]
    v_mfma_f32_16x16x32_bf16 v[124:127], v[52:55], v[132:135], v[124:127]
    v_mfma_f32_16x16x32_bf16 v[128:131], v[56:59], v[132:135], v[128:131]
    s_waitcnt lgkmcnt(0)
    s_barrier
    ds_read_b128 v[20:23], v13 offset:28672
    v_mfma_f32_16x16x32_bf16 v[76:79], v[64:67], v[36:39], v[76:79]
    ds_read_b128 v[52:55], v14 offset:28672
    v_mfma_f32_16x16x32_bf16 v[92:95], v[68:71], v[36:39], v[92:95]
    ds_read_b128 v[24:27], v13 offset:28928
    v_mfma_f32_16x16x32_bf16 v[108:111], v[72:75], v[36:39], v[108:111]
    ds_read_b128 v[56:59], v15 offset:28672
    v_mfma_f32_16x16x32_bf16 v[80:83], v[64:67], v[40:43], v[80:83]
    ds_read_b128 v[28:31], v13 offset:29184
    v_mfma_f32_16x16x32_bf16 v[96:99], v[68:71], v[40:43], v[96:99]
    ds_read_b128 v[60:63], v16 offset:28672
    v_mfma_f32_16x16x32_bf16 v[112:115], v[72:75], v[40:43], v[112:115]
    ds_read_b128 v[32:35], v13 offset:29440
    v_mfma_f32_16x16x32_bf16 v[84:87], v[64:67], v[44:47], v[84:87]
    v_mfma_f32_16x16x32_bf16 v[100:103], v[68:71], v[44:47], v[100:103]
    v_mfma_f32_16x16x32_bf16 v[116:119], v[72:75], v[44:47], v[116:119]
    v_mfma_f32_16x16x32_bf16 v[88:91], v[64:67], v[48:51], v[88:91]
    v_mfma_f32_16x16x32_bf16 v[104:107], v[68:71], v[48:51], v[104:107]
    v_mfma_f32_16x16x32_bf16 v[120:123], v[72:75], v[48:51], v[120:123]
    v_mfma_f32_16x16x32_bf16 v[124:127], v[64:67], v[132:135], v[124:127]
    v_mfma_f32_16x16x32_bf16 v[128:131], v[68:71], v[132:135], v[128:131]
    s_waitcnt lgkmcnt(0)
    ds_read_b128 v[36:39], v13 offset:36864
    v_mfma_f32_16x16x32_bf16 v[76:79], v[52:55], v[20:23], v[76:79]
    ds_read_b128 v[64:67], v14 offset:34816
    v_mfma_f32_16x16x32_bf16 v[92:95], v[56:59], v[20:23], v[92:95]
    ds_read_b128 v[40:43], v13 offset:37120
    v_mfma_f32_16x16x32_bf16 v[108:111], v[60:63], v[20:23], v[108:111]
    ds_read_b128 v[68:71], v15 offset:34816
    v_mfma_f32_16x16x32_bf16 v[80:83], v[52:55], v[24:27], v[80:83]
    ds_read_b128 v[44:47], v13 offset:37376
    v_mfma_f32_16x16x32_bf16 v[96:99], v[56:59], v[24:27], v[96:99]
    ds_read_b128 v[72:75], v16 offset:34816
    v_mfma_f32_16x16x32_bf16 v[112:115], v[60:63], v[24:27], v[112:115]
    ds_read_b128 v[48:51], v13 offset:37632
    v_mfma_f32_16x16x32_bf16 v[84:87], v[52:55], v[28:31], v[84:87]
    v_mfma_f32_16x16x32_bf16 v[100:103], v[56:59], v[28:31], v[100:103]
    v_mfma_f32_16x16x32_bf16 v[116:119], v[60:63], v[28:31], v[116:119]
    v_mfma_f32_16x16x32_bf16 v[88:91], v[52:55], v[32:35], v[88:91]
    v_mfma_f32_16x16x32_bf16 v[104:107], v[56:59], v[32:35], v[104:107]
    v_mfma_f32_16x16x32_bf16 v[120:123], v[60:63], v[32:35], v[120:123]
    v_mfma_f32_16x16x32_bf16 v[124:127], v[52:55], v[132:135], v[124:127]
    v_mfma_f32_16x16x32_bf16 v[128:131], v[56:59], v[132:135], v[128:131]
    s_waitcnt lgkmcnt(0)
    s_barrier
    v_add_u32 v13, 32768, v9
    v_add_u32 v14, 32768, v10
    v_add_u32 v15, 32768, v11
    v_add_u32 v16, 32768, v12
    ds_read_b128 v[20:23], v13 offset:24576
    v_mfma_f32_16x16x32_bf16 v[76:79], v[64:67], v[36:39], v[76:79]
    ds_read_b128 v[52:55], v14 offset:24576
    v_mfma_f32_16x16x32_bf16 v[92:95], v[68:71], v[36:39], v[92:95]
    ds_read_b128 v[24:27], v13 offset:24832
    v_mfma_f32_16x16x32_bf16 v[108:111], v[72:75], v[36:39], v[108:111]
    ds_read_b128 v[56:59], v15 offset:24576
    v_mfma_f32_16x16x32_bf16 v[80:83], v[64:67], v[40:43], v[80:83]
    ds_read_b128 v[28:31], v13 offset:25088
    v_mfma_f32_16x16x32_bf16 v[96:99], v[68:71], v[40:43], v[96:99]
    ds_read_b128 v[60:63], v16 offset:24576
    v_mfma_f32_16x16x32_bf16 v[112:115], v[72:75], v[40:43], v[112:115]
    ds_read_b128 v[32:35], v13 offset:25344
    v_mfma_f32_16x16x32_bf16 v[84:87], v[64:67], v[44:47], v[84:87]
    v_mfma_f32_16x16x32_bf16 v[100:103], v[68:71], v[44:47], v[100:103]
    v_mfma_f32_16x16x32_bf16 v[116:119], v[72:75], v[44:47], v[116:119]
    v_mfma_f32_16x16x32_bf16 v[88:91], v[64:67], v[48:51], v[88:91]
    v_mfma_f32_16x16x32_bf16 v[104:107], v[68:71], v[48:51], v[104:107]
    v_mfma_f32_16x16x32_bf16 v[120:123], v[72:75], v[48:51], v[120:123]
    v_mfma_f32_16x16x32_bf16 v[124:127], v[64:67], v[132:135], v[124:127]
    v_mfma_f32_16x16x32_bf16 v[128:131], v[68:71], v[132:135], v[128:131]
    s_waitcnt lgkmcnt(0)
    ds_read_b128 v[36:39], v13 offset:32768
    v_mfma_f32_16x16x32_bf16 v[76:79], v[52:55], v[20:23], v[76:79]
    ds_read_b128 v[64:67], v14 offset:30720
    v_mfma_f32_16x16x32_bf16 v[92:95], v[56:59], v[20:23], v[92:95]
    ds_read_b128 v[40:43], v13 offset:33024
    v_mfma_f32_16x16x32_bf16 v[108:111], v[60:63], v[20:23], v[108:111]
    ds_read_b128 v[68:71], v15 offset:30720
    v_mfma_f32_16x16x32_bf16 v[80:83], v[52:55], v[24:27], v[80:83]
    ds_read_b128 v[44:47], v13 offset:33280
    v_mfma_f32_16x16x32_bf16 v[96:99], v[56:59], v[24:27], v[96:99]
    ds_read_b128 v[72:75], v16 offset:30720
    v_mfma_f32_16x16x32_bf16 v[112:115], v[60:63], v[24:27], v[112:115]
    ds_read_b128 v[48:51], v13 offset:33536
    v_mfma_f32_16x16x32_bf16 v[84:87], v[52:55], v[28:31], v[84:87]
    v_mfma_f32_16x16x32_bf16 v[100:103], v[56:59], v[28:31], v[100:103]
    v_mfma_f32_16x16x32_bf16 v[116:119], v[60:63], v[28:31], v[116:119]
    v_mfma_f32_16x16x32_bf16 v[88:91], v[52:55], v[32:35], v[88:91]
    v_mfma_f32_16x16x32_bf16 v[104:107], v[56:59], v[32:35], v[104:107]
    v_mfma_f32_16x16x32_bf16 v[120:123], v[60:63], v[32:35], v[120:123]
    v_mfma_f32_16x16x32_bf16 v[124:127], v[52:55], v[132:135], v[124:127]
    v_mfma_f32_16x16x32_bf16 v[128:131], v[56:59], v[132:135], v[128:131]
    s_waitcnt lgkmcnt(0)
    s_barrier
    v_add_u32 v13, 65536, v9
    v_add_u32 v14, 65536, v10
    v_add_u32 v15, 65536, v11
    v_add_u32 v16, 65536, v12
    ds_read_b128 v[20:23], v13 offset:20480
    v_mfma_f32_16x16x32_bf16 v[76:79], v[64:67], v[36:39], v[76:79]
    ds_read_b128 v[52:55], v14 offset:20480
    v_mfma_f32_16x16x32_bf16 v[92:95], v[68:71], v[36:39], v[92:95]
    ds_read_b128 v[24:27], v13 offset:20736
    v_mfma_f32_16x16x32_bf16 v[108:111], v[72:75], v[36:39], v[108:111]
    ds_read_b128 v[56:59], v15 offset:20480
    v_mfma_f32_16x16x32_bf16 v[80:83], v[64:67], v[40:43], v[80:83]
    ds_read_b128 v[28:31], v13 offset:20992
    v_mfma_f32_16x16x32_bf16 v[96:99], v[68:71], v[40:43], v[96:99]
    ds_read_b128 v[60:63], v16 offset:20480
    v_mfma_f32_16x16x32_bf16 v[112:115], v[72:75], v[40:43], v[112:115]
    ds_read_b128 v[32:35], v13 offset:21248
    v_mfma_f32_16x16x32_bf16 v[84:87], v[64:67], v[44:47], v[84:87]
    v_mfma_f32_16x16x32_bf16 v[100:103], v[68:71], v[44:47], v[100:103]
    v_mfma_f32_16x16x32_bf16 v[116:119], v[72:75], v[44:47], v[116:119]
    v_mfma_f32_16x16x32_bf16 v[88:91], v[64:67], v[48:51], v[88:91]
    v_mfma_f32_16x16x32_bf16 v[104:107], v[68:71], v[48:51], v[104:107]
    v_mfma_f32_16x16x32_bf16 v[120:123], v[72:75], v[48:51], v[120:123]
    v_mfma_f32_16x16x32_bf16 v[124:127], v[64:67], v[132:135], v[124:127]
    v_mfma_f32_16x16x32_bf16 v[128:131], v[68:71], v[132:135], v[128:131]
    s_waitcnt lgkmcnt(0)
    ds_read_b128 v[36:39], v13 offset:28672
    v_mfma_f32_16x16x32_bf16 v[76:79], v[52:55], v[20:23], v[76:79]
    ds_read_b128 v[64:67], v14 offset:26624
    v_mfma_f32_16x16x32_bf16 v[92:95], v[56:59], v[20:23], v[92:95]
    ds_read_b128 v[40:43], v13 offset:28928
    v_mfma_f32_16x16x32_bf16 v[108:111], v[60:63], v[20:23], v[108:111]
    ds_read_b128 v[68:71], v15 offset:26624
    v_mfma_f32_16x16x32_bf16 v[80:83], v[52:55], v[24:27], v[80:83]
    ds_read_b128 v[44:47], v13 offset:29184
    v_mfma_f32_16x16x32_bf16 v[96:99], v[56:59], v[24:27], v[96:99]
    ds_read_b128 v[72:75], v16 offset:26624
    v_mfma_f32_16x16x32_bf16 v[112:115], v[60:63], v[24:27], v[112:115]
    ds_read_b128 v[48:51], v13 offset:29440
    v_mfma_f32_16x16x32_bf16 v[84:87], v[52:55], v[28:31], v[84:87]
    v_mfma_f32_16x16x32_bf16 v[100:103], v[56:59], v[28:31], v[100:103]
    v_mfma_f32_16x16x32_bf16 v[116:119], v[60:63], v[28:31], v[116:119]
    v_mfma_f32_16x16x32_bf16 v[88:91], v[52:55], v[32:35], v[88:91]
    v_mfma_f32_16x16x32_bf16 v[104:107], v[56:59], v[32:35], v[104:107]
    v_mfma_f32_16x16x32_bf16 v[120:123], v[60:63], v[32:35], v[120:123]
    v_mfma_f32_16x16x32_bf16 v[124:127], v[52:55], v[132:135], v[124:127]
    v_mfma_f32_16x16x32_bf16 v[128:131], v[56:59], v[132:135], v[128:131]
    s_waitcnt lgkmcnt(0)
    s_barrier
    v_add_u32 v13, 0, v9
    v_add_u32 v14, 0, v10
    v_add_u32 v15, 0, v11
    v_add_u32 v16, 0, v12
    ds_read_b128 v[20:23], v13 offset:0
    v_mfma_f32_16x16x32_bf16 v[76:79], v[64:67], v[36:39], v[76:79]
    ds_read_b128 v[52:55], v14 offset:0
    v_mfma_f32_16x16x32_bf16 v[92:95], v[68:71], v[36:39], v[92:95]
    ds_read_b128 v[24:27], v13 offset:256
    v_mfma_f32_16x16x32_bf16 v[108:111], v[72:75], v[36:39], v[108:111]
    ds_read_b128 v[56:59], v15 offset:0
    v_mfma_f32_16x16x32_bf16 v[80:83], v[64:67], v[40:43], v[80:83]
    ds_read_b128 v[28:31], v13 offset:512
    v_mfma_f32_16x16x32_bf16 v[96:99], v[68:71], v[40:43], v[96:99]
    ds_read_b128 v[60:63], v16 offset:0
    v_mfma_f32_16x16x32_bf16 v[112:115], v[72:75], v[40:43], v[112:115]
    ds_read_b128 v[32:35], v13 offset:768
    v_mfma_f32_16x16x32_bf16 v[84:87], v[64:67], v[44:47], v[84:87]
    v_mfma_f32_16x16x32_bf16 v[100:103], v[68:71], v[44:47], v[100:103]
    v_mfma_f32_16x16x32_bf16 v[116:119], v[72:75], v[44:47], v[116:119]
    v_mfma_f32_16x16x32_bf16 v[88:91], v[64:67], v[48:51], v[88:91]
    v_mfma_f32_16x16x32_bf16 v[104:107], v[68:71], v[48:51], v[104:107]
    v_mfma_f32_16x16x32_bf16 v[120:123], v[72:75], v[48:51], v[120:123]
    v_mfma_f32_16x16x32_bf16 v[124:127], v[64:67], v[132:135], v[124:127]
    v_mfma_f32_16x16x32_bf16 v[128:131], v[68:71], v[132:135], v[128:131]
    s_waitcnt lgkmcnt(0)
    ds_read_b128 v[36:39], v13 offset:8192
    v_mfma_f32_16x16x32_bf16 v[76:79], v[52:55], v[20:23], v[76:79]
    ds_read_b128 v[64:67], v14 offset:6144
    v_mfma_f32_16x16x32_bf16 v[92:95], v[56:59], v[20:23], v[92:95]
    ds_read_b128 v[40:43], v13 offset:8448
    v_mfma_f32_16x16x32_bf16 v[108:111], v[60:63], v[20:23], v[108:111]
    ds_read_b128 v[68:71], v15 offset:6144
    v_mfma_f32_16x16x32_bf16 v[80:83], v[52:55], v[24:27], v[80:83]
    ds_read_b128 v[44:47], v13 offset:8704
    v_mfma_f32_16x16x32_bf16 v[96:99], v[56:59], v[24:27], v[96:99]
    ds_read_b128 v[72:75], v16 offset:6144
    v_mfma_f32_16x16x32_bf16 v[112:115], v[60:63], v[24:27], v[112:115]
    ds_read_b128 v[48:51], v13 offset:8960
    v_mfma_f32_16x16x32_bf16 v[84:87], v[52:55], v[28:31], v[84:87]
    v_mfma_f32_16x16x32_bf16 v[100:103], v[56:59], v[28:31], v[100:103]
    v_mfma_f32_16x16x32_bf16 v[116:119], v[60:63], v[28:31], v[116:119]
    v_mfma_f32_16x16x32_bf16 v[88:91], v[52:55], v[32:35], v[88:91]
    v_mfma_f32_16x16x32_bf16 v[104:107], v[56:59], v[32:35], v[104:107]
    v_mfma_f32_16x16x32_bf16 v[120:123], v[60:63], v[32:35], v[120:123]
    v_mfma_f32_16x16x32_bf16 v[124:127], v[52:55], v[132:135], v[124:127]
    v_mfma_f32_16x16x32_bf16 v[128:131], v[56:59], v[132:135], v[128:131]
    s_waitcnt lgkmcnt(0)
    s_barrier
    ds_read_b128 v[20:23], v13 offset:28672
    v_mfma_f32_16x16x32_bf16 v[76:79], v[64:67], v[36:39], v[76:79]
    ds_read_b128 v[52:55], v14 offset:28672
    v_mfma_f32_16x16x32_bf16 v[92:95], v[68:71], v[36:39], v[92:95]
    ds_read_b128 v[24:27], v13 offset:28928
    v_mfma_f32_16x16x32_bf16 v[108:111], v[72:75], v[36:39], v[108:111]
    ds_read_b128 v[56:59], v15 offset:28672
    v_mfma_f32_16x16x32_bf16 v[80:83], v[64:67], v[40:43], v[80:83]
    ds_read_b128 v[28:31], v13 offset:29184
    v_mfma_f32_16x16x32_bf16 v[96:99], v[68:71], v[40:43], v[96:99]
    ds_read_b128 v[60:63], v16 offset:28672
    v_mfma_f32_16x16x32_bf16 v[112:115], v[72:75], v[40:43], v[112:115]
    ds_read_b128 v[32:35], v13 offset:29440
    v_mfma_f32_16x16x32_bf16 v[84:87], v[64:67], v[44:47], v[84:87]
    v_mfma_f32_16x16x32_bf16 v[100:103], v[68:71], v[44:47], v[100:103]
    v_mfma_f32_16x16x32_bf16 v[116:119], v[72:75], v[44:47], v[116:119]
    v_mfma_f32_16x16x32_bf16 v[88:91], v[64:67], v[48:51], v[88:91]
    v_mfma_f32_16x16x32_bf16 v[104:107], v[68:71], v[48:51], v[104:107]
    v_mfma_f32_16x16x32_bf16 v[120:123], v[72:75], v[48:51], v[120:123]
    v_mfma_f32_16x16x32_bf16 v[124:127], v[64:67], v[132:135], v[124:127]
    v_mfma_f32_16x16x32_bf16 v[128:131], v[68:71], v[132:135], v[128:131]
    s_waitcnt lgkmcnt(0)
    ds_read_b128 v[36:39], v13 offset:36864
    v_mfma_f32_16x16x32_bf16 v[76:79], v[52:55], v[20:23], v[76:79]
    ds_read_b128 v[64:67], v14 offset:34816
    v_mfma_f32_16x16x32_bf16 v[92:95], v[56:59], v[20:23], v[92:95]
    ds_read_b128 v[40:43], v13 offset:37120
    v_mfma_f32_16x16x32_bf16 v[108:111], v[60:63], v[20:23], v[108:111]
    ds_read_b128 v[68:71], v15 offset:34816
    v_mfma_f32_16x16x32_bf16 v[80:83], v[52:55], v[24:27], v[80:83]
    ds_read_b128 v[44:47], v13 offset:37376
    v_mfma_f32_16x16x32_bf16 v[96:99], v[56:59], v[24:27], v[96:99]
    ds_read_b128 v[72:75], v16 offset:34816
    v_mfma_f32_16x16x32_bf16 v[112:115], v[60:63], v[24:27], v[112:115]
    ds_read_b128 v[48:51], v13 offset:37632
    v_mfma_f32_16x16x32_bf16 v[84:87], v[52:55], v[28:31], v[84:87]
    v_mfma_f32_16x16x32_bf16 v[100:103], v[56:59], v[28:31], v[100:103]
    v_mfma_f32_16x16x32_bf16 v[116:119], v[60:63], v[28:31], v[116:119]
    v_mfma_f32_16x16x32_bf16 v[88:91], v[52:55], v[32:35], v[88:91]
    v_mfma_f32_16x16x32_bf16 v[104:107], v[56:59], v[32:35], v[104:107]
    v_mfma_f32_16x16x32_bf16 v[120:123], v[60:63], v[32:35], v[120:123]
    v_mfma_f32_16x16x32_bf16 v[124:127], v[52:55], v[132:135], v[124:127]
    v_mfma_f32_16x16x32_bf16 v[128:131], v[56:59], v[132:135], v[128:131]
    s_waitcnt lgkmcnt(0)
    s_barrier
    v_add_u32 v13, 32768, v9
    v_add_u32 v14, 32768, v10
    v_add_u32 v15, 32768, v11
    v_add_u32 v16, 32768, v12
    ds_read_b128 v[20:23], v13 offset:24576
    v_mfma_f32_16x16x32_bf16 v[76:79], v[64:67], v[36:39], v[76:79]
    ds_read_b128 v[52:55], v14 offset:24576
    v_mfma_f32_16x16x32_bf16 v[92:95], v[68:71], v[36:39], v[92:95]
    ds_read_b128 v[24:27], v13 offset:24832
    v_mfma_f32_16x16x32_bf16 v[108:111], v[72:75], v[36:39], v[108:111]
    ds_read_b128 v[56:59], v15 offset:24576
    v_mfma_f32_16x16x32_bf16 v[80:83], v[64:67], v[40:43], v[80:83]
    ds_read_b128 v[28:31], v13 offset:25088
    v_mfma_f32_16x16x32_bf16 v[96:99], v[68:71], v[40:43], v[96:99]
    ds_read_b128 v[60:63], v16 offset:24576
    v_mfma_f32_16x16x32_bf16 v[112:115], v[72:75], v[40:43], v[112:115]
    ds_read_b128 v[32:35], v13 offset:25344
    v_mfma_f32_16x16x32_bf16 v[84:87], v[64:67], v[44:47], v[84:87]
    v_mfma_f32_16x16x32_bf16 v[100:103], v[68:71], v[44:47], v[100:103]
    v_mfma_f32_16x16x32_bf16 v[116:119], v[72:75], v[44:47], v[116:119]
    v_mfma_f32_16x16x32_bf16 v[88:91], v[64:67], v[48:51], v[88:91]
    v_mfma_f32_16x16x32_bf16 v[104:107], v[68:71], v[48:51], v[104:107]
    v_mfma_f32_16x16x32_bf16 v[120:123], v[72:75], v[48:51], v[120:123]
    v_mfma_f32_16x16x32_bf16 v[124:127], v[64:67], v[132:135], v[124:127]
    v_mfma_f32_16x16x32_bf16 v[128:131], v[68:71], v[132:135], v[128:131]
    s_waitcnt lgkmcnt(0)
    ds_read_b128 v[36:39], v13 offset:32768
    v_mfma_f32_16x16x32_bf16 v[76:79], v[52:55], v[20:23], v[76:79]
    ds_read_b128 v[64:67], v14 offset:30720
    v_mfma_f32_16x16x32_bf16 v[92:95], v[56:59], v[20:23], v[92:95]
    ds_read_b128 v[40:43], v13 offset:33024
    v_mfma_f32_16x16x32_bf16 v[108:111], v[60:63], v[20:23], v[108:111]
    ds_read_b128 v[68:71], v15 offset:30720
    v_mfma_f32_16x16x32_bf16 v[80:83], v[52:55], v[24:27], v[80:83]
    ds_read_b128 v[44:47], v13 offset:33280
    v_mfma_f32_16x16x32_bf16 v[96:99], v[56:59], v[24:27], v[96:99]
    ds_read_b128 v[72:75], v16 offset:30720
    v_mfma_f32_16x16x32_bf16 v[112:115], v[60:63], v[24:27], v[112:115]
    ds_read_b128 v[48:51], v13 offset:33536
    v_mfma_f32_16x16x32_bf16 v[84:87], v[52:55], v[28:31], v[84:87]
    v_mfma_f32_16x16x32_bf16 v[100:103], v[56:59], v[28:31], v[100:103]
    v_mfma_f32_16x16x32_bf16 v[116:119], v[60:63], v[28:31], v[116:119]
    v_mfma_f32_16x16x32_bf16 v[88:91], v[52:55], v[32:35], v[88:91]
    v_mfma_f32_16x16x32_bf16 v[104:107], v[56:59], v[32:35], v[104:107]
    v_mfma_f32_16x16x32_bf16 v[120:123], v[60:63], v[32:35], v[120:123]
    v_mfma_f32_16x16x32_bf16 v[124:127], v[52:55], v[132:135], v[124:127]
    v_mfma_f32_16x16x32_bf16 v[128:131], v[56:59], v[132:135], v[128:131]
    s_waitcnt lgkmcnt(0)
    s_barrier
    v_add_u32 v13, 65536, v9
    v_add_u32 v14, 65536, v10
    v_add_u32 v15, 65536, v11
    v_add_u32 v16, 65536, v12
    ds_read_b128 v[20:23], v13 offset:20480
    v_mfma_f32_16x16x32_bf16 v[76:79], v[64:67], v[36:39], v[76:79]
    ds_read_b128 v[52:55], v14 offset:20480
    v_mfma_f32_16x16x32_bf16 v[92:95], v[68:71], v[36:39], v[92:95]
    ds_read_b128 v[24:27], v13 offset:20736
    v_mfma_f32_16x16x32_bf16 v[108:111], v[72:75], v[36:39], v[108:111]
    ds_read_b128 v[56:59], v15 offset:20480
    v_mfma_f32_16x16x32_bf16 v[80:83], v[64:67], v[40:43], v[80:83]
    ds_read_b128 v[28:31], v13 offset:20992
    v_mfma_f32_16x16x32_bf16 v[96:99], v[68:71], v[40:43], v[96:99]
    ds_read_b128 v[60:63], v16 offset:20480
    v_mfma_f32_16x16x32_bf16 v[112:115], v[72:75], v[40:43], v[112:115]
    ds_read_b128 v[32:35], v13 offset:21248
    v_mfma_f32_16x16x32_bf16 v[84:87], v[64:67], v[44:47], v[84:87]
    v_mfma_f32_16x16x32_bf16 v[100:103], v[68:71], v[44:47], v[100:103]
    v_mfma_f32_16x16x32_bf16 v[116:119], v[72:75], v[44:47], v[116:119]
    v_mfma_f32_16x16x32_bf16 v[88:91], v[64:67], v[48:51], v[88:91]
    v_mfma_f32_16x16x32_bf16 v[104:107], v[68:71], v[48:51], v[104:107]
    v_mfma_f32_16x16x32_bf16 v[120:123], v[72:75], v[48:51], v[120:123]
    v_mfma_f32_16x16x32_bf16 v[124:127], v[64:67], v[132:135], v[124:127]
    v_mfma_f32_16x16x32_bf16 v[128:131], v[68:71], v[132:135], v[128:131]
    s_waitcnt lgkmcnt(0)
    ds_read_b128 v[36:39], v13 offset:28672
    v_mfma_f32_16x16x32_bf16 v[76:79], v[52:55], v[20:23], v[76:79]
    ds_read_b128 v[64:67], v14 offset:26624
    v_mfma_f32_16x16x32_bf16 v[92:95], v[56:59], v[20:23], v[92:95]
    ds_read_b128 v[40:43], v13 offset:28928
    v_mfma_f32_16x16x32_bf16 v[108:111], v[60:63], v[20:23], v[108:111]
    ds_read_b128 v[68:71], v15 offset:26624
    v_mfma_f32_16x16x32_bf16 v[80:83], v[52:55], v[24:27], v[80:83]
    ds_read_b128 v[44:47], v13 offset:29184
    v_mfma_f32_16x16x32_bf16 v[96:99], v[56:59], v[24:27], v[96:99]
    ds_read_b128 v[72:75], v16 offset:26624
    v_mfma_f32_16x16x32_bf16 v[112:115], v[60:63], v[24:27], v[112:115]
    ds_read_b128 v[48:51], v13 offset:29440
    v_mfma_f32_16x16x32_bf16 v[84:87], v[52:55], v[28:31], v[84:87]
    v_mfma_f32_16x16x32_bf16 v[100:103], v[56:59], v[28:31], v[100:103]
    v_mfma_f32_16x16x32_bf16 v[116:119], v[60:63], v[28:31], v[116:119]
    v_mfma_f32_16x16x32_bf16 v[88:91], v[52:55], v[32:35], v[88:91]
    v_mfma_f32_16x16x32_bf16 v[104:107], v[56:59], v[32:35], v[104:107]
    v_mfma_f32_16x16x32_bf16 v[120:123], v[60:63], v[32:35], v[120:123]
    v_mfma_f32_16x16x32_bf16 v[124:127], v[52:55], v[132:135], v[124:127]
    v_mfma_f32_16x16x32_bf16 v[128:131], v[56:59], v[132:135], v[128:131]
    s_waitcnt lgkmcnt(0)
    s_barrier
    v_add_u32 v13, 0, v9
    v_add_u32 v14, 0, v10
    v_add_u32 v15, 0, v11
    v_add_u32 v16, 0, v12
    ds_read_b128 v[20:23], v13 offset:0
    v_mfma_f32_16x16x32_bf16 v[76:79], v[64:67], v[36:39], v[76:79]
    ds_read_b128 v[52:55], v14 offset:0
    v_mfma_f32_16x16x32_bf16 v[92:95], v[68:71], v[36:39], v[92:95]
    ds_read_b128 v[24:27], v13 offset:256
    v_mfma_f32_16x16x32_bf16 v[108:111], v[72:75], v[36:39], v[108:111]
    ds_read_b128 v[56:59], v15 offset:0
    v_mfma_f32_16x16x32_bf16 v[80:83], v[64:67], v[40:43], v[80:83]
    ds_read_b128 v[28:31], v13 offset:512
    v_mfma_f32_16x16x32_bf16 v[96:99], v[68:71], v[40:43], v[96:99]
    ds_read_b128 v[60:63], v16 offset:0
    v_mfma_f32_16x16x32_bf16 v[112:115], v[72:75], v[40:43], v[112:115]
    ds_read_b128 v[32:35], v13 offset:768
    v_mfma_f32_16x16x32_bf16 v[84:87], v[64:67], v[44:47], v[84:87]
    v_mfma_f32_16x16x32_bf16 v[100:103], v[68:71], v[44:47], v[100:103]
    v_mfma_f32_16x16x32_bf16 v[116:119], v[72:75], v[44:47], v[116:119]
    v_mfma_f32_16x16x32_bf16 v[88:91], v[64:67], v[48:51], v[88:91]
    v_mfma_f32_16x16x32_bf16 v[104:107], v[68:71], v[48:51], v[104:107]
    v_mfma_f32_16x16x32_bf16 v[120:123], v[72:75], v[48:51], v[120:123]
    v_mfma_f32_16x16x32_bf16 v[124:127], v[64:67], v[132:135], v[124:127]
    v_mfma_f32_16x16x32_bf16 v[128:131], v[68:71], v[132:135], v[128:131]
    s_waitcnt lgkmcnt(0)
    ds_read_b128 v[36:39], v13 offset:8192
    v_mfma_f32_16x16x32_bf16 v[76:79], v[52:55], v[20:23], v[76:79]
    ds_read_b128 v[64:67], v14 offset:6144
    v_mfma_f32_16x16x32_bf16 v[92:95], v[56:59], v[20:23], v[92:95]
    ds_read_b128 v[40:43], v13 offset:8448
    v_mfma_f32_16x16x32_bf16 v[108:111], v[60:63], v[20:23], v[108:111]
    ds_read_b128 v[68:71], v15 offset:6144
    v_mfma_f32_16x16x32_bf16 v[80:83], v[52:55], v[24:27], v[80:83]
    ds_read_b128 v[44:47], v13 offset:8704
    v_mfma_f32_16x16x32_bf16 v[96:99], v[56:59], v[24:27], v[96:99]
    ds_read_b128 v[72:75], v16 offset:6144
    v_mfma_f32_16x16x32_bf16 v[112:115], v[60:63], v[24:27], v[112:115]
    ds_read_b128 v[48:51], v13 offset:8960
    v_mfma_f32_16x16x32_bf16 v[84:87], v[52:55], v[28:31], v[84:87]
    v_mfma_f32_16x16x32_bf16 v[100:103], v[56:59], v[28:31], v[100:103]
    v_mfma_f32_16x16x32_bf16 v[116:119], v[60:63], v[28:31], v[116:119]
    v_mfma_f32_16x16x32_bf16 v[88:91], v[52:55], v[32:35], v[88:91]
    v_mfma_f32_16x16x32_bf16 v[104:107], v[56:59], v[32:35], v[104:107]
    v_mfma_f32_16x16x32_bf16 v[120:123], v[60:63], v[32:35], v[120:123]
    v_mfma_f32_16x16x32_bf16 v[124:127], v[52:55], v[132:135], v[124:127]
    v_mfma_f32_16x16x32_bf16 v[128:131], v[56:59], v[132:135], v[128:131]
    s_waitcnt lgkmcnt(0)
    s_barrier
    ds_read_b128 v[20:23], v13 offset:28672
    v_mfma_f32_16x16x32_bf16 v[76:79], v[64:67], v[36:39], v[76:79]
    ds_read_b128 v[52:55], v14 offset:28672
    v_mfma_f32_16x16x32_bf16 v[92:95], v[68:71], v[36:39], v[92:95]
    ds_read_b128 v[24:27], v13 offset:28928
    v_mfma_f32_16x16x32_bf16 v[108:111], v[72:75], v[36:39], v[108:111]
    ds_read_b128 v[56:59], v15 offset:28672
    v_mfma_f32_16x16x32_bf16 v[80:83], v[64:67], v[40:43], v[80:83]
    ds_read_b128 v[28:31], v13 offset:29184
    v_mfma_f32_16x16x32_bf16 v[96:99], v[68:71], v[40:43], v[96:99]
    ds_read_b128 v[60:63], v16 offset:28672
    v_mfma_f32_16x16x32_bf16 v[112:115], v[72:75], v[40:43], v[112:115]
    ds_read_b128 v[32:35], v13 offset:29440
    v_mfma_f32_16x16x32_bf16 v[84:87], v[64:67], v[44:47], v[84:87]
    v_mfma_f32_16x16x32_bf16 v[100:103], v[68:71], v[44:47], v[100:103]
    v_mfma_f32_16x16x32_bf16 v[116:119], v[72:75], v[44:47], v[116:119]
    v_mfma_f32_16x16x32_bf16 v[88:91], v[64:67], v[48:51], v[88:91]
    v_mfma_f32_16x16x32_bf16 v[104:107], v[68:71], v[48:51], v[104:107]
    v_mfma_f32_16x16x32_bf16 v[120:123], v[72:75], v[48:51], v[120:123]
    v_mfma_f32_16x16x32_bf16 v[124:127], v[64:67], v[132:135], v[124:127]
    v_mfma_f32_16x16x32_bf16 v[128:131], v[68:71], v[132:135], v[128:131]
    s_waitcnt lgkmcnt(0)
    ds_read_b128 v[36:39], v13 offset:36864
    v_mfma_f32_16x16x32_bf16 v[76:79], v[52:55], v[20:23], v[76:79]
    ds_read_b128 v[64:67], v14 offset:34816
    v_mfma_f32_16x16x32_bf16 v[92:95], v[56:59], v[20:23], v[92:95]
    ds_read_b128 v[40:43], v13 offset:37120
    v_mfma_f32_16x16x32_bf16 v[108:111], v[60:63], v[20:23], v[108:111]
    ds_read_b128 v[68:71], v15 offset:34816
    v_mfma_f32_16x16x32_bf16 v[80:83], v[52:55], v[24:27], v[80:83]
    ds_read_b128 v[44:47], v13 offset:37376
    v_mfma_f32_16x16x32_bf16 v[96:99], v[56:59], v[24:27], v[96:99]
    ds_read_b128 v[72:75], v16 offset:34816
    v_mfma_f32_16x16x32_bf16 v[112:115], v[60:63], v[24:27], v[112:115]
    ds_read_b128 v[48:51], v13 offset:37632
    v_mfma_f32_16x16x32_bf16 v[84:87], v[52:55], v[28:31], v[84:87]
    v_mfma_f32_16x16x32_bf16 v[100:103], v[56:59], v[28:31], v[100:103]
    v_mfma_f32_16x16x32_bf16 v[116:119], v[60:63], v[28:31], v[116:119]
    v_mfma_f32_16x16x32_bf16 v[88:91], v[52:55], v[32:35], v[88:91]
    v_mfma_f32_16x16x32_bf16 v[104:107], v[56:59], v[32:35], v[104:107]
    v_mfma_f32_16x16x32_bf16 v[120:123], v[60:63], v[32:35], v[120:123]
    v_mfma_f32_16x16x32_bf16 v[124:127], v[52:55], v[132:135], v[124:127]
    v_mfma_f32_16x16x32_bf16 v[128:131], v[56:59], v[132:135], v[128:131]
    s_waitcnt lgkmcnt(0)
    v_mfma_f32_16x16x32_bf16 v[76:79], v[64:67], v[36:39], v[76:79]
    v_mfma_f32_16x16x32_bf16 v[92:95], v[68:71], v[36:39], v[92:95]
    v_mfma_f32_16x16x32_bf16 v[108:111], v[72:75], v[36:39], v[108:111]
    v_mfma_f32_16x16x32_bf16 v[80:83], v[64:67], v[40:43], v[80:83]
    v_mfma_f32_16x16x32_bf16 v[96:99], v[68:71], v[40:43], v[96:99]
    v_mfma_f32_16x16x32_bf16 v[112:115], v[72:75], v[40:43], v[112:115]
    v_mfma_f32_16x16x32_bf16 v[84:87], v[64:67], v[44:47], v[84:87]
    v_mfma_f32_16x16x32_bf16 v[100:103], v[68:71], v[44:47], v[100:103]
    v_mfma_f32_16x16x32_bf16 v[116:119], v[72:75], v[44:47], v[116:119]
    v_mfma_f32_16x16x32_bf16 v[88:91], v[64:67], v[48:51], v[88:91]
    v_mfma_f32_16x16x32_bf16 v[104:107], v[68:71], v[48:51], v[104:107]
    v_mfma_f32_16x16x32_bf16 v[120:123], v[72:75], v[48:51], v[120:123]
    v_mfma_f32_16x16x32_bf16 v[124:127], v[64:67], v[132:135], v[124:127]
    v_mfma_f32_16x16x32_bf16 v[128:131], v[68:71], v[132:135], v[128:131]
    s_waitcnt vmcnt(0)
    s_nop 7
    s_lshl_b32 s3, s60, 6
    v_lshlrev_b32 v6, 4, v4
    v_add_u32 v6, s3, v6
    v_add_u32 v6, 114688, v6
    ds_write_b128 v6, v[124:127]
    s_lshl_b32 s3, s61, 6
    v_lshlrev_b32 v6, 4, v4
    v_add_u32 v6, s3, v6
    v_add_u32 v6, 114688, v6
    ds_write_b128 v6, v[128:131]
    s_waitcnt lgkmcnt(0)
k4_w1_kernel_after3:
    s_barrier
    s_cmp_ge_u32 s26, 4
    s_cbranch_scc1 k4_w1_kernel_p4skip4
    s_lshl_b32 s3, s60, 6
    v_lshlrev_b32 v6, 4, v4
    v_add_u32 v6, s3, v6
    v_add_u32 v6, 114688, v6
    ds_read_b128 v[172:175], v6
    s_lshl_b32 s3, s61, 6
    v_lshlrev_b32 v6, 4, v4
    v_add_u32 v6, s3, v6
    v_add_u32 v6, 114688, v6
    ds_read_b128 v[176:179], v6
    s_lshl_b32 s3, s62, 6
    v_lshlrev_b32 v6, 4, v4
    v_add_u32 v6, s3, v6
    v_add_u32 v6, 114688, v6
    ds_read_b128 v[180:183], v6
    v_add_f32 v138, v138, v140
    v_add_f32 v139, v139, v141
    v_mov_b32 v160, v138
    v_mov_b32 v161, v139
    s_nop 1
    v_permlane16_swap_b32 v138, v160
    v_permlane16_swap_b32 v139, v161
    s_nop 1
    v_add_f32 v138, v138, v160
    v_add_f32 v139, v139, v161
    v_mov_b32 v160, v138
    v_mov_b32 v161, v139
    s_nop 1
    v_permlane32_swap_b32 v138, v160
    v_permlane32_swap_b32 v139, v161
    s_nop 1
    v_add_f32 v138, v138, v160
    v_add_f32 v139, v139, v161
    v_mul_f32 v164, 0x3acccccd, v138
    v_mul_f32 v160, 0x3acccccd, v139
    v_fma_f32 v160, -v164, v164, v160
    v_max_f32 v160, 0, v160
    v_add_f32 v161, 0x3727c5ac, v160
    v_rsq_f32 v161, v161
    s_nop 0
    v_mul_f32 v162, v161, v161
    v_mul_f32 v162, v162, v160
    v_add_f32 v162, 0x3727c5ac, v162
    v_rsq_f32 v162, v162
    s_nop 0
    v_mul_f32 v168, v161, v162
    v_add_f32 v142, v142, v144
    v_add_f32 v143, v143, v145
    v_mov_b32 v160, v142
    v_mov_b32 v161, v143
    s_nop 1
    v_permlane16_swap_b32 v142, v160
    v_permlane16_swap_b32 v143, v161
    s_nop 1
    v_add_f32 v142, v142, v160
    v_add_f32 v143, v143, v161
    v_mov_b32 v160, v142
    v_mov_b32 v161, v143
    s_nop 1
    v_permlane32_swap_b32 v142, v160
    v_permlane32_swap_b32 v143, v161
    s_nop 1
    v_add_f32 v142, v142, v160
    v_add_f32 v143, v143, v161
    v_mul_f32 v165, 0x3acccccd, v142
    v_mul_f32 v160, 0x3acccccd, v143
    v_fma_f32 v160, -v165, v165, v160
    v_max_f32 v160, 0, v160
    v_add_f32 v161, 0x3727c5ac, v160
    v_rsq_f32 v161, v161
    s_nop 0
    v_mul_f32 v162, v161, v161
    v_mul_f32 v162, v162, v160
    v_add_f32 v162, 0x3727c5ac, v162
    v_rsq_f32 v162, v162
    s_nop 0
    v_mul_f32 v169, v161, v162
    v_add_f32 v146, v146, v148
    v_add_f32 v147, v147, v149
    v_mov_b32 v160, v146
    v_mov_b32 v161, v147
    s_nop 1
    v_permlane16_swap_b32 v146, v160
    v_permlane16_swap_b32 v147, v161
    s_nop 1
    v_add_f32 v146, v146, v160
    v_add_f32 v147, v147, v161
    v_mov_b32 v160, v146
    v_mov_b32 v161, v147
    s_nop 1
    v_permlane32_swap_b32 v146, v160
    v_permlane32_swap_b32 v147, v161
    s_nop 1
    v_add_f32 v146, v146, v160
    v_add_f32 v147, v147, v161
    v_mul_f32 v166, 0x3acccccd, v146
    v_mul_f32 v160, 0x3acccccd, v147
    v_fma_f32 v160, -v166, v166, v160
    v_max_f32 v160, 0, v160
    v_add_f32 v161, 0x3727c5ac, v160
    v_rsq_f32 v161, v161
    s_nop 0
    v_mul_f32 v162, v161, v161
    v_mul_f32 v162, v162, v160
    v_add_f32 v162, 0x3727c5ac, v162
    v_rsq_f32 v162, v162
    s_nop 0
    v_mul_f32 v170, v161, v162
    v_add_f32 v150, v150, v152
    v_add_f32 v151, v151, v153
    v_mov_b32 v160, v150
    v_mov_b32 v161, v151
    s_nop 1
    v_permlane16_swap_b32 v150, v160
    v_permlane16_swap_b32 v151, v161
    s_nop 1
    v_add_f32 v150, v150, v160
    v_add_f32 v151, v151, v161
    v_mov_b32 v160, v150
    v_mov_b32 v161, v151
    s_nop 1
    v_permlane32_swap_b32 v150, v160
    v_permlane32_swap_b32 v151, v161
    s_nop 1
    v_add_f32 v150, v150, v160
    v_add_f32 v151, v151, v161
    v_mul_f32 v167, 0x3acccccd, v150
    v_mul_f32 v160, 0x3acccccd, v151
    v_fma_f32 v160, -v167, v167, v160
    v_max_f32 v160, 0, v160
    v_add_f32 v161, 0x3727c5ac, v160
    v_rsq_f32 v161, v161
    s_nop 0
    v_mul_f32 v162, v161, v161
    v_mul_f32 v162, v162, v160
    v_add_f32 v162, 0x3727c5ac, v162
    v_rsq_f32 v162, v162
    s_nop 0
    v_mul_f32 v171, v161, v162
    s_mul_i32 s28, s31, 12
    s_lshl_b32 s3, s60, 1
    s_lshl_b32 s27, s61, 1
    v_mov_b32 v5, s3
    v_mov_b32 v6, s27
    v_and_b32 v7, 1, v4
    v_cmp_eq_u32 vcc, 1, v7
    v_lshrrev_b32 v160, 1, v4
    s_nop 0
    v_cndmask_b32 v5, v5, v6, vcc
    v_add3_u32 v5, v5, v160, s28
    v_lshlrev_b32 v184, 15, v5
    v_lshl_add_u32 v184, v136, 4, v184
    s_lshl_b32 s3, s62, 1
    s_add_u32 s3, s3, s28
    v_add_u32 v5, s3, v160
    v_lshlrev_b32 v185, 15, v5
    v_lshl_add_u32 v185, v136, 4, v185
    v_lshl_add_u32 v185, v7, 3, v185
    s_waitcnt lgkmcnt(0)
    s_mov_b32 s63, 0xbdd2d3e8
    v_mov_b32 v186, 0xc0135761
    v_lshlrev_b32 v188, 16, v154
    v_and_b32 v189, 0xffff0000, v154
    v_lshlrev_b32 v190, 16, v155
    v_and_b32 v191, 0xffff0000, v155
    v_lshlrev_b32 v192, 16, v156
    v_and_b32 v193, 0xffff0000, v156
    v_lshlrev_b32 v194, 16, v157
    v_and_b32 v195, 0xffff0000, v157
    v_lshlrev_b32 v196, 16, v158
    v_and_b32 v197, 0xffff0000, v158
    v_lshlrev_b32 v198, 16, v159
    v_and_b32 v199, 0xffff0000, v159
    v_fma_f32 v76, -v164, v172, v76
    v_fma_f32 v77, -v164, v173, v77
    v_fma_f32 v78, -v164, v174, v78
    v_fma_f32 v79, -v164, v175, v79
    v_fma_f32 v76, v168, v76, v188
    v_fma_f32 v77, v168, v77, v189
    v_fma_f32 v78, v168, v78, v190
    v_fma_f32 v79, v168, v79, v191
    v_mul_f32 v200, v76, v76
    v_mul_f32 v201, v77, v77
    v_mul_f32 v202, v78, v78
    v_mul_f32 v203, v79, v79
    v_fma_f32 v200, v200, s63, v186
    v_fma_f32 v201, v201, s63, v186
    v_fma_f32 v202, v202, s63, v186
    v_fma_f32 v203, v203, s63, v186
    v_mul_f32 v200, v200, v76
    v_mul_f32 v201, v201, v77
    v_mul_f32 v202, v202, v78
    v_mul_f32 v203, v203, v79
    v_exp_f32 v200, v200
    v_exp_f32 v201, v201
    v_exp_f32 v202, v202
    v_exp_f32 v203, v203
    s_nop 0
    v_add_f32 v200, 1.0, v200
    v_add_f32 v201, 1.0, v201
    v_add_f32 v202, 1.0, v202
    v_add_f32 v203, 1.0, v203
    v_rcp_f32 v200, v200
    v_rcp_f32 v201, v201
    v_rcp_f32 v202, v202
    v_rcp_f32 v203, v203
    s_nop 0
    v_mul_f32 v76, v76, v200
    v_mul_f32 v77, v77, v201
    v_mul_f32 v78, v78, v202
    v_mul_f32 v79, v79, v203
    v_fma_f32 v92, -v164, v176, v92
    v_fma_f32 v93, -v164, v177, v93
    v_fma_f32 v94, -v164, v178, v94
    v_fma_f32 v95, -v164, v179, v95
    v_fma_f32 v92, v168, v92, v192
    v_fma_f32 v93, v168, v93, v193
    v_fma_f32 v94, v168, v94, v194
    v_fma_f32 v95, v168, v95, v195
    v_mul_f32 v200, v92, v92
    v_mul_f32 v201, v93, v93
    v_mul_f32 v202, v94, v94
    v_mul_f32 v203, v95, v95
    v_fma_f32 v200, v200, s63, v186
    v_fma_f32 v201, v201, s63, v186
    v_fma_f32 v202, v202, s63, v186
    v_fma_f32 v203, v203, s63, v186
    v_mul_f32 v200, v200, v92
    v_mul_f32 v201, v201, v93
    v_mul_f32 v202, v202, v94
    v_mul_f32 v203, v203, v95
    v_exp_f32 v200, v200
    v_exp_f32 v201, v201
    v_exp_f32 v202, v202
    v_exp_f32 v203, v203
    s_nop 0
    v_add_f32 v200, 1.0, v200
    v_add_f32 v201, 1.0, v201
    v_add_f32 v202, 1.0, v202
    v_add_f32 v203, 1.0, v203
    v_rcp_f32 v200, v200
    v_rcp_f32 v201, v201
    v_rcp_f32 v202, v202
    v_rcp_f32 v203, v203
    s_nop 0
    v_mul_f32 v92, v92, v200
    v_mul_f32 v93, v93, v201
    v_mul_f32 v94, v94, v202
    v_mul_f32 v95, v95, v203
    v_cvt_pk_bf16_f32 v204, v76, v77
    v_cvt_pk_bf16_f32 v205, v78, v79
    v_cvt_pk_bf16_f32 v206, v92, v93
    v_cvt_pk_bf16_f32 v207, v94, v95
    s_nop 1
    v_permlane16_swap_b32 v204, v206
    v_permlane16_swap_b32 v205, v207
    s_nop 1
    buffer_store_dwordx4 v[204:207], v184, s[44:47], 0 offen offset:0 sc1
    v_fma_f32 v108, -v164, v180, v108
    v_fma_f32 v109, -v164, v181, v109
    v_fma_f32 v110, -v164, v182, v110
    v_fma_f32 v111, -v164, v183, v111
    v_fma_f32 v108, v168, v108, v196
    v_fma_f32 v109, v168, v109, v197
    v_fma_f32 v110, v168, v110, v198
    v_fma_f32 v111, v168, v111, v199
    v_mul_f32 v200, v108, v108
    v_mul_f32 v201, v109, v109
    v_mul_f32 v202, v110, v110
    v_mul_f32 v203, v111, v111
    v_fma_f32 v200, v200, s63, v186
    v_fma_f32 v201, v201, s63, v186
    v_fma_f32 v202, v202, s63, v186
    v_fma_f32 v203, v203, s63, v186
    v_mul_f32 v200, v200, v108
    v_mul_f32 v201, v201, v109
    v_mul_f32 v202, v202, v110
    v_mul_f32 v203, v203, v111
    v_exp_f32 v200, v200
    v_exp_f32 v201, v201
    v_exp_f32 v202, v202
    v_exp_f32 v203, v203
    s_nop 0
    v_add_f32 v200, 1.0, v200
    v_add_f32 v201, 1.0, v201
    v_add_f32 v202, 1.0, v202
    v_add_f32 v203, 1.0, v203
    v_rcp_f32 v200, v200
    v_rcp_f32 v201, v201
    v_rcp_f32 v202, v202
    v_rcp_f32 v203, v203
    s_nop 0
    v_mul_f32 v108, v108, v200
    v_mul_f32 v109, v109, v201
    v_mul_f32 v110, v110, v202
    v_mul_f32 v111, v111, v203
    v_cvt_pk_bf16_f32 v212, v108, v109
    v_cvt_pk_bf16_f32 v213, v110, v111
    buffer_store_dwordx2 v[212:213], v185, s[44:47], 0 offen offset:0 sc1
    v_fma_f32 v80, -v165, v172, v80
    v_fma_f32 v81, -v165, v173, v81
    v_fma_f32 v82, -v165, v174, v82
    v_fma_f32 v83, -v165, v175, v83
    v_fma_f32 v80, v169, v80, v188
    v_fma_f32 v81, v169, v81, v189
    v_fma_f32 v82, v169, v82, v190
    v_fma_f32 v83, v169, v83, v191
    v_mul_f32 v200, v80, v80
    v_mul_f32 v201, v81, v81
    v_mul_f32 v202, v82, v82
    v_mul_f32 v203, v83, v83
    v_fma_f32 v200, v200, s63, v186
    v_fma_f32 v201, v201, s63, v186
    v_fma_f32 v202, v202, s63, v186
    v_fma_f32 v203, v203, s63, v186
    v_mul_f32 v200, v200, v80
    v_mul_f32 v201, v201, v81
    v_mul_f32 v202, v202, v82
    v_mul_f32 v203, v203, v83
    v_exp_f32 v200, v200
    v_exp_f32 v201, v201
    v_exp_f32 v202, v202
    v_exp_f32 v203, v203
    s_nop 0
    v_add_f32 v200, 1.0, v200
    v_add_f32 v201, 1.0, v201
    v_add_f32 v202, 1.0, v202
    v_add_f32 v203, 1.0, v203
    v_rcp_f32 v200, v200
    v_rcp_f32 v201, v201
    v_rcp_f32 v202, v202
    v_rcp_f32 v203, v203
    s_nop 0
    v_mul_f32 v80, v80, v200
    v_mul_f32 v81, v81, v201
    v_mul_f32 v82, v82, v202
    v_mul_f32 v83, v83, v203
    v_fma_f32 v96, -v165, v176, v96
    v_fma_f32 v97, -v165, v177, v97
    v_fma_f32 v98, -v165, v178, v98
    v_fma_f32 v99, -v165, v179, v99
    v_fma_f32 v96, v169, v96, v192
    v_fma_f32 v97, v169, v97, v193
    v_fma_f32 v98, v169, v98, v194
    v_fma_f32 v99, v169, v99, v195
    v_mul_f32 v200, v96, v96
    v_mul_f32 v201, v97, v97
    v_mul_f32 v202, v98, v98
    v_mul_f32 v203, v99, v99
    v_fma_f32 v200, v200, s63, v186
    v_fma_f32 v201, v201, s63, v186
    v_fma_f32 v202, v202, s63, v186
    v_fma_f32 v203, v203, s63, v186
    v_mul_f32 v200, v200, v96
    v_mul_f32 v201, v201, v97
    v_mul_f32 v202, v202, v98
    v_mul_f32 v203, v203, v99
    v_exp_f32 v200, v200
    v_exp_f32 v201, v201
    v_exp_f32 v202, v202
    v_exp_f32 v203, v203
    s_nop 0
    v_add_f32 v200, 1.0, v200
    v_add_f32 v201, 1.0, v201
    v_add_f32 v202, 1.0, v202
    v_add_f32 v203, 1.0, v203
    v_rcp_f32 v200, v200
    v_rcp_f32 v201, v201
    v_rcp_f32 v202, v202
    v_rcp_f32 v203, v203
    s_nop 0
    v_mul_f32 v96, v96, v200
    v_mul_f32 v97, v97, v201
    v_mul_f32 v98, v98, v202
    v_mul_f32 v99, v99, v203
    v_cvt_pk_bf16_f32 v208, v80, v81
    v_cvt_pk_bf16_f32 v209, v82, v83
    v_cvt_pk_bf16_f32 v210, v96, v97
    v_cvt_pk_bf16_f32 v211, v98, v99
    s_nop 1
    v_permlane16_swap_b32 v208, v210
    v_permlane16_swap_b32 v209, v211
    s_nop 1
    buffer_store_dwordx4 v[208:211], v184, s[44:47], 0 offen offset:256 sc1
    v_fma_f32 v112, -v165, v180, v112
    v_fma_f32 v113, -v165, v181, v113
    v_fma_f32 v114, -v165, v182, v114
    v_fma_f32 v115, -v165, v183, v115
    v_fma_f32 v112, v169, v112, v196
    v_fma_f32 v113, v169, v113, v197
    v_fma_f32 v114, v169, v114, v198
    v_fma_f32 v115, v169, v115, v199
    v_mul_f32 v200, v112, v112
    v_mul_f32 v201, v113, v113
    v_mul_f32 v202, v114, v114
    v_mul_f32 v203, v115, v115
    v_fma_f32 v200, v200, s63, v186
    v_fma_f32 v201, v201, s63, v186
    v_fma_f32 v202, v202, s63, v186
    v_fma_f32 v203, v203, s63, v186
    v_mul_f32 v200, v200, v112
    v_mul_f32 v201, v201, v113
    v_mul_f32 v202, v202, v114
    v_mul_f32 v203, v203, v115
    v_exp_f32 v200, v200
    v_exp_f32 v201, v201
    v_exp_f32 v202, v202
    v_exp_f32 v203, v203
    s_nop 0
    v_add_f32 v200, 1.0, v200
    v_add_f32 v201, 1.0, v201
    v_add_f32 v202, 1.0, v202
    v_add_f32 v203, 1.0, v203
    v_rcp_f32 v200, v200
    v_rcp_f32 v201, v201
    v_rcp_f32 v202, v202
    v_rcp_f32 v203, v203
    s_nop 0
    v_mul_f32 v112, v112, v200
    v_mul_f32 v113, v113, v201
    v_mul_f32 v114, v114, v202
    v_mul_f32 v115, v115, v203
    v_cvt_pk_bf16_f32 v214, v112, v113
    v_cvt_pk_bf16_f32 v215, v114, v115
    buffer_store_dwordx2 v[214:215], v185, s[44:47], 0 offen offset:256 sc1
    v_fma_f32 v84, -v166, v172, v84
    v_fma_f32 v85, -v166, v173, v85
    v_fma_f32 v86, -v166, v174, v86
    v_fma_f32 v87, -v166, v175, v87
    v_fma_f32 v84, v170, v84, v188
    v_fma_f32 v85, v170, v85, v189
    v_fma_f32 v86, v170, v86, v190
    v_fma_f32 v87, v170, v87, v191
    v_mul_f32 v200, v84, v84
    v_mul_f32 v201, v85, v85
    v_mul_f32 v202, v86, v86
    v_mul_f32 v203, v87, v87
    v_fma_f32 v200, v200, s63, v186
    v_fma_f32 v201, v201, s63, v186
    v_fma_f32 v202, v202, s63, v186
    v_fma_f32 v203, v203, s63, v186
    v_mul_f32 v200, v200, v84
    v_mul_f32 v201, v201, v85
    v_mul_f32 v202, v202, v86
    v_mul_f32 v203, v203, v87
    v_exp_f32 v200, v200
    v_exp_f32 v201, v201
    v_exp_f32 v202, v202
    v_exp_f32 v203, v203
    s_nop 0
    v_add_f32 v200, 1.0, v200
    v_add_f32 v201, 1.0, v201
    v_add_f32 v202, 1.0, v202
    v_add_f32 v203, 1.0, v203
    v_rcp_f32 v200, v200
    v_rcp_f32 v201, v201
    v_rcp_f32 v202, v202
    v_rcp_f32 v203, v203
    s_nop 0
    v_mul_f32 v84, v84, v200
    v_mul_f32 v85, v85, v201
    v_mul_f32 v86, v86, v202
    v_mul_f32 v87, v87, v203
    v_fma_f32 v100, -v166, v176, v100
    v_fma_f32 v101, -v166, v177, v101
    v_fma_f32 v102, -v166, v178, v102
    v_fma_f32 v103, -v166, v179, v103
    v_fma_f32 v100, v170, v100, v192
    v_fma_f32 v101, v170, v101, v193
    v_fma_f32 v102, v170, v102, v194
    v_fma_f32 v103, v170, v103, v195
    v_mul_f32 v200, v100, v100
    v_mul_f32 v201, v101, v101
    v_mul_f32 v202, v102, v102
    v_mul_f32 v203, v103, v103
    v_fma_f32 v200, v200, s63, v186
    v_fma_f32 v201, v201, s63, v186
    v_fma_f32 v202, v202, s63, v186
    v_fma_f32 v203, v203, s63, v186
    v_mul_f32 v200, v200, v100
    v_mul_f32 v201, v201, v101
    v_mul_f32 v202, v202, v102
    v_mul_f32 v203, v203, v103
    v_exp_f32 v200, v200
    v_exp_f32 v201, v201
    v_exp_f32 v202, v202
    v_exp_f32 v203, v203
    s_nop 0
    v_add_f32 v200, 1.0, v200
    v_add_f32 v201, 1.0, v201
    v_add_f32 v202, 1.0, v202
    v_add_f32 v203, 1.0, v203
    v_rcp_f32 v200, v200
    v_rcp_f32 v201, v201
    v_rcp_f32 v202, v202
    v_rcp_f32 v203, v203
    s_nop 0
    v_mul_f32 v100, v100, v200
    v_mul_f32 v101, v101, v201
    v_mul_f32 v102, v102, v202
    v_mul_f32 v103, v103, v203
    v_cvt_pk_bf16_f32 v204, v84, v85
    v_cvt_pk_bf16_f32 v205, v86, v87
    v_cvt_pk_bf16_f32 v206, v100, v101
    v_cvt_pk_bf16_f32 v207, v102, v103
    s_nop 1
    v_permlane16_swap_b32 v204, v206
    v_permlane16_swap_b32 v205, v207
    s_nop 1
    buffer_store_dwordx4 v[204:207], v184, s[44:47], 0 offen offset:512 sc1
    v_fma_f32 v116, -v166, v180, v116
    v_fma_f32 v117, -v166, v181, v117
    v_fma_f32 v118, -v166, v182, v118
    v_fma_f32 v119, -v166, v183, v119
    v_fma_f32 v116, v170, v116, v196
    v_fma_f32 v117, v170, v117, v197
    v_fma_f32 v118, v170, v118, v198
    v_fma_f32 v119, v170, v119, v199
    v_mul_f32 v200, v116, v116
    v_mul_f32 v201, v117, v117
    v_mul_f32 v202, v118, v118
    v_mul_f32 v203, v119, v119
    v_fma_f32 v200, v200, s63, v186
    v_fma_f32 v201, v201, s63, v186
    v_fma_f32 v202, v202, s63, v186
    v_fma_f32 v203, v203, s63, v186
    v_mul_f32 v200, v200, v116
    v_mul_f32 v201, v201, v117
    v_mul_f32 v202, v202, v118
    v_mul_f32 v203, v203, v119
    v_exp_f32 v200, v200
    v_exp_f32 v201, v201
    v_exp_f32 v202, v202
    v_exp_f32 v203, v203
    s_nop 0
    v_add_f32 v200, 1.0, v200
    v_add_f32 v201, 1.0, v201
    v_add_f32 v202, 1.0, v202
    v_add_f32 v203, 1.0, v203
    v_rcp_f32 v200, v200
    v_rcp_f32 v201, v201
    v_rcp_f32 v202, v202
    v_rcp_f32 v203, v203
    s_nop 0
    v_mul_f32 v116, v116, v200
    v_mul_f32 v117, v117, v201
    v_mul_f32 v118, v118, v202
    v_mul_f32 v119, v119, v203
    v_cvt_pk_bf16_f32 v212, v116, v117
    v_cvt_pk_bf16_f32 v213, v118, v119
    buffer_store_dwordx2 v[212:213], v185, s[44:47], 0 offen offset:512 sc1
    v_fma_f32 v88, -v167, v172, v88
    v_fma_f32 v89, -v167, v173, v89
    v_fma_f32 v90, -v167, v174, v90
    v_fma_f32 v91, -v167, v175, v91
    v_fma_f32 v88, v171, v88, v188
    v_fma_f32 v89, v171, v89, v189
    v_fma_f32 v90, v171, v90, v190
    v_fma_f32 v91, v171, v91, v191
    v_mul_f32 v200, v88, v88
    v_mul_f32 v201, v89, v89
    v_mul_f32 v202, v90, v90
    v_mul_f32 v203, v91, v91
    v_fma_f32 v200, v200, s63, v186
    v_fma_f32 v201, v201, s63, v186
    v_fma_f32 v202, v202, s63, v186
    v_fma_f32 v203, v203, s63, v186
    v_mul_f32 v200, v200, v88
    v_mul_f32 v201, v201, v89
    v_mul_f32 v202, v202, v90
    v_mul_f32 v203, v203, v91
    v_exp_f32 v200, v200
    v_exp_f32 v201, v201
    v_exp_f32 v202, v202
    v_exp_f32 v203, v203
    s_nop 0
    v_add_f32 v200, 1.0, v200
    v_add_f32 v201, 1.0, v201
    v_add_f32 v202, 1.0, v202
    v_add_f32 v203, 1.0, v203
    v_rcp_f32 v200, v200
    v_rcp_f32 v201, v201
    v_rcp_f32 v202, v202
    v_rcp_f32 v203, v203
    s_nop 0
    v_mul_f32 v88, v88, v200
    v_mul_f32 v89, v89, v201
    v_mul_f32 v90, v90, v202
    v_mul_f32 v91, v91, v203
    v_fma_f32 v104, -v167, v176, v104
    v_fma_f32 v105, -v167, v177, v105
    v_fma_f32 v106, -v167, v178, v106
    v_fma_f32 v107, -v167, v179, v107
    v_fma_f32 v104, v171, v104, v192
    v_fma_f32 v105, v171, v105, v193
    v_fma_f32 v106, v171, v106, v194
    v_fma_f32 v107, v171, v107, v195
    v_mul_f32 v200, v104, v104
    v_mul_f32 v201, v105, v105
    v_mul_f32 v202, v106, v106
    v_mul_f32 v203, v107, v107
    v_fma_f32 v200, v200, s63, v186
    v_fma_f32 v201, v201, s63, v186
    v_fma_f32 v202, v202, s63, v186
    v_fma_f32 v203, v203, s63, v186
    v_mul_f32 v200, v200, v104
    v_mul_f32 v201, v201, v105
    v_mul_f32 v202, v202, v106
    v_mul_f32 v203, v203, v107
    v_exp_f32 v200, v200
    v_exp_f32 v201, v201
    v_exp_f32 v202, v202
    v_exp_f32 v203, v203
    s_nop 0
    v_add_f32 v200, 1.0, v200
    v_add_f32 v201, 1.0, v201
    v_add_f32 v202, 1.0, v202
    v_add_f32 v203, 1.0, v203
    v_rcp_f32 v200, v200
    v_rcp_f32 v201, v201
    v_rcp_f32 v202, v202
    v_rcp_f32 v203, v203
    s_nop 0
    v_mul_f32 v104, v104, v200
    v_mul_f32 v105, v105, v201
    v_mul_f32 v106, v106, v202
    v_mul_f32 v107, v107, v203
    v_cvt_pk_bf16_f32 v208, v88, v89
    v_cvt_pk_bf16_f32 v209, v90, v91
    v_cvt_pk_bf16_f32 v210, v104, v105
    v_cvt_pk_bf16_f32 v211, v106, v107
    s_nop 1
    v_permlane16_swap_b32 v208, v210
    v_permlane16_swap_b32 v209, v211
    s_nop 1
    buffer_store_dwordx4 v[208:211], v184, s[44:47], 0 offen offset:768 sc1
    v_fma_f32 v120, -v167, v180, v120
    v_fma_f32 v121, -v167, v181, v121
    v_fma_f32 v122, -v167, v182, v122
    v_fma_f32 v123, -v167, v183, v123
    v_fma_f32 v120, v171, v120, v196
    v_fma_f32 v121, v171, v121, v197
    v_fma_f32 v122, v171, v122, v198
    v_fma_f32 v123, v171, v123, v199
    v_mul_f32 v200, v120, v120
    v_mul_f32 v201, v121, v121
    v_mul_f32 v202, v122, v122
    v_mul_f32 v203, v123, v123
    v_fma_f32 v200, v200, s63, v186
    v_fma_f32 v201, v201, s63, v186
    v_fma_f32 v202, v202, s63, v186
    v_fma_f32 v203, v203, s63, v186
    v_mul_f32 v200, v200, v120
    v_mul_f32 v201, v201, v121
    v_mul_f32 v202, v202, v122
    v_mul_f32 v203, v203, v123
    v_exp_f32 v200, v200
    v_exp_f32 v201, v201
    v_exp_f32 v202, v202
    v_exp_f32 v203, v203
    s_nop 0
    v_add_f32 v200, 1.0, v200
    v_add_f32 v201, 1.0, v201
    v_add_f32 v202, 1.0, v202
    v_add_f32 v203, 1.0, v203
    v_rcp_f32 v200, v200
    v_rcp_f32 v201, v201
    v_rcp_f32 v202, v202
    v_rcp_f32 v203, v203
    s_nop 0
    v_mul_f32 v120, v120, v200
    v_mul_f32 v121, v121, v201
    v_mul_f32 v122, v122, v202
    v_mul_f32 v123, v123, v203
    v_cvt_pk_bf16_f32 v214, v120, v121
    v_cvt_pk_bf16_f32 v215, v122, v123
    buffer_store_dwordx2 v[214:215], v185, s[44:47], 0 offen offset:768 sc1
k4_w1_kernel_p4skip4:
k4_w1_kernel_end1:
    s_endpgm
.globl k5_w2_kernel
.p2align 8
.type k5_w2_kernel,@function
k5_w2_kernel:
    s_cmp_ge_u32 s2, 256
    s_cbranch_scc1 k5_w2_kernel_end1
    s_load_dwordx16 s[4:19], s[0:1], 0
    s_load_dwordx4 s[20:23], s[0:1], 64
    s_load_dwordx2 s[24:25], s[0:1], 80
    v_lshrrev_b32 v5, 6, v0
    v_and_b32 v2, 63, v0
    v_readfirstlane_b32 s26, v5
    v_and_b32 v3, 15, v2
    v_lshrrev_b32 v4, 4, v2
    s_and_b32 s29, s26, 3
    s_and_b32 s27, s2, 7
    s_lshr_b32 s28, s2, 3
    s_lshl_b32 s30, s27, 1
    s_and_b32 s3, s28, 1
    s_add_u32 s30, s30, s3
    s_lshr_b32 s31, s28, 1
    s_lshl_b32 s32, s30, 1
    s_and_b32 s3, s31, 1
    s_add_u32 s32, s32, s3
    s_lshr_b32 s33, s31, 1
    s_and_b32 s34, s29, 1
    s_lshr_b32 s35, s29, 1
    v_lshlrev_b32 v8, 4, v2
    s_cmp_lt_u32 s26, 4
    s_cbranch_scc1 k5_w2_kernel_cons2
    s_mul_i32 s60, s33, 245760
    s_mul_i32 s3, s29, 5120
    s_add_u32 s60, s60, s3
    s_mul_i32 s62, s29, 5120
    s_lshl_b32 s63, s29, 12
    s_lshl_b32 s61, s29, 17
    s_lshl_b32 s3, s32, 10
    s_add_u32 s61, s61, s3
    s_waitcnt lgkmcnt(0)
    s_add_u32 s36, s24, 28311552
    s_addc_u32 s37, s25, 0
    s_and_b32 s37, s37, 0xffff
    s_mov_b32 s38, 1966080
    s_mov_b32 s39, 0x20000
    s_add_u32 s40, s24, 16777216
    s_addc_u32 s41, s25, 0
    s_and_b32 s41, s41, 0xffff
    s_mov_b32 s42, 6291456
    s_mov_b32 s43, 0x20000
    s_add_u32 m0, s63, 0
    s_add_u32 s3, s61, 0
    buffer_load_dwordx4 v8, s[40:43], s3 offen lds
    s_add_u32 m0, s63, 1024
    s_add_u32 s3, s61, 32768
    buffer_load_dwordx4 v8, s[40:43], s3 offen lds
    s_add_u32 m0, s63, 2048
    s_add_u32 s3, s61, 65536
    buffer_load_dwordx4 v8, s[40:43], s3 offen lds
    s_add_u32 m0, s63, 3072
    s_add_u32 s3, s61, 98304
    buffer_load_dwordx4 v8, s[40:43], s3 offen lds
    s_add_u32 s61, s61, 524288
    s_add_u32 m0, s62, 16384
    s_nop 0
    buffer_load_dwordx4 v8, s[36:39], s60 offen offset:0 lds
    buffer_load_dwordx4 v8, s[36:39], s60 offen offset:1024 lds
    buffer_load_dwordx4 v8, s[36:39], s60 offen offset:2048 lds
    buffer_load_dwordx4 v8, s[36:39], s60 offen offset:3072 lds
    s_add_u32 m0, s62, 20480
    s_add_u32 s3, s60, 4096
    buffer_load_dwordx4 v8, s[36:39], s3 offen lds
    s_add_u32 s60, s60, 20480
    s_add_u32 m0, s63, 36864
    s_add_u32 s3, s61, 0
    buffer_load_dwordx4 v8, s[40:43], s3 offen lds
    s_add_u32 m0, s63, 37888
    s_add_u32 s3, s61, 32768
    buffer_load_dwordx4 v8, s[40:43], s3 offen lds
    s_add_u32 m0, s63, 38912
    s_add_u32 s3, s61, 65536
    buffer_load_dwordx4 v8, s[40:43], s3 offen lds
    s_add_u32 m0, s63, 39936
    s_add_u32 s3, s61, 98304
    buffer_load_dwordx4 v8, s[40:43], s3 offen lds
    s_add_u32 s61, s61, 524288
    s_add_u32 m0, s62, 53248
    s_nop 0
    buffer_load_dwordx4 v8, s[36:39], s60 offen offset:0 lds
    buffer_load_dwordx4 v8, s[36:39], s60 offen offset:1024 lds
    buffer_load_dwordx4 v8, s[36:39], s60 offen offset:2048 lds
    buffer_load_dwordx4 v8, s[36:39], s60 offen offset:3072 lds
    s_add_u32 m0, s62, 57344
    s_add_u32 s3, s60, 4096
    buffer_load_dwordx4 v8, s[36:39], s3 offen lds
    s_add_u32 s60, s60, 20480
    s_waitcnt vmcnt(9)
    s_barrier
    s_add_u32 m0, s63, 73728
    s_add_u32 s3, s61, 0
    buffer_load_dwordx4 v8, s[40:43], s3 offen lds
    s_add_u32 m0, s63, 74752
    s_add_u32 s3, s61, 32768
    buffer_load_dwordx4 v8, s[40:43], s3 offen lds
    s_add_u32 m0, s63, 75776
    s_add_u32 s3, s61, 65536
    buffer_load_dwordx4 v8, s[40:43], s3 offen lds
    s_add_u32 m0, s63, 76800
    s_add_u32 s3, s61, 98304
    buffer_load_dwordx4 v8, s[40:43], s3 offen lds
    s_add_u32 s61, s61, 524288
    s_add_u32 m0, s62, 90112
    s_nop 0
    buffer_load_dwordx4 v8, s[36:39], s60 offen offset:0 lds
    buffer_load_dwordx4 v8, s[36:39], s60 offen offset:1024 lds
    buffer_load_dwordx4 v8, s[36:39], s60 offen offset:2048 lds
    buffer_load_dwordx4 v8, s[36:39], s60 offen offset:3072 lds
    s_add_u32 m0, s62, 94208
    s_add_u32 s3, s60, 4096
    buffer_load_dwordx4 v8, s[36:39], s3 offen lds
    s_add_u32 s60, s60, 20480
    s_add_u32 m0, s63, 110592
    s_add_u32 s3, s61, 0
    buffer_load_dwordx4 v8, s[40:43], s3 offen lds
    s_add_u32 m0, s63, 111616
    s_add_u32 s3, s61, 32768
    buffer_load_dwordx4 v8, s[40:43], s3 offen lds
    s_add_u32 m0, s63, 112640
    s_add_u32 s3, s61, 65536
    buffer_load_dwordx4 v8, s[40:43], s3 offen lds
    s_add_u32 m0, s63, 113664
    s_add_u32 s3, s61, 98304
    buffer_load_dwordx4 v8, s[40:43], s3 offen lds
    s_add_u32 s61, s61, 524288
    s_add_u32 m0, s62, 126976
    s_nop 0
    buffer_load_dwordx4 v8, s[36:39], s60 offen offset:0 lds
    buffer_load_dwordx4 v8, s[36:39], s60 offen offset:1024 lds
    buffer_load_dwordx4 v8, s[36:39], s60 offen offset:2048 lds
    buffer_load_dwordx4 v8, s[36:39], s60 offen offset:3072 lds
    s_add_u32 m0, s62, 131072
    s_add_u32 s3, s60, 4096
    buffer_load_dwordx4 v8, s[36:39], s3 offen lds
    s_add_u32 s60, s60, 20480
    s_waitcnt vmcnt(18)
    s_barrier
    s_add_u32 m0, s63, 0
    s_add_u32 s3, s61, 0
    buffer_load_dwordx4 v8, s[40:43], s3 offen lds
    s_add_u32 m0, s63, 1024
    s_add_u32 s3, s61, 32768
    buffer_load_dwordx4 v8, s[40:43], s3 offen lds
    s_add_u32 m0, s63, 2048
    s_add_u32 s3, s61, 65536
    buffer_load_dwordx4 v8, s[40:43], s3 offen lds
    s_add_u32 m0, s63, 3072
    s_add_u32 s3, s61, 98304
    buffer_load_dwordx4 v8, s[40:43], s3 offen lds
    s_add_u32 s61, s61, 524288
    s_add_u32 m0, s62, 16384
    s_nop 0
    buffer_load_dwordx4 v8, s[36:39], s60 offen offset:0 lds
    buffer_load_dwordx4 v8, s[36:39], s60 offen offset:1024 lds
    buffer_load_dwordx4 v8, s[36:39], s60 offen offset:2048 lds
    buffer_load_dwordx4 v8, s[36:39], s60 offen offset:3072 lds
    s_add_u32 m0, s62, 20480
    s_add_u32 s3, s60, 4096
    buffer_load_dwordx4 v8, s[36:39], s3 offen lds
    s_add_u32 s60, s60, 20480
    s_waitcnt vmcnt(18)
    s_barrier
    s_add_u32 m0, s63, 36864
    s_add_u32 s3, s61, 0
    buffer_load_dwordx4 v8, s[40:43], s3 offen lds
    s_add_u32 m0, s63, 37888
    s_add_u32 s3, s61, 32768
    buffer_load_dwordx4 v8, s[40:43], s3 offen lds
    s_add_u32 m0, s63, 38912
    s_add_u32 s3, s61, 65536
    buffer_load_dwordx4 v8, s[40:43], s3 offen lds
    s_add_u32 m0, s63, 39936
    s_add_u32 s3, s61, 98304
    buffer_load_dwordx4 v8, s[40:43], s3 offen lds
    s_add_u32 s61, s61, 524288
    s_add_u32 m0, s62, 53248
    s_nop 0
    buffer_load_dwordx4 v8, s[36:39], s60 offen offset:0 lds
    buffer_load_dwordx4 v8, s[36:39], s60 offen offset:1024 lds
    buffer_load_dwordx4 v8, s[36:39], s60 offen offset:2048 lds
    buffer_load_dwordx4 v8, s[36:39], s60 offen offset:3072 lds
    s_add_u32 m0, s62, 57344
    s_add_u32 s3, s60, 4096
    buffer_load_dwordx4 v8, s[36:39], s3 offen lds
    s_add_u32 s60, s60, 20480
    s_waitcnt vmcnt(18)
    s_barrier
    s_add_u32 m0, s63, 73728
    s_add_u32 s3, s61, 0
    buffer_load_dwordx4 v8, s[40:43], s3 offen lds
    s_add_u32 m0, s63, 74752
    s_add_u32 s3, s61, 32768
    buffer_load_dwordx4 v8, s[40:43], s3 offen lds
    s_add_u32 m0, s63, 75776
    s_add_u32 s3, s61, 65536
    buffer_load_dwordx4 v8, s[40:43], s3 offen lds
    s_add_u32 m0, s63, 76800
    s_add_u32 s3, s61, 98304
    buffer_load_dwordx4 v8, s[40:43], s3 offen lds
    s_add_u32 s61, s61, 524288
    s_add_u32 m0, s62, 90112
    s_nop 0
    buffer_load_dwordx4 v8, s[36:39], s60 offen offset:0 lds
    buffer_load_dwordx4 v8, s[36:39], s60 offen offset:1024 lds
    buffer_load_dwordx4 v8, s[36:39], s60 offen offset:2048 lds
    buffer_load_dwordx4 v8, s[36:39], s60 offen offset:3072 lds
    s_add_u32 m0, s62, 94208
    s_add_u32 s3, s60, 4096
    buffer_load_dwordx4 v8, s[36:39], s3 offen lds
    s_add_u32 s60, s60, 20480
    s_waitcnt vmcnt(18)
    s_barrier
    s_add_u32 m0, s63, 110592
    s_add_u32 s3, s61, 0
    buffer_load_dwordx4 v8, s[40:43], s3 offen lds
    s_add_u32 m0, s63, 111616
    s_add_u32 s3, s61, 32768
    buffer_load_dwordx4 v8, s[40:43], s3 offen lds
    s_add_u32 m0, s63, 112640
    s_add_u32 s3, s61, 65536
    buffer_load_dwordx4 v8, s[40:43], s3 offen lds
    s_add_u32 m0, s63, 113664
    s_add_u32 s3, s61, 98304
    buffer_load_dwordx4 v8, s[40:43], s3 offen lds
    s_add_u32 s61, s61, 524288
    s_add_u32 m0, s62, 126976
    s_nop 0
    buffer_load_dwordx4 v8, s[36:39], s60 offen offset:0 lds
    buffer_load_dwordx4 v8, s[36:39], s60 offen offset:1024 lds
    buffer_load_dwordx4 v8, s[36:39], s60 offen offset:2048 lds
    buffer_load_dwordx4 v8, s[36:39], s60 offen offset:3072 lds
    s_add_u32 m0, s62, 131072
    s_add_u32 s3, s60, 4096
    buffer_load_dwordx4 v8, s[36:39], s3 offen lds
    s_add_u32 s60, s60, 20480
    s_waitcnt vmcnt(18)
    s_barrier
    s_add_u32 m0, s63, 0
    s_add_u32 s3, s61, 0
    buffer_load_dwordx4 v8, s[40:43], s3 offen lds
    s_add_u32 m0, s63, 1024
    s_add_u32 s3, s61, 32768
    buffer_load_dwordx4 v8, s[40:43], s3 offen lds
    s_add_u32 m0, s63, 2048
    s_add_u32 s3, s61, 65536
    buffer_load_dwordx4 v8, s[40:43], s3 offen lds
    s_add_u32 m0, s63, 3072
    s_add_u32 s3, s61, 98304
    buffer_load_dwordx4 v8, s[40:43], s3 offen lds
    s_add_u32 s61, s61, 524288
    s_add_u32 m0, s62, 16384
    s_nop 0
    buffer_load_dwordx4 v8, s[36:39], s60 offen offset:0 lds
    buffer_load_dwordx4 v8, s[36:39], s60 offen offset:1024 lds
    buffer_load_dwordx4 v8, s[36:39], s60 offen offset:2048 lds
    buffer_load_dwordx4 v8, s[36:39], s60 offen offset:3072 lds
    s_add_u32 m0, s62, 20480
    s_add_u32 s3, s60, 4096
    buffer_load_dwordx4 v8, s[36:39], s3 offen lds
    s_add_u32 s60, s60, 20480
    s_waitcnt vmcnt(18)
    s_barrier
    s_add_u32 m0, s63, 36864
    s_add_u32 s3, s61, 0
    buffer_load_dwordx4 v8, s[40:43], s3 offen lds
    s_add_u32 m0, s63, 37888
    s_add_u32 s3, s61, 32768
    buffer_load_dwordx4 v8, s[40:43], s3 offen lds
    s_add_u32 m0, s63, 38912
    s_add_u32 s3, s61, 65536
    buffer_load_dwordx4 v8, s[40:43], s3 offen lds
    s_add_u32 m0, s63, 39936
    s_add_u32 s3, s61, 98304
    buffer_load_dwordx4 v8, s[40:43], s3 offen lds
    s_add_u32 s61, s61, 524288
    s_add_u32 m0, s62, 53248
    s_nop 0
    buffer_load_dwordx4 v8, s[36:39], s60 offen offset:0 lds
    buffer_load_dwordx4 v8, s[36:39], s60 offen offset:1024 lds
    buffer_load_dwordx4 v8, s[36:39], s60 offen offset:2048 lds
    buffer_load_dwordx4 v8, s[36:39], s60 offen offset:3072 lds
    s_add_u32 m0, s62, 57344
    s_add_u32 s3, s60, 4096
    buffer_load_dwordx4 v8, s[36:39], s3 offen lds
    s_add_u32 s60, s60, 20480
    s_waitcnt vmcnt(18)
    s_barrier
    s_add_u32 m0, s63, 73728
    s_add_u32 s3, s61, 0
    buffer_load_dwordx4 v8, s[40:43], s3 offen lds
    s_add_u32 m0, s63, 74752
    s_add_u32 s3, s61, 32768
    buffer_load_dwordx4 v8, s[40:43], s3 offen lds
    s_add_u32 m0, s63, 75776
    s_add_u32 s3, s61, 65536
    buffer_load_dwordx4 v8, s[40:43], s3 offen lds
    s_add_u32 m0, s63, 76800
    s_add_u32 s3, s61, 98304
    buffer_load_dwordx4 v8, s[40:43], s3 offen lds
    s_add_u32 s61, s61, 524288
    s_add_u32 m0, s62, 90112
    s_nop 0
    buffer_load_dwordx4 v8, s[36:39], s60 offen offset:0 lds
    buffer_load_dwordx4 v8, s[36:39], s60 offen offset:1024 lds
    buffer_load_dwordx4 v8, s[36:39], s60 offen offset:2048 lds
    buffer_load_dwordx4 v8, s[36:39], s60 offen offset:3072 lds
    s_add_u32 m0, s62, 94208
    s_add_u32 s3, s60, 4096
    buffer_load_dwordx4 v8, s[36:39], s3 offen lds
    s_add_u32 s60, s60, 20480
    s_waitcnt vmcnt(18)
    s_barrier
    s_add_u32 m0, s63, 110592
    s_add_u32 s3, s61, 0
    buffer_load_dwordx4 v8, s[40:43], s3 offen lds
    s_add_u32 m0, s63, 111616
    s_add_u32 s3, s61, 32768
    buffer_load_dwordx4 v8, s[40:43], s3 offen lds
    s_add_u32 m0, s63, 112640
    s_add_u32 s3, s61, 65536
    buffer_load_dwordx4 v8, s[40:43], s3 offen lds
    s_add_u32 m0, s63, 113664
    s_add_u32 s3, s61, 98304
    buffer_load_dwordx4 v8, s[40:43], s3 offen lds
    s_add_u32 s61, s61, 524288
    s_add_u32 m0, s62, 126976
    s_nop 0
    buffer_load_dwordx4 v8, s[36:39], s60 offen offset:0 lds
    buffer_load_dwordx4 v8, s[36:39], s60 offen offset:1024 lds
    buffer_load_dwordx4 v8, s[36:39], s60 offen offset:2048 lds
    buffer_load_dwordx4 v8, s[36:39], s60 offen offset:3072 lds
    s_add_u32 m0, s62, 131072
    s_add_u32 s3, s60, 4096
    buffer_load_dwordx4 v8, s[36:39], s3 offen lds
    s_add_u32 s60, s60, 20480
    s_waitcnt vmcnt(18)
    s_barrier
    s_waitcnt vmcnt(9)
    s_barrier
    s_waitcnt vmcnt(0)
    s_barrier
    s_branch k5_w2_kernel_after3
k5_w2_kernel_cons2:
    s_lshl_b32 s3, s32, 6
    s_lshl_b32 s27, s34, 5
    s_add_u32 s3, s3, s27
    v_add_u32 v9, s3, v3
    v_add_u32 v10, 16, v9
    s_lshl_b32 s3, s34, 9
    s_lshl_b32 s27, s35, 12
    s_add_u32 s3, s3, s27
    v_lshlrev_b32 v11, 10, v4
    v_lshl_add_u32 v11, v3, 4, v11
    v_add_u32 v11, s3, v11
    s_mul_i32 s3, s35, 5120
    s_add_u32 s3, s3, 16384
    v_add_u32 v12, s3, v8
    v_mov_b32 v72, 0
    v_mov_b32 v73, 0
    v_mov_b32 v74, 0
    v_mov_b32 v75, 0
    v_mov_b32 v76, 0
    v_mov_b32 v77, 0
    v_mov_b32 v78, 0
    v_mov_b32 v79, 0
    v_mov_b32 v80, 0
    v_mov_b32 v81, 0
    v_mov_b32 v82, 0
    v_mov_b32 v83, 0
    v_mov_b32 v84, 0
    v_mov_b32 v85, 0
    v_mov_b32 v86, 0
    v_mov_b32 v87, 0
    v_mov_b32 v88, 0
    v_mov_b32 v89, 0
    v_mov_b32 v90, 0
    v_mov_b32 v91, 0
    v_mov_b32 v92, 0
    v_mov_b32 v93, 0
    v_mov_b32 v94, 0
    v_mov_b32 v95, 0
    v_mov_b32 v96, 0
    v_mov_b32 v97, 0
    v_mov_b32 v98, 0
    v_mov_b32 v99, 0
    v_mov_b32 v100, 0
    v_mov_b32 v101, 0
    v_mov_b32 v102, 0
    v_mov_b32 v103, 0
    v_mov_b32 v104, 0
    v_mov_b32 v105, 0
    v_mov_b32 v106, 0
    v_mov_b32 v107, 0
    v_mov_b32 v108, 0
    v_mov_b32 v109, 0
    v_mov_b32 v110, 0
    v_mov_b32 v111, 0
    s_lshl_b32 s3, s34, 10
    v_add_u32 v145, s3, v8
    v_mul_u32_u24 v142, 1280, v9
    s_mul_i32 s3, s33, 160
    v_lshl_add_u32 v142, v4, 3, v142
    v_add_u32 v142, s3, v142
    s_mul_i32 s3, s33, 10
    v_lshrrev_b32 v5, 1, v4
    v_add_u32 v5, s3, v5
    v_lshlrev_b32 v143, 15, v5
    v_lshl_add_u32 v143, v9, 4, v143
    v_and_b32 v5, 1, v4
    v_lshl_add_u32 v143, v5, 3, v143
    s_waitcnt lgkmcnt(0)
    s_add_u32 s44, s24, 11534336
    s_addc_u32 s45, s25, 0
    s_and_b32 s45, s45, 0xffff
    s_mov_b32 s46, 2621440
    s_mov_b32 s47, 0x20000
    s_mov_b32 s48, s20
    s_and_b32 s49, s21, 0xffff
    s_mov_b32 s50, 2621440
    s_mov_b32 s51, 0x20000
    s_mov_b32 s56, s18
    s_and_b32 s57, s19, 0xffff
    s_mov_b32 s58, 1280
    s_mov_b32 s59, 0x20000
    s_cmp_lg_u32 s35, 0
    s_cbranch_scc1 k5_w2_kernel_noload4
    s_mul_i32 s3, s33, 160
    v_lshlrev_b32 v144, 3, v4
    v_add_u32 v144, s3, v144
    buffer_load_dwordx2 v[132:133], v144, s[56:59], 0 offen offset:0
    buffer_load_dwordx2 v[134:135], v144, s[56:59], 0 offen offset:32
    buffer_load_dwordx2 v[136:137], v144, s[56:59], 0 offen offset:64
    buffer_load_dwordx2 v[138:139], v144, s[56:59], 0 offen offset:96
    buffer_load_dwordx2 v[140:141], v144, s[56:59], 0 offen offset:128
    s_mov_b32 s64, 0
    buffer_load_dwordx2 v[112:113], v143, s[44:47], s64 offen offset:0
    buffer_load_dwordx2 v[114:115], v143, s[44:47], s64 offen offset:256
    s_mov_b32 s64, 65536
    buffer_load_dwordx2 v[116:117], v143, s[44:47], s64 offen offset:0
    buffer_load_dwordx2 v[118:119], v143, s[44:47], s64 offen offset:256
    s_mov_b32 s64, 131072
    buffer_load_dwordx2 v[120:121], v143, s[44:47], s64 offen offset:0
    buffer_load_dwordx2 v[122:123], v143, s[44:47], s64 offen offset:256
    s_mov_b32 s64, 196608
    buffer_load_dwordx2 v[124:125], v143, s[44:47], s64 offen offset:0
    buffer_load_dwordx2 v[126:127], v143, s[44:47], s64 offen offset:256
    s_mov_b32 s64, 262144
    buffer_load_dwordx2 v[128:129], v143, s[44:47], s64 offen offset:0
    buffer_load_dwordx2 v[130:131], v143, s[44:47], s64 offen offset:256
k5_w2_kernel_noload4:
    s_waitcnt lgkmcnt(0)
    s_barrier
    v_add_u32 v14, 0, v12
    v_add_u32 v13, 0, v11
    ds_read_b128 v[16:19], v13 offset:0
    ds_read_b128 v[20:23], v13 offset:256
    ds_read_b128 v[32:35], v14 offset:0
    ds_read_b128 v[36:39], v14 offset:1024
    ds_read_b128 v[40:43], v14 offset:2048
    ds_read_b128 v[44:47], v14 offset:3072
    ds_read_b128 v[48:51], v14 offset:4096
    s_waitcnt lgkmcnt(0)
    ds_read_b128 v[24:27], v13 offset:8192
    v_mfma_f32_16x16x32_bf16 v[72:75], v[32:35], v[16:19], v[72:75]
    ds_read_b128 v[28:31], v13 offset:8448
    v_mfma_f32_16x16x32_bf16 v[76:79], v[32:35], v[20:23], v[76:79]
    ds_read_b128 v[52:55], v14 offset:10240
    v_mfma_f32_16x16x32_bf16 v[80:83], v[36:39], v[16:19], v[80:83]
    ds_read_b128 v[56:59], v14 offset:11264
    v_mfma_f32_16x16x32_bf16 v[84:87], v[36:39], v[20:23], v[84:87]
    ds_read_b128 v[60:63], v14 offset:12288
    v_mfma_f32_16x16x32_bf16 v[88:91], v[40:43], v[16:19], v[88:91]
    ds_read_b128 v[64:67], v14 offset:13312
    v_mfma_f32_16x16x32_bf16 v[92:95], v[40:43], v[20:23], v[92:95]
    ds_read_b128 v[68:71], v14 offset:14336
    v_mfma_f32_16x16x32_bf16 v[96:99], v[44:47], v[16:19], v[96:99]
    v_mfma_f32_16x16x32_bf16 v[100:103], v[44:47], v[20:23], v[100:103]
    v_mfma_f32_16x16x32_bf16 v[104:107], v[48:51], v[16:19], v[104:107]
    v_mfma_f32_16x16x32_bf16 v[108:111], v[48:51], v[20:23], v[108:111]
    s_waitcnt lgkmcnt(0)
    s_barrier
    v_add_u32 v14, 32768, v12
    v_add_u32 v13, 32768, v11
    ds_read_b128 v[16:19], v13 offset:4096
    v_mfma_f32_16x16x32_bf16 v[72:75], v[52:55], v[24:27], v[72:75]
    ds_read_b128 v[20:23], v13 offset:4352
    v_mfma_f32_16x16x32_bf16 v[76:79], v[52:55], v[28:31], v[76:79]
    ds_read_b128 v[32:35], v14 offset:4096
    v_mfma_f32_16x16x32_bf16 v[80:83], v[56:59], v[24:27], v[80:83]
    ds_read_b128 v[36:39], v14 offset:5120
    v_mfma_f32_16x16x32_bf16 v[84:87], v[56:59], v[28:31], v[84:87]
    ds_read_b128 v[40:43], v14 offset:6144
    v_mfma_f32_16x16x32_bf16 v[88:91], v[60:63], v[24:27], v[88:91]
    ds_read_b128 v[44:47], v14 offset:7168
    v_mfma_f32_16x16x32_bf16 v[92:95], v[60:63], v[28:31], v[92:95]
    ds_read_b128 v[48:51], v14 offset:8192
    v_mfma_f32_16x16x32_bf16 v[96:99], v[64:67], v[24:27], v[96:99]
    v_mfma_f32_16x16x32_bf16 v[100:103], v[64:67], v[28:31], v[100:103]
    v_mfma_f32_16x16x32_bf16 v[104:107], v[68:71], v[24:27], v[104:107]
    v_mfma_f32_16x16x32_bf16 v[108:111], v[68:71], v[28:31], v[108:111]
    s_waitcnt lgkmcnt(0)
    ds_read_b128 v[24:27], v13 offset:12288
    v_mfma_f32_16x16x32_bf16 v[72:75], v[32:35], v[16:19], v[72:75]
    ds_read_b128 v[28:31], v13 offset:12544
    v_mfma_f32_16x16x32_bf16 v[76:79], v[32:35], v[20:23], v[76:79]
    ds_read_b128 v[52:55], v14 offset:14336
    v_mfma_f32_16x16x32_bf16 v[80:83], v[36:39], v[16:19], v[80:83]
    ds_read_b128 v[56:59], v14 offset:15360
    v_mfma_f32_16x16x32_bf16 v[84:87], v[36:39], v[20:23], v[84:87]
    ds_read_b128 v[60:63], v14 offset:16384
    v_mfma_f32_16x16x32_bf16 v[88:91], v[40:43], v[16:19], v[88:91]
    ds_read_b128 v[64:67], v14 offset:17408
    v_mfma_f32_16x16x32_bf16 v[92:95], v[40:43], v[20:23], v[92:95]
    ds_read_b128 v[68:71], v14 offset:18432
    v_mfma_f32_16x16x32_bf16 v[96:99], v[44:47], v[16:19], v[96:99]
    v_mfma_f32_16x16x32_bf16 v[100:103], v[44:47], v[20:23], v[100:103]
    v_mfma_f32_16x16x32_bf16 v[104:107], v[48:51], v[16:19], v[104:107]
    v_mfma_f32_16x16x32_bf16 v[108:111], v[48:51], v[20:23], v[108:111]
    s_waitcnt lgkmcnt(0)
    s_barrier
    v_add_u32 v14, 65536, v12
    v_add_u32 v13, 65536, v11
    ds_read_b128 v[16:19], v13 offset:8192
    v_mfma_f32_16x16x32_bf16 v[72:75], v[52:55], v[24:27], v[72:75]
    ds_read_b128 v[20:23], v13 offset:8448
    v_mfma_f32_16x16x32_bf16 v[76:79], v[52:55], v[28:31], v[76:79]
    ds_read_b128 v[32:35], v14 offset:8192
    v_mfma_f32_16x16x32_bf16 v[80:83], v[56:59], v[24:27], v[80:83]
    ds_read_b128 v[36:39], v14 offset:9216
    v_mfma_f32_16x16x32_bf16 v[84:87], v[56:59], v[28:31], v[84:87]
    ds_read_b128 v[40:43], v14 offset:10240
    v_mfma_f32_16x16x32_bf16 v[88:91], v[60:63], v[24:27], v[88:91]
    ds_read_b128 v[44:47], v14 offset:11264
    v_mfma_f32_16x16x32_bf16 v[92:95], v[60:63], v[28:31], v[92:95]
    ds_read_b128 v[48:51], v14 offset:12288
    v_mfma_f32_16x16x32_bf16 v[96:99], v[64:67], v[24:27], v[96:99]
    v_mfma_f32_16x16x32_bf16 v[100:103], v[64:67], v[28:31], v[100:103]
    v_mfma_f32_16x16x32_bf16 v[104:107], v[68:71], v[24:27], v[104:107]
    v_mfma_f32_16x16x32_bf16 v[108:111], v[68:71], v[28:31], v[108:111]
    s_waitcnt lgkmcnt(0)
    ds_read_b128 v[24:27], v13 offset:16384
    v_mfma_f32_16x16x32_bf16 v[72:75], v[32:35], v[16:19], v[72:75]
    ds_read_b128 v[28:31], v13 offset:16640
    v_mfma_f32_16x16x32_bf16 v[76:79], v[32:35], v[20:23], v[76:79]
    ds_read_b128 v[52:55], v14 offset:18432
    v_mfma_f32_16x16x32_bf16 v[80:83], v[36:39], v[16:19], v[80:83]
    ds_read_b128 v[56:59], v14 offset:19456
    v_mfma_f32_16x16x32_bf16 v[84:87], v[36:39], v[20:23], v[84:87]
    ds_read_b128 v[60:63], v14 offset:20480
    v_mfma_f32_16x16x32_bf16 v[88:91], v[40:43], v[16:19], v[88:91]
    ds_read_b128 v[64:67], v14 offset:21504
    v_mfma_f32_16x16x32_bf16 v[92:95], v[40:43], v[20:23], v[92:95]
    ds_read_b128 v[68:71], v14 offset:22528
    v_mfma_f32_16x16x32_bf16 v[96:99], v[44:47], v[16:19], v[96:99]
    v_mfma_f32_16x16x32_bf16 v[100:103], v[44:47], v[20:23], v[100:103]
    v_mfma_f32_16x16x32_bf16 v[104:107], v[48:51], v[16:19], v[104:107]
    v_mfma_f32_16x16x32_bf16 v[108:111], v[48:51], v[20:23], v[108:111]
    s_waitcnt lgkmcnt(0)
    s_barrier
    v_add_u32 v14, 98304, v12
    v_add_u32 v13, 98304, v11
    ds_read_b128 v[16:19], v13 offset:12288
    v_mfma_f32_16x16x32_bf16 v[72:75], v[52:55], v[24:27], v[72:75]
    ds_read_b128 v[20:23], v13 offset:12544
    v_mfma_f32_16x16x32_bf16 v[76:79], v[52:55], v[28:31], v[76:79]
    ds_read_b128 v[32:35], v14 offset:12288
    v_mfma_f32_16x16x32_bf16 v[80:83], v[56:59], v[24:27], v[80:83]
    ds_read_b128 v[36:39], v14 offset:13312
    v_mfma_f32_16x16x32_bf16 v[84:87], v[56:59], v[28:31], v[84:87]
    ds_read_b128 v[40:43], v14 offset:14336
    v_mfma_f32_16x16x32_bf16 v[88:91], v[60:63], v[24:27], v[88:91]
    ds_read_b128 v[44:47], v14 offset:15360
    v_mfma_f32_16x16x32_bf16 v[92:95], v[60:63], v[28:31], v[92:95]
    ds_read_b128 v[48:51], v14 offset:16384
    v_mfma_f32_16x16x32_bf16 v[96:99], v[64:67], v[24:27], v[96:99]
    v_mfma_f32_16x16x32_bf16 v[100:103], v[64:67], v[28:31], v[100:103]
    v_mfma_f32_16x16x32_bf16 v[104:107], v[68:71], v[24:27], v[104:107]
    v_mfma_f32_16x16x32_bf16 v[108:111], v[68:71], v[28:31], v[108:111]
    s_waitcnt lgkmcnt(0)
    ds_read_b128 v[24:27], v13 offset:20480
    v_mfma_f32_16x16x32_bf16 v[72:75], v[32:35], v[16:19], v[72:75]
    ds_read_b128 v[28:31], v13 offset:20736
    v_mfma_f32_16x16x32_bf16 v[76:79], v[32:35], v[20:23], v[76:79]
    ds_read_b128 v[52:55], v14 offset:22528
    v_mfma_f32_16x16x32_bf16 v[80:83], v[36:39], v[16:19], v[80:83]
    ds_read_b128 v[56:59], v14 offset:23552
    v_mfma_f32_16x16x32_bf16 v[84:87], v[36:39], v[20:23], v[84:87]
    ds_read_b128 v[60:63], v14 offset:24576
    v_mfma_f32_16x16x32_bf16 v[88:91], v[40:43], v[16:19], v[88:91]
    ds_read_b128 v[64:67], v14 offset:25600
    v_mfma_f32_16x16x32_bf16 v[92:95], v[40:43], v[20:23], v[92:95]
    ds_read_b128 v[68:71], v14 offset:26624
    v_mfma_f32_16x16x32_bf16 v[96:99], v[44:47], v[16:19], v[96:99]
    v_mfma_f32_16x16x32_bf16 v[100:103], v[44:47], v[20:23], v[100:103]
    v_mfma_f32_16x16x32_bf16 v[104:107], v[48:51], v[16:19], v[104:107]
    v_mfma_f32_16x16x32_bf16 v[108:111], v[48:51], v[20:23], v[108:111]
    s_waitcnt lgkmcnt(0)
    s_barrier
    v_add_u32 v14, 0, v12
    v_add_u32 v13, 0, v11
    ds_read_b128 v[16:19], v13 offset:0
    v_mfma_f32_16x16x32_bf16 v[72:75], v[52:55], v[24:27], v[72:75]
    ds_read_b128 v[20:23], v13 offset:256
    v_mfma_f32_16x16x32_bf16 v[76:79], v[52:55], v[28:31], v[76:79]
    ds_read_b128 v[32:35], v14 offset:0
    v_mfma_f32_16x16x32_bf16 v[80:83], v[56:59], v[24:27], v[80:83]
    ds_read_b128 v[36:39], v14 offset:1024
    v_mfma_f32_16x16x32_bf16 v[84:87], v[56:59], v[28:31], v[84:87]
    ds_read_b128 v[40:43], v14 offset:2048
    v_mfma_f32_16x16x32_bf16 v[88:91], v[60:63], v[24:27], v[88:91]
    ds_read_b128 v[44:47], v14 offset:3072
    v_mfma_f32_16x16x32_bf16 v[92:95], v[60:63], v[28:31], v[92:95]
    ds_read_b128 v[48:51], v14 offset:4096
    v_mfma_f32_16x16x32_bf16 v[96:99], v[64:67], v[24:27], v[96:99]
    v_mfma_f32_16x16x32_bf16 v[100:103], v[64:67], v[28:31], v[100:103]
    v_mfma_f32_16x16x32_bf16 v[104:107], v[68:71], v[24:27], v[104:107]
    v_mfma_f32_16x16x32_bf16 v[108:111], v[68:71], v[28:31], v[108:111]
    s_waitcnt lgkmcnt(0)
    ds_read_b128 v[24:27], v13 offset:8192
    v_mfma_f32_16x16x32_bf16 v[72:75], v[32:35], v[16:19], v[72:75]
    ds_read_b128 v[28:31], v13 offset:8448
    v_mfma_f32_16x16x32_bf16 v[76:79], v[32:35], v[20:23], v[76:79]
    ds_read_b128 v[52:55], v14 offset:10240
    v_mfma_f32_16x16x32_bf16 v[80:83], v[36:39], v[16:19], v[80:83]
    ds_read_b128 v[56:59], v14 offset:11264
    v_mfma_f32_16x16x32_bf16 v[84:87], v[36:39], v[20:23], v[84:87]
    ds_read_b128 v[60:63], v14 offset:12288
    v_mfma_f32_16x16x32_bf16 v[88:91], v[40:43], v[16:19], v[88:91]
    ds_read_b128 v[64:67], v14 offset:13312
    v_mfma_f32_16x16x32_bf16 v[92:95], v[40:43], v[20:23], v[92:95]
    ds_read_b128 v[68:71], v14 offset:14336
    v_mfma_f32_16x16x32_bf16 v[96:99], v[44:47], v[16:19], v[96:99]
    v_mfma_f32_16x16x32_bf16 v[100:103], v[44:47], v[20:23], v[100:103]
    v_mfma_f32_16x16x32_bf16 v[104:107], v[48:51], v[16:19], v[104:107]
    v_mfma_f32_16x16x32_bf16 v[108:111], v[48:51], v[20:23], v[108:111]
    s_waitcnt lgkmcnt(0)
    s_barrier
    v_add_u32 v14, 32768, v12
    v_add_u32 v13, 32768, v11
    ds_read_b128 v[16:19], v13 offset:4096
    v_mfma_f32_16x16x32_bf16 v[72:75], v[52:55], v[24:27], v[72:75]
    ds_read_b128 v[20:23], v13 offset:4352
    v_mfma_f32_16x16x32_bf16 v[76:79], v[52:55], v[28:31], v[76:79]
    ds_read_b128 v[32:35], v14 offset:4096
    v_mfma_f32_16x16x32_bf16 v[80:83], v[56:59], v[24:27], v[80:83]
    ds_read_b128 v[36:39], v14 offset:5120
    v_mfma_f32_16x16x32_bf16 v[84:87], v[56:59], v[28:31], v[84:87]
    ds_read_b128 v[40:43], v14 offset:6144
    v_mfma_f32_16x16x32_bf16 v[88:91], v[60:63], v[24:27], v[88:91]
    ds_read_b128 v[44:47], v14 offset:7168
    v_mfma_f32_16x16x32_bf16 v[92:95], v[60:63], v[28:31], v[92:95]
    ds_read_b128 v[48:51], v14 offset:8192
    v_mfma_f32_16x16x32_bf16 v[96:99], v[64:67], v[24:27], v[96:99]
    v_mfma_f32_16x16x32_bf16 v[100:103], v[64:67], v[28:31], v[100:103]
    v_mfma_f32_16x16x32_bf16 v[104:107], v[68:71], v[24:27], v[104:107]
    v_mfma_f32_16x16x32_bf16 v[108:111], v[68:71], v[28:31], v[108:111]
    s_waitcnt lgkmcnt(0)
    ds_read_b128 v[24:27], v13 offset:12288
    v_mfma_f32_16x16x32_bf16 v[72:75], v[32:35], v[16:19], v[72:75]
    ds_read_b128 v[28:31], v13 offset:12544
    v_mfma_f32_16x16x32_bf16 v[76:79], v[32:35], v[20:23], v[76:79]
    ds_read_b128 v[52:55], v14 offset:14336
    v_mfma_f32_16x16x32_bf16 v[80:83], v[36:39], v[16:19], v[80:83]
    ds_read_b128 v[56:59], v14 offset:15360
    v_mfma_f32_16x16x32_bf16 v[84:87], v[36:39], v[20:23], v[84:87]
    ds_read_b128 v[60:63], v14 offset:16384
    v_mfma_f32_16x16x32_bf16 v[88:91], v[40:43], v[16:19], v[88:91]
    ds_read_b128 v[64:67], v14 offset:17408
    v_mfma_f32_16x16x32_bf16 v[92:95], v[40:43], v[20:23], v[92:95]
    ds_read_b128 v[68:71], v14 offset:18432
    v_mfma_f32_16x16x32_bf16 v[96:99], v[44:47], v[16:19], v[96:99]
    v_mfma_f32_16x16x32_bf16 v[100:103], v[44:47], v[20:23], v[100:103]
    v_mfma_f32_16x16x32_bf16 v[104:107], v[48:51], v[16:19], v[104:107]
    v_mfma_f32_16x16x32_bf16 v[108:111], v[48:51], v[20:23], v[108:111]
    s_waitcnt lgkmcnt(0)
    s_barrier
    v_add_u32 v14, 65536, v12
    v_add_u32 v13, 65536, v11
    ds_read_b128 v[16:19], v13 offset:8192
    v_mfma_f32_16x16x32_bf16 v[72:75], v[52:55], v[24:27], v[72:75]
    ds_read_b128 v[20:23], v13 offset:8448
    v_mfma_f32_16x16x32_bf16 v[76:79], v[52:55], v[28:31], v[76:79]
    ds_read_b128 v[32:35], v14 offset:8192
    v_mfma_f32_16x16x32_bf16 v[80:83], v[56:59], v[24:27], v[80:83]
    ds_read_b128 v[36:39], v14 offset:9216
    v_mfma_f32_16x16x32_bf16 v[84:87], v[56:59], v[28:31], v[84:87]
    ds_read_b128 v[40:43], v14 offset:10240
    v_mfma_f32_16x16x32_bf16 v[88:91], v[60:63], v[24:27], v[88:91]
    ds_read_b128 v[44:47], v14 offset:11264
    v_mfma_f32_16x16x32_bf16 v[92:95], v[60:63], v[28:31], v[92:95]
    ds_read_b128 v[48:51], v14 offset:12288
    v_mfma_f32_16x16x32_bf16 v[96:99], v[64:67], v[24:27], v[96:99]
    v_mfma_f32_16x16x32_bf16 v[100:103], v[64:67], v[28:31], v[100:103]
    v_mfma_f32_16x16x32_bf16 v[104:107], v[68:71], v[24:27], v[104:107]
    v_mfma_f32_16x16x32_bf16 v[108:111], v[68:71], v[28:31], v[108:111]
    s_waitcnt lgkmcnt(0)
    ds_read_b128 v[24:27], v13 offset:16384
    v_mfma_f32_16x16x32_bf16 v[72:75], v[32:35], v[16:19], v[72:75]
    ds_read_b128 v[28:31], v13 offset:16640
    v_mfma_f32_16x16x32_bf16 v[76:79], v[32:35], v[20:23], v[76:79]
    ds_read_b128 v[52:55], v14 offset:18432
    v_mfma_f32_16x16x32_bf16 v[80:83], v[36:39], v[16:19], v[80:83]
    ds_read_b128 v[56:59], v14 offset:19456
    v_mfma_f32_16x16x32_bf16 v[84:87], v[36:39], v[20:23], v[84:87]
    ds_read_b128 v[60:63], v14 offset:20480
    v_mfma_f32_16x16x32_bf16 v[88:91], v[40:43], v[16:19], v[88:91]
    ds_read_b128 v[64:67], v14 offset:21504
    v_mfma_f32_16x16x32_bf16 v[92:95], v[40:43], v[20:23], v[92:95]
    ds_read_b128 v[68:71], v14 offset:22528
    v_mfma_f32_16x16x32_bf16 v[96:99], v[44:47], v[16:19], v[96:99]
    v_mfma_f32_16x16x32_bf16 v[100:103], v[44:47], v[20:23], v[100:103]
    v_mfma_f32_16x16x32_bf16 v[104:107], v[48:51], v[16:19], v[104:107]
    v_mfma_f32_16x16x32_bf16 v[108:111], v[48:51], v[20:23], v[108:111]
    s_waitcnt lgkmcnt(0)
    s_barrier
    v_add_u32 v14, 98304, v12
    v_add_u32 v13, 98304, v11
    ds_read_b128 v[16:19], v13 offset:12288
    v_mfma_f32_16x16x32_bf16 v[72:75], v[52:55], v[24:27], v[72:75]
    ds_read_b128 v[20:23], v13 offset:12544
    v_mfma_f32_16x16x32_bf16 v[76:79], v[52:55], v[28:31], v[76:79]
    ds_read_b128 v[32:35], v14 offset:12288
    v_mfma_f32_16x16x32_bf16 v[80:83], v[56:59], v[24:27], v[80:83]
    ds_read_b128 v[36:39], v14 offset:13312
    v_mfma_f32_16x16x32_bf16 v[84:87], v[56:59], v[28:31], v[84:87]
    ds_read_b128 v[40:43], v14 offset:14336
    v_mfma_f32_16x16x32_bf16 v[88:91], v[60:63], v[24:27], v[88:91]
    ds_read_b128 v[44:47], v14 offset:15360
    v_mfma_f32_16x16x32_bf16 v[92:95], v[60:63], v[28:31], v[92:95]
    ds_read_b128 v[48:51], v14 offset:16384
    v_mfma_f32_16x16x32_bf16 v[96:99], v[64:67], v[24:27], v[96:99]
    v_mfma_f32_16x16x32_bf16 v[100:103], v[64:67], v[28:31], v[100:103]
    v_mfma_f32_16x16x32_bf16 v[104:107], v[68:71], v[24:27], v[104:107]
    v_mfma_f32_16x16x32_bf16 v[108:111], v[68:71], v[28:31], v[108:111]
    s_waitcnt lgkmcnt(0)
    ds_read_b128 v[24:27], v13 offset:20480
    v_mfma_f32_16x16x32_bf16 v[72:75], v[32:35], v[16:19], v[72:75]
    ds_read_b128 v[28:31], v13 offset:20736
    v_mfma_f32_16x16x32_bf16 v[76:79], v[32:35], v[20:23], v[76:79]
    ds_read_b128 v[52:55], v14 offset:22528
    v_mfma_f32_16x16x32_bf16 v[80:83], v[36:39], v[16:19], v[80:83]
    ds_read_b128 v[56:59], v14 offset:23552
    v_mfma_f32_16x16x32_bf16 v[84:87], v[36:39], v[20:23], v[84:87]
    ds_read_b128 v[60:63], v14 offset:24576
    v_mfma_f32_16x16x32_bf16 v[88:91], v[40:43], v[16:19], v[88:91]
    ds_read_b128 v[64:67], v14 offset:25600
    v_mfma_f32_16x16x32_bf16 v[92:95], v[40:43], v[20:23], v[92:95]
    ds_read_b128 v[68:71], v14 offset:26624
    v_mfma_f32_16x16x32_bf16 v[96:99], v[44:47], v[16:19], v[96:99]
    v_mfma_f32_16x16x32_bf16 v[100:103], v[44:47], v[20:23], v[100:103]
    v_mfma_f32_16x16x32_bf16 v[104:107], v[48:51], v[16:19], v[104:107]
    v_mfma_f32_16x16x32_bf16 v[108:111], v[48:51], v[20:23], v[108:111]
    s_waitcnt lgkmcnt(0)
    s_barrier
    v_add_u32 v14, 0, v12
    v_add_u32 v13, 0, v11
    ds_read_b128 v[16:19], v13 offset:0
    v_mfma_f32_16x16x32_bf16 v[72:75], v[52:55], v[24:27], v[72:75]
    ds_read_b128 v[20:23], v13 offset:256
    v_mfma_f32_16x16x32_bf16 v[76:79], v[52:55], v[28:31], v[76:79]
    ds_read_b128 v[32:35], v14 offset:0
    v_mfma_f32_16x16x32_bf16 v[80:83], v[56:59], v[24:27], v[80:83]
    ds_read_b128 v[36:39], v14 offset:1024
    v_mfma_f32_16x16x32_bf16 v[84:87], v[56:59], v[28:31], v[84:87]
    ds_read_b128 v[40:43], v14 offset:2048
    v_mfma_f32_16x16x32_bf16 v[88:91], v[60:63], v[24:27], v[88:91]
    ds_read_b128 v[44:47], v14 offset:3072
    v_mfma_f32_16x16x32_bf16 v[92:95], v[60:63], v[28:31], v[92:95]
    ds_read_b128 v[48:51], v14 offset:4096
    v_mfma_f32_16x16x32_bf16 v[96:99], v[64:67], v[24:27], v[96:99]
    v_mfma_f32_16x16x32_bf16 v[100:103], v[64:67], v[28:31], v[100:103]
    v_mfma_f32_16x16x32_bf16 v[104:107], v[68:71], v[24:27], v[104:107]
    v_mfma_f32_16x16x32_bf16 v[108:111], v[68:71], v[28:31], v[108:111]
    s_waitcnt lgkmcnt(0)
    ds_read_b128 v[24:27], v13 offset:8192
    v_mfma_f32_16x16x32_bf16 v[72:75], v[32:35], v[16:19], v[72:75]
    ds_read_b128 v[28:31], v13 offset:8448
    v_mfma_f32_16x16x32_bf16 v[76:79], v[32:35], v[20:23], v[76:79]
    ds_read_b128 v[52:55], v14 offset:10240
    v_mfma_f32_16x16x32_bf16 v[80:83], v[36:39], v[16:19], v[80:83]
    ds_read_b128 v[56:59], v14 offset:11264
    v_mfma_f32_16x16x32_bf16 v[84:87], v[36:39], v[20:23], v[84:87]
    ds_read_b128 v[60:63], v14 offset:12288
    v_mfma_f32_16x16x32_bf16 v[88:91], v[40:43], v[16:19], v[88:91]
    ds_read_b128 v[64:67], v14 offset:13312
    v_mfma_f32_16x16x32_bf16 v[92:95], v[40:43], v[20:23], v[92:95]
    ds_read_b128 v[68:71], v14 offset:14336
    v_mfma_f32_16x16x32_bf16 v[96:99], v[44:47], v[16:19], v[96:99]
    v_mfma_f32_16x16x32_bf16 v[100:103], v[44:47], v[20:23], v[100:103]
    v_mfma_f32_16x16x32_bf16 v[104:107], v[48:51], v[16:19], v[104:107]
    v_mfma_f32_16x16x32_bf16 v[108:111], v[48:51], v[20:23], v[108:111]
    s_waitcnt lgkmcnt(0)
    s_barrier
    v_add_u32 v14, 32768, v12
    v_add_u32 v13, 32768, v11
    ds_read_b128 v[16:19], v13 offset:4096
    v_mfma_f32_16x16x32_bf16 v[72:75], v[52:55], v[24:27], v[72:75]
    ds_read_b128 v[20:23], v13 offset:4352
    v_mfma_f32_16x16x32_bf16 v[76:79], v[52:55], v[28:31], v[76:79]
    ds_read_b128 v[32:35], v14 offset:4096
    v_mfma_f32_16x16x32_bf16 v[80:83], v[56:59], v[24:27], v[80:83]
    ds_read_b128 v[36:39], v14 offset:5120
    v_mfma_f32_16x16x32_bf16 v[84:87], v[56:59], v[28:31], v[84:87]
    ds_read_b128 v[40:43], v14 offset:6144
    v_mfma_f32_16x16x32_bf16 v[88:91], v[60:63], v[24:27], v[88:91]
    ds_read_b128 v[44:47], v14 offset:7168
    v_mfma_f32_16x16x32_bf16 v[92:95], v[60:63], v[28:31], v[92:95]
    ds_read_b128 v[48:51], v14 offset:8192
    v_mfma_f32_16x16x32_bf16 v[96:99], v[64:67], v[24:27], v[96:99]
    v_mfma_f32_16x16x32_bf16 v[100:103], v[64:67], v[28:31], v[100:103]
    v_mfma_f32_16x16x32_bf16 v[104:107], v[68:71], v[24:27], v[104:107]
    v_mfma_f32_16x16x32_bf16 v[108:111], v[68:71], v[28:31], v[108:111]
    s_waitcnt lgkmcnt(0)
    ds_read_b128 v[24:27], v13 offset:12288
    v_mfma_f32_16x16x32_bf16 v[72:75], v[32:35], v[16:19], v[72:75]
    ds_read_b128 v[28:31], v13 offset:12544
    v_mfma_f32_16x16x32_bf16 v[76:79], v[32:35], v[20:23], v[76:79]
    ds_read_b128 v[52:55], v14 offset:14336
    v_mfma_f32_16x16x32_bf16 v[80:83], v[36:39], v[16:19], v[80:83]
    ds_read_b128 v[56:59], v14 offset:15360
    v_mfma_f32_16x16x32_bf16 v[84:87], v[36:39], v[20:23], v[84:87]
    ds_read_b128 v[60:63], v14 offset:16384
    v_mfma_f32_16x16x32_bf16 v[88:91], v[40:43], v[16:19], v[88:91]
    ds_read_b128 v[64:67], v14 offset:17408
    v_mfma_f32_16x16x32_bf16 v[92:95], v[40:43], v[20:23], v[92:95]
    ds_read_b128 v[68:71], v14 offset:18432
    v_mfma_f32_16x16x32_bf16 v[96:99], v[44:47], v[16:19], v[96:99]
    v_mfma_f32_16x16x32_bf16 v[100:103], v[44:47], v[20:23], v[100:103]
    v_mfma_f32_16x16x32_bf16 v[104:107], v[48:51], v[16:19], v[104:107]
    v_mfma_f32_16x16x32_bf16 v[108:111], v[48:51], v[20:23], v[108:111]
    s_waitcnt lgkmcnt(0)
    s_barrier
    v_add_u32 v14, 65536, v12
    v_add_u32 v13, 65536, v11
    ds_read_b128 v[16:19], v13 offset:8192
    v_mfma_f32_16x16x32_bf16 v[72:75], v[52:55], v[24:27], v[72:75]
    ds_read_b128 v[20:23], v13 offset:8448
    v_mfma_f32_16x16x32_bf16 v[76:79], v[52:55], v[28:31], v[76:79]
    ds_read_b128 v[32:35], v14 offset:8192
    v_mfma_f32_16x16x32_bf16 v[80:83], v[56:59], v[24:27], v[80:83]
    ds_read_b128 v[36:39], v14 offset:9216
    v_mfma_f32_16x16x32_bf16 v[84:87], v[56:59], v[28:31], v[84:87]
    ds_read_b128 v[40:43], v14 offset:10240
    v_mfma_f32_16x16x32_bf16 v[88:91], v[60:63], v[24:27], v[88:91]
    ds_read_b128 v[44:47], v14 offset:11264
    v_mfma_f32_16x16x32_bf16 v[92:95], v[60:63], v[28:31], v[92:95]
    ds_read_b128 v[48:51], v14 offset:12288
    v_mfma_f32_16x16x32_bf16 v[96:99], v[64:67], v[24:27], v[96:99]
    v_mfma_f32_16x16x32_bf16 v[100:103], v[64:67], v[28:31], v[100:103]
    v_mfma_f32_16x16x32_bf16 v[104:107], v[68:71], v[24:27], v[104:107]
    v_mfma_f32_16x16x32_bf16 v[108:111], v[68:71], v[28:31], v[108:111]
    s_waitcnt lgkmcnt(0)
    ds_read_b128 v[24:27], v13 offset:16384
    v_mfma_f32_16x16x32_bf16 v[72:75], v[32:35], v[16:19], v[72:75]
    ds_read_b128 v[28:31], v13 offset:16640
    v_mfma_f32_16x16x32_bf16 v[76:79], v[32:35], v[20:23], v[76:79]
    ds_read_b128 v[52:55], v14 offset:18432
    v_mfma_f32_16x16x32_bf16 v[80:83], v[36:39], v[16:19], v[80:83]
    ds_read_b128 v[56:59], v14 offset:19456
    v_mfma_f32_16x16x32_bf16 v[84:87], v[36:39], v[20:23], v[84:87]
    ds_read_b128 v[60:63], v14 offset:20480
    v_mfma_f32_16x16x32_bf16 v[88:91], v[40:43], v[16:19], v[88:91]
    ds_read_b128 v[64:67], v14 offset:21504
    v_mfma_f32_16x16x32_bf16 v[92:95], v[40:43], v[20:23], v[92:95]
    ds_read_b128 v[68:71], v14 offset:22528
    v_mfma_f32_16x16x32_bf16 v[96:99], v[44:47], v[16:19], v[96:99]
    v_mfma_f32_16x16x32_bf16 v[100:103], v[44:47], v[20:23], v[100:103]
    v_mfma_f32_16x16x32_bf16 v[104:107], v[48:51], v[16:19], v[104:107]
    v_mfma_f32_16x16x32_bf16 v[108:111], v[48:51], v[20:23], v[108:111]
    s_waitcnt lgkmcnt(0)
    s_barrier
    v_add_u32 v14, 98304, v12
    v_add_u32 v13, 98304, v11
    ds_read_b128 v[16:19], v13 offset:12288
    v_mfma_f32_16x16x32_bf16 v[72:75], v[52:55], v[24:27], v[72:75]
    ds_read_b128 v[20:23], v13 offset:12544
    v_mfma_f32_16x16x32_bf16 v[76:79], v[52:55], v[28:31], v[76:79]
    ds_read_b128 v[32:35], v14 offset:12288
    v_mfma_f32_16x16x32_bf16 v[80:83], v[56:59], v[24:27], v[80:83]
    ds_read_b128 v[36:39], v14 offset:13312
    v_mfma_f32_16x16x32_bf16 v[84:87], v[56:59], v[28:31], v[84:87]
    ds_read_b128 v[40:43], v14 offset:14336
    v_mfma_f32_16x16x32_bf16 v[88:91], v[60:63], v[24:27], v[88:91]
    ds_read_b128 v[44:47], v14 offset:15360
    v_mfma_f32_16x16x32_bf16 v[92:95], v[60:63], v[28:31], v[92:95]
    ds_read_b128 v[48:51], v14 offset:16384
    v_mfma_f32_16x16x32_bf16 v[96:99], v[64:67], v[24:27], v[96:99]
    v_mfma_f32_16x16x32_bf16 v[100:103], v[64:67], v[28:31], v[100:103]
    v_mfma_f32_16x16x32_bf16 v[104:107], v[68:71], v[24:27], v[104:107]
    v_mfma_f32_16x16x32_bf16 v[108:111], v[68:71], v[28:31], v[108:111]
    s_waitcnt lgkmcnt(0)
    ds_read_b128 v[24:27], v13 offset:20480
    v_mfma_f32_16x16x32_bf16 v[72:75], v[32:35], v[16:19], v[72:75]
    ds_read_b128 v[28:31], v13 offset:20736
    v_mfma_f32_16x16x32_bf16 v[76:79], v[32:35], v[20:23], v[76:79]
    ds_read_b128 v[52:55], v14 offset:22528
    v_mfma_f32_16x16x32_bf16 v[80:83], v[36:39], v[16:19], v[80:83]
    ds_read_b128 v[56:59], v14 offset:23552
    v_mfma_f32_16x16x32_bf16 v[84:87], v[36:39], v[20:23], v[84:87]
    ds_read_b128 v[60:63], v14 offset:24576
    v_mfma_f32_16x16x32_bf16 v[88:91], v[40:43], v[16:19], v[88:91]
    ds_read_b128 v[64:67], v14 offset:25600
    v_mfma_f32_16x16x32_bf16 v[92:95], v[40:43], v[20:23], v[92:95]
    ds_read_b128 v[68:71], v14 offset:26624
    v_mfma_f32_16x16x32_bf16 v[96:99], v[44:47], v[16:19], v[96:99]
    v_mfma_f32_16x16x32_bf16 v[100:103], v[44:47], v[20:23], v[100:103]
    v_mfma_f32_16x16x32_bf16 v[104:107], v[48:51], v[16:19], v[104:107]
    v_mfma_f32_16x16x32_bf16 v[108:111], v[48:51], v[20:23], v[108:111]
    s_waitcnt lgkmcnt(0)
    v_mfma_f32_16x16x32_bf16 v[72:75], v[52:55], v[24:27], v[72:75]
    v_mfma_f32_16x16x32_bf16 v[76:79], v[52:55], v[28:31], v[76:79]
    v_mfma_f32_16x16x32_bf16 v[80:83], v[56:59], v[24:27], v[80:83]
    v_mfma_f32_16x16x32_bf16 v[84:87], v[56:59], v[28:31], v[84:87]
    v_mfma_f32_16x16x32_bf16 v[88:91], v[60:63], v[24:27], v[88:91]
    v_mfma_f32_16x16x32_bf16 v[92:95], v[60:63], v[28:31], v[92:95]
    v_mfma_f32_16x16x32_bf16 v[96:99], v[64:67], v[24:27], v[96:99]
    v_mfma_f32_16x16x32_bf16 v[100:103], v[64:67], v[28:31], v[100:103]
    v_mfma_f32_16x16x32_bf16 v[104:107], v[68:71], v[24:27], v[104:107]
    v_mfma_f32_16x16x32_bf16 v[108:111], v[68:71], v[28:31], v[108:111]
    s_nop 7
k5_w2_kernel_after3:
    s_barrier
    s_cmp_ge_u32 s26, 4
    s_cbranch_scc1 k5_w2_kernel_b27
    s_cmp_eq_u32 s35, 0
    s_cbranch_scc1 k5_w2_kernel_h05
    ds_write_b128 v145, v[72:75] offset:0
    ds_write_b128 v145, v[76:79] offset:2048
    ds_write_b128 v145, v[80:83] offset:4096
    ds_write_b128 v145, v[84:87] offset:6144
    ds_write_b128 v145, v[88:91] offset:8192
    ds_write_b128 v145, v[92:95] offset:10240
    ds_write_b128 v145, v[96:99] offset:12288
    ds_write_b128 v145, v[100:103] offset:14336
    ds_write_b128 v145, v[104:107] offset:16384
    ds_write_b128 v145, v[108:111] offset:18432
    s_waitcnt lgkmcnt(0)
    s_branch k5_w2_kernel_b27
k5_w2_kernel_h05:
k5_w2_kernel_b27:
    s_barrier
    s_cmp_ge_u32 s26, 2
    s_cbranch_scc1 k5_w2_kernel_fin6
    ds_read_b128 v[32:35], v145 offset:0
    ds_read_b128 v[52:55], v145 offset:2048
    ds_read_b128 v[36:39], v145 offset:4096
    ds_read_b128 v[56:59], v145 offset:6144
    ds_read_b128 v[40:43], v145 offset:8192
    ds_read_b128 v[60:63], v145 offset:10240
    ds_read_b128 v[44:47], v145 offset:12288
    ds_read_b128 v[64:67], v145 offset:14336
    ds_read_b128 v[48:51], v145 offset:16384
    ds_read_b128 v[68:71], v145 offset:18432
    s_waitcnt vmcnt(0) lgkmcnt(0)
    v_lshlrev_b32 v16, 16, v132
    v_and_b32 v17, 0xffff0000, v132
    v_lshlrev_b32 v18, 16, v133
    v_and_b32 v19, 0xffff0000, v133
    v_add_f32 v72, v72, v32
    v_add_f32 v73, v73, v33
    v_add_f32 v74, v74, v34
    v_add_f32 v75, v75, v35
    v_lshlrev_b32 v146, 16, v112
    v_and_b32 v147, 0xffff0000, v112
    v_lshlrev_b32 v148, 16, v113
    v_and_b32 v149, 0xffff0000, v113
    v_add_f32 v72, v72, v146
    v_add_f32 v73, v73, v147
    v_add_f32 v74, v74, v148
    v_add_f32 v75, v75, v149
    v_add_f32 v72, v72, v16
    v_add_f32 v73, v73, v17
    v_add_f32 v74, v74, v18
    v_add_f32 v75, v75, v19
    v_add_f32 v76, v76, v52
    v_add_f32 v77, v77, v53
    v_add_f32 v78, v78, v54
    v_add_f32 v79, v79, v55
    v_lshlrev_b32 v146, 16, v114
    v_and_b32 v147, 0xffff0000, v114
    v_lshlrev_b32 v148, 16, v115
    v_and_b32 v149, 0xffff0000, v115
    v_add_f32 v76, v76, v146
    v_add_f32 v77, v77, v147
    v_add_f32 v78, v78, v148
    v_add_f32 v79, v79, v149
    v_add_f32 v76, v76, v16
    v_add_f32 v77, v77, v17
    v_add_f32 v78, v78, v18
    v_add_f32 v79, v79, v19
    v_lshlrev_b32 v16, 16, v134
    v_and_b32 v17, 0xffff0000, v134
    v_lshlrev_b32 v18, 16, v135
    v_and_b32 v19, 0xffff0000, v135
    v_add_f32 v80, v80, v36
    v_add_f32 v81, v81, v37
    v_add_f32 v82, v82, v38
    v_add_f32 v83, v83, v39
    v_lshlrev_b32 v146, 16, v116
    v_and_b32 v147, 0xffff0000, v116
    v_lshlrev_b32 v148, 16, v117
    v_and_b32 v149, 0xffff0000, v117
    v_add_f32 v80, v80, v146
    v_add_f32 v81, v81, v147
    v_add_f32 v82, v82, v148
    v_add_f32 v83, v83, v149
    v_add_f32 v80, v80, v16
    v_add_f32 v81, v81, v17
    v_add_f32 v82, v82, v18
    v_add_f32 v83, v83, v19
    v_add_f32 v84, v84, v56
    v_add_f32 v85, v85, v57
    v_add_f32 v86, v86, v58
    v_add_f32 v87, v87, v59
    v_lshlrev_b32 v146, 16, v118
    v_and_b32 v147, 0xffff0000, v118
    v_lshlrev_b32 v148, 16, v119
    v_and_b32 v149, 0xffff0000, v119
    v_add_f32 v84, v84, v146
    v_add_f32 v85, v85, v147
    v_add_f32 v86, v86, v148
    v_add_f32 v87, v87, v149
    v_add_f32 v84, v84, v16
    v_add_f32 v85, v85, v17
    v_add_f32 v86, v86, v18
    v_add_f32 v87, v87, v19
    v_lshlrev_b32 v16, 16, v136
    v_and_b32 v17, 0xffff0000, v136
    v_lshlrev_b32 v18, 16, v137
    v_and_b32 v19, 0xffff0000, v137
    v_add_f32 v88, v88, v40
    v_add_f32 v89, v89, v41
    v_add_f32 v90, v90, v42
    v_add_f32 v91, v91, v43
    v_lshlrev_b32 v146, 16, v120
    v_and_b32 v147, 0xffff0000, v120
    v_lshlrev_b32 v148, 16, v121
    v_and_b32 v149, 0xffff0000, v121
    v_add_f32 v88, v88, v146
    v_add_f32 v89, v89, v147
    v_add_f32 v90, v90, v148
    v_add_f32 v91, v91, v149
    v_add_f32 v88, v88, v16
    v_add_f32 v89, v89, v17
    v_add_f32 v90, v90, v18
    v_add_f32 v91, v91, v19
    v_add_f32 v92, v92, v60
    v_add_f32 v93, v93, v61
    v_add_f32 v94, v94, v62
    v_add_f32 v95, v95, v63
    v_lshlrev_b32 v146, 16, v122
    v_and_b32 v147, 0xffff0000, v122
    v_lshlrev_b32 v148, 16, v123
    v_and_b32 v149, 0xffff0000, v123
    v_add_f32 v92, v92, v146
    v_add_f32 v93, v93, v147
    v_add_f32 v94, v94, v148
    v_add_f32 v95, v95, v149
    v_add_f32 v92, v92, v16
    v_add_f32 v93, v93, v17
    v_add_f32 v94, v94, v18
    v_add_f32 v95, v95, v19
    v_lshlrev_b32 v16, 16, v138
    v_and_b32 v17, 0xffff0000, v138
    v_lshlrev_b32 v18, 16, v139
    v_and_b32 v19, 0xffff0000, v139
    v_add_f32 v96, v96, v44
    v_add_f32 v97, v97, v45
    v_add_f32 v98, v98, v46
    v_add_f32 v99, v99, v47
    v_lshlrev_b32 v146, 16, v124
    v_and_b32 v147, 0xffff0000, v124
    v_lshlrev_b32 v148, 16, v125
    v_and_b32 v149, 0xffff0000, v125
    v_add_f32 v96, v96, v146
    v_add_f32 v97, v97, v147
    v_add_f32 v98, v98, v148
    v_add_f32 v99, v99, v149
    v_add_f32 v96, v96, v16
    v_add_f32 v97, v97, v17
    v_add_f32 v98, v98, v18
    v_add_f32 v99, v99, v19
    v_add_f32 v100, v100, v64
    v_add_f32 v101, v101, v65
    v_add_f32 v102, v102, v66
    v_add_f32 v103, v103, v67
    v_lshlrev_b32 v146, 16, v126
    v_and_b32 v147, 0xffff0000, v126
    v_lshlrev_b32 v148, 16, v127
    v_and_b32 v149, 0xffff0000, v127
    v_add_f32 v100, v100, v146
    v_add_f32 v101, v101, v147
    v_add_f32 v102, v102, v148
    v_add_f32 v103, v103, v149
    v_add_f32 v100, v100, v16
    v_add_f32 v101, v101, v17
    v_add_f32 v102, v102, v18
    v_add_f32 v103, v103, v19
    v_lshlrev_b32 v16, 16, v140
    v_and_b32 v17, 0xffff0000, v140
    v_lshlrev_b32 v18, 16, v141
    v_and_b32 v19, 0xffff0000, v141
    v_add_f32 v104, v104, v48
    v_add_f32 v105, v105, v49
    v_add_f32 v106, v106, v50
    v_add_f32 v107, v107, v51
    v_lshlrev_b32 v146, 16, v128
    v_and_b32 v147, 0xffff0000, v128
    v_lshlrev_b32 v148, 16, v129
    v_and_b32 v149, 0xffff0000, v129
    v_add_f32 v104, v104, v146
    v_add_f32 v105, v105, v147
    v_add_f32 v106, v106, v148
    v_add_f32 v107, v107, v149
    v_add_f32 v104, v104, v16
    v_add_f32 v105, v105, v17
    v_add_f32 v106, v106, v18
    v_add_f32 v107, v107, v19
    v_add_f32 v108, v108, v68
    v_add_f32 v109, v109, v69
    v_add_f32 v110, v110, v70
    v_add_f32 v111, v111, v71
    v_lshlrev_b32 v146, 16, v130
    v_and_b32 v147, 0xffff0000, v130
    v_lshlrev_b32 v148, 16, v131
    v_and_b32 v149, 0xffff0000, v131
    v_add_f32 v108, v108, v146
    v_add_f32 v109, v109, v147
    v_add_f32 v110, v110, v148
    v_add_f32 v111, v111, v149
    v_add_f32 v108, v108, v16
    v_add_f32 v109, v109, v17
    v_add_f32 v110, v110, v18
    v_add_f32 v111, v111, v19
    v_and_b32 v5, 1, v4
    v_lshlrev_b32 v5, 1, v5
    v_lshrrev_b32 v6, 1, v4
    v_add_u32 v5, v5, v6
    v_mul_u32_u24 v164, 1280, v9
    s_mul_i32 s3, s33, 160
    v_lshl_add_u32 v164, v5, 4, v164
    v_add_u32 v164, s3, v164
    v_add_u32 v165, 20480, v164
    v_add_u32 v166, 20480, v142
    v_cvt_pk_bf16_f32 v152, v72, v73
    v_cvt_pk_bf16_f32 v153, v74, v75
    v_cvt_pk_bf16_f32 v154, v80, v81
    v_cvt_pk_bf16_f32 v155, v82, v83
    s_nop 1
    v_permlane16_swap_b32 v152, v154
    v_permlane16_swap_b32 v153, v155
    s_nop 1
    buffer_store_dwordx4 v[152:155], v164, s[48:51], 0 offen offset:0
    v_cvt_pk_bf16_f32 v156, v88, v89
    v_cvt_pk_bf16_f32 v157, v90, v91
    v_cvt_pk_bf16_f32 v158, v96, v97
    v_cvt_pk_bf16_f32 v159, v98, v99
    s_nop 1
    v_permlane16_swap_b32 v156, v158
    v_permlane16_swap_b32 v157, v159
    s_nop 1
    buffer_store_dwordx4 v[156:159], v164, s[48:51], 0 offen offset:64
    v_cvt_pk_bf16_f32 v160, v104, v105
    v_cvt_pk_bf16_f32 v161, v106, v107
    buffer_store_dwordx2 v[160:161], v142, s[48:51], 0 offen offset:128
    v_cvt_pk_bf16_f32 v152, v76, v77
    v_cvt_pk_bf16_f32 v153, v78, v79
    v_cvt_pk_bf16_f32 v154, v84, v85
    v_cvt_pk_bf16_f32 v155, v86, v87
    s_nop 1
    v_permlane16_swap_b32 v152, v154
    v_permlane16_swap_b32 v153, v155
    s_nop 1
    buffer_store_dwordx4 v[152:155], v165, s[48:51], 0 offen offset:0
    v_cvt_pk_bf16_f32 v156, v92, v93
    v_cvt_pk_bf16_f32 v157, v94, v95
    v_cvt_pk_bf16_f32 v158, v100, v101
    v_cvt_pk_bf16_f32 v159, v102, v103
    s_nop 1
    v_permlane16_swap_b32 v156, v158
    v_permlane16_swap_b32 v157, v159
    s_nop 1
    buffer_store_dwordx4 v[156:159], v165, s[48:51], 0 offen offset:64
    v_cvt_pk_bf16_f32 v160, v108, v109
    v_cvt_pk_bf16_f32 v161, v110, v111
    buffer_store_dwordx2 v[160:161], v166, s[48:51], 0 offen offset:128
k5_w2_kernel_fin6:
k5_w2_kernel_end1:
    s_endpgm
code_end:
.section .rodata,"a"
.p2align 6
.amdhsa_kernel k1_qkv_kernel
  .amdhsa_next_free_vgpr 168
  .amdhsa_next_free_sgpr 68
  .amdhsa_accum_offset 168
  .amdhsa_group_segment_fixed_size 0
  .amdhsa_kernarg_size 88
  .amdhsa_user_sgpr_count 2
  .amdhsa_user_sgpr_kernarg_segment_ptr 1
  .amdhsa_system_sgpr_workgroup_id_x 1
.end_amdhsa_kernel
.p2align 6
.amdhsa_kernel k2_attn_kernel
  .amdhsa_next_free_vgpr 248
  .amdhsa_next_free_sgpr 80
  .amdhsa_accum_offset 248
  .amdhsa_group_segment_fixed_size 0
  .amdhsa_kernarg_size 88
  .amdhsa_user_sgpr_count 2
  .amdhsa_user_sgpr_kernarg_segment_ptr 1
  .amdhsa_system_sgpr_workgroup_id_x 1
.end_amdhsa_kernel
.p2align 6
.amdhsa_kernel k3_wo_kernel
  .amdhsa_next_free_vgpr 176
  .amdhsa_next_free_sgpr 65
  .amdhsa_accum_offset 176
  .amdhsa_group_segment_fixed_size 0
  .amdhsa_kernarg_size 88
  .amdhsa_user_sgpr_count 2
  .amdhsa_user_sgpr_kernarg_segment_ptr 1
  .amdhsa_system_sgpr_workgroup_id_x 1
.end_amdhsa_kernel
.p2align 6
.amdhsa_kernel k4_w1_kernel
  .amdhsa_next_free_vgpr 216
  .amdhsa_next_free_sgpr 64
  .amdhsa_accum_offset 216
  .amdhsa_group_segment_fixed_size 0
  .amdhsa_kernarg_size 88
  .amdhsa_user_sgpr_count 2
  .amdhsa_user_sgpr_kernarg_segment_ptr 1
  .amdhsa_system_sgpr_workgroup_id_x 1
.end_amdhsa_kernel
.p2align 6
.amdhsa_kernel k5_w2_kernel
  .amdhsa_next_free_vgpr 168
  .amdhsa_next_free_sgpr 65
  .amdhsa_accum_offset 168
  .amdhsa_group_segment_fixed_size 0
  .amdhsa_kernarg_size 88
  .amdhsa_user_sgpr_count 2
  .amdhsa_user_sgpr_kernarg_segment_ptr 1
  .amdhsa_system_sgpr_workgroup_id_x 1
.end_amdhsa_kernel
```
